```python
import torch

def _softmax(x, axis=-1):
    return torch.softmax(x, dim=axis)
def _gelu(x):
    return torch.nn.functional.gelu(x, approximate="tanh")
def _silu(x):
    return torch.nn.functional.silu(x)
def _sigmoid(x):
    return torch.sigmoid(x)
def _layernorm(x, axis=-1, eps=1e-5):
    m = x.mean(dim=axis, keepdim=True)
    v = x.var(dim=axis, keepdim=True, unbiased=False)
    return (x - m) / torch.sqrt(v + eps)
def _scatter_add(tgt, idx, src, axis=0):
    return tgt.clone().index_add_(axis, idx, src)
def _segment_sum(src, seg, n):
    out = torch.zeros((n,) + src.shape[1:], dtype=src.dtype)
    return out.index_add_(0, seg, src)
def _pad(x, pw):
    flat = tuple(v for pair in reversed(pw) for v in pair)
    return torch.nn.functional.pad(x, flat)

kernel_name = 'gather_scatter__molecular_angular_gemnet__graph'

def setup_inputs():

    _w = (lambda a: (lambda t: t.to(torch.bfloat16) if t.is_floating_point() else t)(torch.as_tensor(a)))
    N, deg, De, L = 50000, 16, 16, 1
    E = N * deg
    T = E * deg
    NR = 8
    dist = torch.rand(E).to(float)
    angle = (torch.rand(T) * torch.pi).to(float)
    centers = torch.linspace(0.0, 1.0, NR).to(float)
    ang_freq = torch.arange(1, L + 1).to(float)
    return {
        "m": _w((lambda *s: torch.randn(*s, dtype=torch.bfloat16) * 0.05)(E, De)),
        "idx_in": _w((lambda lo, hi, *s: torch.randint(lo, hi, s))(0, E, T).to(torch.int64)),
        "idx_out": _w((lambda lo, hi, *s: torch.randint(lo, hi, s))(0, E, T).to(torch.int64)),
        "dist": _w(dist),
        "angle": _w(angle),
        "centers": _w(centers),
        "ang_freq": _w(ang_freq),
        "w_rbf": _w((lambda *s: torch.randn(*s, dtype=torch.bfloat16) * 0.2)(NR, De)),
        "w_sbf": _w((lambda *s: torch.randn(*s, dtype=torch.bfloat16) * 0.2)(NR * L, De)),
        "w_down": _w((lambda *s: torch.randn(*s, dtype=torch.bfloat16) * 0.2)(De, De)),
        "w_up": _w((lambda *s: torch.randn(*s, dtype=torch.bfloat16) * 0.2)(De, De)),
    }

def reference(m, idx_in, idx_out, dist, angle, centers, ang_freq, w_rbf, w_sbf, w_down, w_up):
    E, De = m.shape[0], m.shape[1]
    NR = centers.shape[0]
    L = ang_freq.shape[0]
    rbf = torch.exp(-10.0 * (dist[:, None] - centers[None, :]) ** 2)
    cbf = torch.cos(ang_freq[None, :] * angle[:, None])
    rbf_t = rbf[idx_out]
    sbf = torch.reshape(rbf_t[:, :, None] * cbf[:, None, :], (-1, NR * L))
    x = (m[idx_in] @ w_down) * (sbf @ w_sbf)
    agg = _segment_sum(x, idx_out, E)
    return m + (agg @ w_up) * (rbf @ w_rbf)
```

```asm
; @launch grid=(256,1,1) block=(1024,1,1) lds=161936
.amdgcn_target "amdgcn-amd-amdhsa--gfx950"
.text
.globl gather_scatter__molecular_angular_gemnet__graph_kernel
.p2align 8
.type gather_scatter__molecular_angular_gemnet__graph_kernel,@function
gather_scatter__molecular_angular_gemnet__graph_kernel:
    s_load_dwordx2 s[8:9], s[0:1], 8
    s_load_dwordx2 s[12:13], s[0:1], 16
    s_cmp_ge_u32 s2, 256
    s_cbranch_scc1 P2_end
    s_getpc_b64 s[40:41]
P1_pc:
    s_lshr_b32 s45, s2, 3
    s_mulk_i32 s45, 14
    s_mov_b32 s42, P2_end-P1_pc
    s_mov_b32 s43, 0x20000
    v_add_lshl_u32 v127, v0, s45, 7
    v_cmp_gt_u32 vcc, 14, v0
    s_and_b64 exec, exec, vcc
    s_cbranch_execz P1_nopf
    buffer_load_dword v127, v127, s[40:43], 0 offen
P1_nopf:
    s_mov_b64 exec, -1
    s_mov_b32 s10, 51200000
    s_mov_b32 s11, 0x20000
    s_mov_b64 s[14:15], s[10:11]
    s_andn2_b32 s36, s2, 255
    s_mulk_i32 s36, 11
    s_add_u32 s36, s36, s2
    s_lshl_b32 s36, s36, 14
    s_lshr_b32 s37, s36, 1
    s_mov_b32 s4, s36
    v_lshlrev_b32 v1, 4, v0
    v_mov_b32 v2, v1
    s_waitcnt lgkmcnt(0)
    buffer_load_dwordx4 v[78:81], v2, s[12:15], s36 offen nt
    s_add_u32 s36, s36, 4194304
    buffer_load_dwordx4 v[4:7], v2, s[8:11], s4 offen nt
    s_add_u32 s4, s4, 4194304
    s_load_dwordx2 s[16:17], s[0:1], 32
    s_load_dwordx2 s[30:31], s[0:1], 48
    s_load_dwordx2 s[32:33], s[0:1], 104
    s_load_dwordx2 s[94:95], s[0:1], 96
    s_load_dwordx2 s[48:49], s[0:1], 0
    s_load_dwordx2 s[86:87], s[0:1], 88
    v_mov_b32 v3, 1
    v_mov_b32 v104, 0
    v_mov_b32 v105, 0
    v_mov_b32 v106, 0
    v_mov_b32 v107, 0
    ds_write_b128 v1, v[104:107]
    v_lshrrev_b32 v108, 6, v0
    s_nop 0
    v_readfirstlane_b32 s3, v108
    s_mul_i32 s34, s2, 848
    s_add_u32 s34, s34, 12582912
    v_add_u32 v109, s34, v0
    v_cmp_gt_u32 vcc, 848, v0
    v_lshlrev_b32 v110, 2, v109
    v_lshlrev_b32 v109, 1, v109
    v_cndmask_b32 v110, 2.0, v110, vcc
    v_cndmask_b32 v109, 2.0, v109, vcc
    buffer_load_dword v103, v110, s[12:15], 0 offen nt
    buffer_load_dword v52, v110, s[8:11], 0 offen nt
    s_mov_b32 s18, 25600000
    s_mov_b32 s19, 0x20000
    s_waitcnt lgkmcnt(0)
    s_load_dword s35, s[30:31], 0
    buffer_load_ushort v102, v109, s[16:19], 0 offen nt
    s_mov_b32 s38, 0x7c00
    s_mov_b32 s40, 4294956036
    v_lshl_add_u32 v120, v0, 2, 0
    v_mul_u32_u24 v104, 47663, v120
    v_lshrrev_b32 v104, 19, v104
    v_lshlrev_b32 v120, 10, v120
    v_mad_i32_i24 v120, v104, s40, v120
    v_add_u32 v120, 11344, v120
    v_lshl_add_u32 v121, v0, 2, 1
    v_mul_u32_u24 v104, 47663, v121
    v_lshrrev_b32 v104, 19, v104
    v_lshlrev_b32 v121, 10, v121
    v_mad_i32_i24 v121, v104, s40, v121
    v_add_u32 v121, 11344, v121
    v_lshl_add_u32 v122, v0, 2, 2
    v_mul_u32_u24 v104, 47663, v122
    v_lshrrev_b32 v104, 19, v104
    v_lshlrev_b32 v122, 10, v122
    v_mad_i32_i24 v122, v104, s40, v122
    v_add_u32 v122, 11344, v122
    v_lshl_add_u32 v123, v0, 2, 3
    v_mul_u32_u24 v104, 47663, v123
    v_lshrrev_b32 v104, 19, v104
    v_lshlrev_b32 v123, 10, v123
    v_mad_i32_i24 v123, v104, s40, v123
    v_add_u32 v123, 11344, v123
    s_add_u32 s20, s32, 83886080
    s_addc_u32 s21, s33, 0
    s_mov_b32 s22, 2883584
    s_mov_b32 s23, 0x20000
    s_mov_b32 s24, s94
    s_mov_b32 s25, s95
    s_mov_b32 s26, 256
    s_mov_b32 s27, 0x20000
    s_mov_b32 s44, 0
    s_mov_b32 s39, 922
    v_mov_b32 v126, 4202767296
    s_mov_b32 s5, 100000
    v_mov_b32 v124, 0x7c
    v_mov_b32 v125, 0x0ff00000
    s_barrier
    s_waitcnt vmcnt(3)
    buffer_load_dwordx4 v[82:85], v2, s[12:15], s36 offen nt
    s_add_u32 s36, s36, 4194304
    buffer_load_dwordx4 v[8:11], v2, s[8:11], s4 offen nt
    s_add_u32 s4, s4, 4194304
    v_and_b32 v104, -16, v78
    v_mul_hi_u32_u24 v104, 42950, v104
    v_mul_u32_u24 v105, 100000, v104
    v_sub_u32 v106, v4, v105
    v_sub_u32 v78, v78, v105
    v_cmp_gt_u32 s[42:43], s5, v106
    v_ashrrev_i32 v107, 31, v106
    v_add_u32 v106, 800000, v106
    v_and_b32 v107, 100000, v107
    v_add_u32 v107, v107, v4
    v_cndmask_b32 v107, v107, v106, s[42:43]
    v_lshlrev_b32 v105, 11, v78
    v_lshl_or_b32 v4, v78, 28, v4
    v_mad_u32_u24 v107, v107, s39, v126
    v_lshrrev_b32 v78, 2, v78
    v_bitop3_b32 v4, v105, v125, v4 bitop3:0xea
    v_and_b32_sdwa v107, v107, s38 dst_sel:DWORD dst_unused:UNUSED_PAD src0_sel:WORD_1 src1_sel:DWORD
    v_lshl_or_b32 v107, v104, 7, v107
    v_bitop3_b32 v78, v78, v124, v107 bitop3:0xea
    ds_add_u32 v78, v3 offset:16
    v_and_b32 v108, -16, v79
    v_mul_hi_u32_u24 v108, 42950, v108
    v_mul_u32_u24 v109, 100000, v108
    v_sub_u32 v110, v5, v109
    v_sub_u32 v79, v79, v109
    v_cmp_gt_u32 s[42:43], s5, v110
    v_ashrrev_i32 v111, 31, v110
    v_add_u32 v110, 800000, v110
    v_and_b32 v111, 100000, v111
    v_add_u32 v111, v111, v5
    v_cndmask_b32 v111, v111, v110, s[42:43]
    v_lshlrev_b32 v109, 11, v79
    v_lshl_or_b32 v5, v79, 28, v5
    v_mad_u32_u24 v111, v111, s39, v126
    v_lshrrev_b32 v79, 2, v79
    v_bitop3_b32 v5, v109, v125, v5 bitop3:0xea
    v_and_b32_sdwa v111, v111, s38 dst_sel:DWORD dst_unused:UNUSED_PAD src0_sel:WORD_1 src1_sel:DWORD
    v_lshl_or_b32 v111, v108, 7, v111
    v_bitop3_b32 v79, v79, v124, v111 bitop3:0xea
    ds_add_u32 v79, v3 offset:16
    v_and_b32 v112, -16, v80
    v_mul_hi_u32_u24 v112, 42950, v112
    v_mul_u32_u24 v113, 100000, v112
    v_sub_u32 v114, v6, v113
    v_sub_u32 v80, v80, v113
    v_cmp_gt_u32 s[42:43], s5, v114
    v_ashrrev_i32 v115, 31, v114
    v_add_u32 v114, 800000, v114
    v_and_b32 v115, 100000, v115
    v_add_u32 v115, v115, v6
    v_cndmask_b32 v115, v115, v114, s[42:43]
    v_lshlrev_b32 v113, 11, v80
    v_lshl_or_b32 v6, v80, 28, v6
    v_mad_u32_u24 v115, v115, s39, v126
    v_lshrrev_b32 v80, 2, v80
    v_bitop3_b32 v6, v113, v125, v6 bitop3:0xea
    v_and_b32_sdwa v115, v115, s38 dst_sel:DWORD dst_unused:UNUSED_PAD src0_sel:WORD_1 src1_sel:DWORD
    v_lshl_or_b32 v115, v112, 7, v115
    v_bitop3_b32 v80, v80, v124, v115 bitop3:0xea
    ds_add_u32 v80, v3 offset:16
    v_and_b32 v116, -16, v81
    v_mul_hi_u32_u24 v116, 42950, v116
    v_mul_u32_u24 v117, 100000, v116
    v_sub_u32 v118, v7, v117
    v_sub_u32 v81, v81, v117
    v_cmp_gt_u32 s[42:43], s5, v118
    v_ashrrev_i32 v119, 31, v118
    v_add_u32 v118, 800000, v118
    v_and_b32 v119, 100000, v119
    v_add_u32 v119, v119, v7
    v_cndmask_b32 v119, v119, v118, s[42:43]
    v_lshlrev_b32 v117, 11, v81
    v_lshl_or_b32 v7, v81, 28, v7
    v_mad_u32_u24 v119, v119, s39, v126
    v_lshrrev_b32 v81, 2, v81
    v_bitop3_b32 v7, v117, v125, v7 bitop3:0xea
    v_and_b32_sdwa v119, v119, s38 dst_sel:DWORD dst_unused:UNUSED_PAD src0_sel:WORD_1 src1_sel:DWORD
    v_lshl_or_b32 v119, v116, 7, v119
    v_bitop3_b32 v81, v81, v124, v119 bitop3:0xea
    ds_add_u32 v81, v3 offset:16
    v_lshl_or_b32 v53, v79, 16, v78
    v_lshl_or_b32 v54, v81, 16, v80
    s_waitcnt vmcnt(0)
    buffer_load_dwordx4 v[86:89], v2, s[12:15], s36 offen nt
    s_add_u32 s36, s36, 4194304
    buffer_load_dwordx4 v[12:15], v2, s[8:11], s4 offen nt
    s_add_u32 s4, s4, 4194304
    v_and_b32 v104, -16, v82
    v_mul_hi_u32_u24 v104, 42950, v104
    v_mul_u32_u24 v105, 100000, v104
    v_sub_u32 v106, v8, v105
    v_sub_u32 v82, v82, v105
    v_cmp_gt_u32 s[42:43], s5, v106
    v_ashrrev_i32 v107, 31, v106
    v_add_u32 v106, 800000, v106
    v_and_b32 v107, 100000, v107
    v_add_u32 v107, v107, v8
    v_cndmask_b32 v107, v107, v106, s[42:43]
    v_lshlrev_b32 v105, 11, v82
    v_lshl_or_b32 v8, v82, 28, v8
    v_mad_u32_u24 v107, v107, s39, v126
    v_lshrrev_b32 v82, 2, v82
    v_bitop3_b32 v8, v105, v125, v8 bitop3:0xea
    v_and_b32_sdwa v107, v107, s38 dst_sel:DWORD dst_unused:UNUSED_PAD src0_sel:WORD_1 src1_sel:DWORD
    v_lshl_or_b32 v107, v104, 7, v107
    v_bitop3_b32 v82, v82, v124, v107 bitop3:0xea
    ds_add_u32 v82, v3 offset:16
    v_and_b32 v108, -16, v83
    v_mul_hi_u32_u24 v108, 42950, v108
    v_mul_u32_u24 v109, 100000, v108
    v_sub_u32 v110, v9, v109
    v_sub_u32 v83, v83, v109
    v_cmp_gt_u32 s[42:43], s5, v110
    v_ashrrev_i32 v111, 31, v110
    v_add_u32 v110, 800000, v110
    v_and_b32 v111, 100000, v111
    v_add_u32 v111, v111, v9
    v_cndmask_b32 v111, v111, v110, s[42:43]
    v_lshlrev_b32 v109, 11, v83
    v_lshl_or_b32 v9, v83, 28, v9
    v_mad_u32_u24 v111, v111, s39, v126
    v_lshrrev_b32 v83, 2, v83
    v_bitop3_b32 v9, v109, v125, v9 bitop3:0xea
    v_and_b32_sdwa v111, v111, s38 dst_sel:DWORD dst_unused:UNUSED_PAD src0_sel:WORD_1 src1_sel:DWORD
    v_lshl_or_b32 v111, v108, 7, v111
    v_bitop3_b32 v83, v83, v124, v111 bitop3:0xea
    ds_add_u32 v83, v3 offset:16
    v_and_b32 v112, -16, v84
    v_mul_hi_u32_u24 v112, 42950, v112
    v_mul_u32_u24 v113, 100000, v112
    v_sub_u32 v114, v10, v113
    v_sub_u32 v84, v84, v113
    v_cmp_gt_u32 s[42:43], s5, v114
    v_ashrrev_i32 v115, 31, v114
    v_add_u32 v114, 800000, v114
    v_and_b32 v115, 100000, v115
    v_add_u32 v115, v115, v10
    v_cndmask_b32 v115, v115, v114, s[42:43]
    v_lshlrev_b32 v113, 11, v84
    v_lshl_or_b32 v10, v84, 28, v10
    v_mad_u32_u24 v115, v115, s39, v126
    v_lshrrev_b32 v84, 2, v84
    v_bitop3_b32 v10, v113, v125, v10 bitop3:0xea
    v_and_b32_sdwa v115, v115, s38 dst_sel:DWORD dst_unused:UNUSED_PAD src0_sel:WORD_1 src1_sel:DWORD
    v_lshl_or_b32 v115, v112, 7, v115
    v_bitop3_b32 v84, v84, v124, v115 bitop3:0xea
    ds_add_u32 v84, v3 offset:16
    v_and_b32 v116, -16, v85
    v_mul_hi_u32_u24 v116, 42950, v116
    v_mul_u32_u24 v117, 100000, v116
    v_sub_u32 v118, v11, v117
    v_sub_u32 v85, v85, v117
    v_cmp_gt_u32 s[42:43], s5, v118
    v_ashrrev_i32 v119, 31, v118
    v_add_u32 v118, 800000, v118
    v_and_b32 v119, 100000, v119
    v_add_u32 v119, v119, v11
    v_cndmask_b32 v119, v119, v118, s[42:43]
    v_lshlrev_b32 v117, 11, v85
    v_lshl_or_b32 v11, v85, 28, v11
    v_mad_u32_u24 v119, v119, s39, v126
    v_lshrrev_b32 v85, 2, v85
    v_bitop3_b32 v11, v117, v125, v11 bitop3:0xea
    v_and_b32_sdwa v119, v119, s38 dst_sel:DWORD dst_unused:UNUSED_PAD src0_sel:WORD_1 src1_sel:DWORD
    v_lshl_or_b32 v119, v116, 7, v119
    v_bitop3_b32 v85, v85, v124, v119 bitop3:0xea
    ds_add_u32 v85, v3 offset:16
    v_lshl_or_b32 v55, v83, 16, v82
    v_lshl_or_b32 v56, v85, 16, v84
    s_waitcnt vmcnt(0)
    buffer_load_dwordx4 v[90:93], v2, s[12:15], s36 offen nt
    s_add_u32 s36, s36, 4194304
    buffer_load_dwordx4 v[16:19], v2, s[8:11], s4 offen nt
    s_add_u32 s4, s4, 4194304
    v_and_b32 v104, -16, v103
    v_mul_hi_u32_u24 v104, 42950, v104
    v_mul_u32_u24 v105, 100000, v104
    v_sub_u32 v106, v52, v105
    v_sub_u32 v103, v103, v105
    v_cmp_gt_u32 s[42:43], s5, v106
    v_ashrrev_i32 v107, 31, v106
    v_add_u32 v106, 800000, v106
    v_and_b32 v107, 100000, v107
    v_add_u32 v107, v107, v52
    v_cndmask_b32 v107, v107, v106, s[42:43]
    v_lshlrev_b32 v105, 11, v103
    v_lshl_or_b32 v52, v103, 28, v52
    v_mad_u32_u24 v107, v107, s39, v126
    v_lshrrev_b32 v103, 2, v103
    v_bitop3_b32 v52, v105, v125, v52 bitop3:0xea
    v_and_b32_sdwa v107, v107, s38 dst_sel:DWORD dst_unused:UNUSED_PAD src0_sel:WORD_1 src1_sel:DWORD
    v_lshl_or_b32 v107, v104, 7, v107
    v_bitop3_b32 v103, v103, v124, v107 bitop3:0xea
    v_cndmask_b32 v77, 2.0, v103, vcc
    ds_add_u32 v77, v3 offset:16
    v_and_b32 v104, -16, v86
    v_mul_hi_u32_u24 v104, 42950, v104
    v_mul_u32_u24 v105, 100000, v104
    v_sub_u32 v106, v12, v105
    v_sub_u32 v86, v86, v105
    v_cmp_gt_u32 s[42:43], s5, v106
    v_ashrrev_i32 v107, 31, v106
    v_add_u32 v106, 800000, v106
    v_and_b32 v107, 100000, v107
    v_add_u32 v107, v107, v12
    v_cndmask_b32 v107, v107, v106, s[42:43]
    v_lshlrev_b32 v105, 11, v86
    v_lshl_or_b32 v12, v86, 28, v12
    v_mad_u32_u24 v107, v107, s39, v126
    v_lshrrev_b32 v86, 2, v86
    v_bitop3_b32 v12, v105, v125, v12 bitop3:0xea
    v_and_b32_sdwa v107, v107, s38 dst_sel:DWORD dst_unused:UNUSED_PAD src0_sel:WORD_1 src1_sel:DWORD
    v_lshl_or_b32 v107, v104, 7, v107
    v_bitop3_b32 v86, v86, v124, v107 bitop3:0xea
    ds_add_u32 v86, v3 offset:16
    v_and_b32 v108, -16, v87
    v_mul_hi_u32_u24 v108, 42950, v108
    v_mul_u32_u24 v109, 100000, v108
    v_sub_u32 v110, v13, v109
    v_sub_u32 v87, v87, v109
    v_cmp_gt_u32 s[42:43], s5, v110
    v_ashrrev_i32 v111, 31, v110
    v_add_u32 v110, 800000, v110
    v_and_b32 v111, 100000, v111
    v_add_u32 v111, v111, v13
    v_cndmask_b32 v111, v111, v110, s[42:43]
    v_lshlrev_b32 v109, 11, v87
    v_lshl_or_b32 v13, v87, 28, v13
    v_mad_u32_u24 v111, v111, s39, v126
    v_lshrrev_b32 v87, 2, v87
    v_bitop3_b32 v13, v109, v125, v13 bitop3:0xea
    v_and_b32_sdwa v111, v111, s38 dst_sel:DWORD dst_unused:UNUSED_PAD src0_sel:WORD_1 src1_sel:DWORD
    v_lshl_or_b32 v111, v108, 7, v111
    v_bitop3_b32 v87, v87, v124, v111 bitop3:0xea
    ds_add_u32 v87, v3 offset:16
    v_and_b32 v112, -16, v88
    v_mul_hi_u32_u24 v112, 42950, v112
    v_mul_u32_u24 v113, 100000, v112
    v_sub_u32 v114, v14, v113
    v_sub_u32 v88, v88, v113
    v_cmp_gt_u32 s[42:43], s5, v114
    v_ashrrev_i32 v115, 31, v114
    v_add_u32 v114, 800000, v114
    v_and_b32 v115, 100000, v115
    v_add_u32 v115, v115, v14
    v_cndmask_b32 v115, v115, v114, s[42:43]
    v_lshlrev_b32 v113, 11, v88
    v_lshl_or_b32 v14, v88, 28, v14
    v_mad_u32_u24 v115, v115, s39, v126
    v_lshrrev_b32 v88, 2, v88
    v_bitop3_b32 v14, v113, v125, v14 bitop3:0xea
    v_and_b32_sdwa v115, v115, s38 dst_sel:DWORD dst_unused:UNUSED_PAD src0_sel:WORD_1 src1_sel:DWORD
    v_lshl_or_b32 v115, v112, 7, v115
    v_bitop3_b32 v88, v88, v124, v115 bitop3:0xea
    ds_add_u32 v88, v3 offset:16
    v_and_b32 v116, -16, v89
    v_mul_hi_u32_u24 v116, 42950, v116
    v_mul_u32_u24 v117, 100000, v116
    v_sub_u32 v118, v15, v117
    v_sub_u32 v89, v89, v117
    v_cmp_gt_u32 s[42:43], s5, v118
    v_ashrrev_i32 v119, 31, v118
    v_add_u32 v118, 800000, v118
    v_and_b32 v119, 100000, v119
    v_add_u32 v119, v119, v15
    v_cndmask_b32 v119, v119, v118, s[42:43]
    v_lshlrev_b32 v117, 11, v89
    v_lshl_or_b32 v15, v89, 28, v15
    v_mad_u32_u24 v119, v119, s39, v126
    v_lshrrev_b32 v89, 2, v89
    v_bitop3_b32 v15, v117, v125, v15 bitop3:0xea
    v_and_b32_sdwa v119, v119, s38 dst_sel:DWORD dst_unused:UNUSED_PAD src0_sel:WORD_1 src1_sel:DWORD
    v_lshl_or_b32 v119, v116, 7, v119
    v_bitop3_b32 v89, v89, v124, v119 bitop3:0xea
    ds_add_u32 v89, v3 offset:16
    v_lshl_or_b32 v57, v87, 16, v86
    v_lshl_or_b32 v58, v89, 16, v88
    s_waitcnt vmcnt(0)
    buffer_load_dwordx4 v[94:97], v2, s[12:15], s36 offen nt
    s_add_u32 s36, s36, 4194304
    buffer_load_dwordx4 v[20:23], v2, s[8:11], s4 offen nt
    s_add_u32 s4, s4, 4194304
    v_and_b32 v104, -16, v90
    v_mul_hi_u32_u24 v104, 42950, v104
    v_mul_u32_u24 v105, 100000, v104
    v_sub_u32 v106, v16, v105
    v_sub_u32 v90, v90, v105
    v_cmp_gt_u32 s[42:43], s5, v106
    v_ashrrev_i32 v107, 31, v106
    v_add_u32 v106, 800000, v106
    v_and_b32 v107, 100000, v107
    v_add_u32 v107, v107, v16
    v_cndmask_b32 v107, v107, v106, s[42:43]
    v_lshlrev_b32 v105, 11, v90
    v_lshl_or_b32 v16, v90, 28, v16
    v_mad_u32_u24 v107, v107, s39, v126
    v_lshrrev_b32 v90, 2, v90
    v_bitop3_b32 v16, v105, v125, v16 bitop3:0xea
    v_and_b32_sdwa v107, v107, s38 dst_sel:DWORD dst_unused:UNUSED_PAD src0_sel:WORD_1 src1_sel:DWORD
    v_lshl_or_b32 v107, v104, 7, v107
    v_bitop3_b32 v90, v90, v124, v107 bitop3:0xea
    ds_add_u32 v90, v3 offset:16
    v_and_b32 v108, -16, v91
    v_mul_hi_u32_u24 v108, 42950, v108
    v_mul_u32_u24 v109, 100000, v108
    v_sub_u32 v110, v17, v109
    v_sub_u32 v91, v91, v109
    v_cmp_gt_u32 s[42:43], s5, v110
    v_ashrrev_i32 v111, 31, v110
    v_add_u32 v110, 800000, v110
    v_and_b32 v111, 100000, v111
    v_add_u32 v111, v111, v17
    v_cndmask_b32 v111, v111, v110, s[42:43]
    v_lshlrev_b32 v109, 11, v91
    v_lshl_or_b32 v17, v91, 28, v17
    v_mad_u32_u24 v111, v111, s39, v126
    v_lshrrev_b32 v91, 2, v91
    v_bitop3_b32 v17, v109, v125, v17 bitop3:0xea
    v_and_b32_sdwa v111, v111, s38 dst_sel:DWORD dst_unused:UNUSED_PAD src0_sel:WORD_1 src1_sel:DWORD
    v_lshl_or_b32 v111, v108, 7, v111
    v_bitop3_b32 v91, v91, v124, v111 bitop3:0xea
    ds_add_u32 v91, v3 offset:16
    v_and_b32 v112, -16, v92
    v_mul_hi_u32_u24 v112, 42950, v112
    v_mul_u32_u24 v113, 100000, v112
    v_sub_u32 v114, v18, v113
    v_sub_u32 v92, v92, v113
    v_cmp_gt_u32 s[42:43], s5, v114
    v_ashrrev_i32 v115, 31, v114
    v_add_u32 v114, 800000, v114
    v_and_b32 v115, 100000, v115
    v_add_u32 v115, v115, v18
    v_cndmask_b32 v115, v115, v114, s[42:43]
    v_lshlrev_b32 v113, 11, v92
    v_lshl_or_b32 v18, v92, 28, v18
    v_mad_u32_u24 v115, v115, s39, v126
    v_lshrrev_b32 v92, 2, v92
    v_bitop3_b32 v18, v113, v125, v18 bitop3:0xea
    v_and_b32_sdwa v115, v115, s38 dst_sel:DWORD dst_unused:UNUSED_PAD src0_sel:WORD_1 src1_sel:DWORD
    v_lshl_or_b32 v115, v112, 7, v115
    v_bitop3_b32 v92, v92, v124, v115 bitop3:0xea
    ds_add_u32 v92, v3 offset:16
    v_and_b32 v116, -16, v93
    v_mul_hi_u32_u24 v116, 42950, v116
    v_mul_u32_u24 v117, 100000, v116
    v_sub_u32 v118, v19, v117
    v_sub_u32 v93, v93, v117
    v_cmp_gt_u32 s[42:43], s5, v118
    v_ashrrev_i32 v119, 31, v118
    v_add_u32 v118, 800000, v118
    v_and_b32 v119, 100000, v119
    v_add_u32 v119, v119, v19
    v_cndmask_b32 v119, v119, v118, s[42:43]
    v_lshlrev_b32 v117, 11, v93
    v_lshl_or_b32 v19, v93, 28, v19
    v_mad_u32_u24 v119, v119, s39, v126
    v_lshrrev_b32 v93, 2, v93
    v_bitop3_b32 v19, v117, v125, v19 bitop3:0xea
    v_and_b32_sdwa v119, v119, s38 dst_sel:DWORD dst_unused:UNUSED_PAD src0_sel:WORD_1 src1_sel:DWORD
    v_lshl_or_b32 v119, v116, 7, v119
    v_bitop3_b32 v93, v93, v124, v119 bitop3:0xea
    ds_add_u32 v93, v3 offset:16
    v_lshl_or_b32 v59, v91, 16, v90
    v_lshl_or_b32 v60, v93, 16, v92
    s_waitcnt vmcnt(0)
    buffer_load_dwordx4 v[98:101], v2, s[12:15], s36 offen nt
    s_add_u32 s36, s36, 4194304
    buffer_load_dwordx4 v[24:27], v2, s[8:11], s4 offen nt
    s_add_u32 s4, s4, 4194304
    v_and_b32 v104, -16, v94
    v_mul_hi_u32_u24 v104, 42950, v104
    v_mul_u32_u24 v105, 100000, v104
    v_sub_u32 v106, v20, v105
    v_sub_u32 v94, v94, v105
    v_cmp_gt_u32 s[42:43], s5, v106
    v_ashrrev_i32 v107, 31, v106
    v_add_u32 v106, 800000, v106
    v_and_b32 v107, 100000, v107
    v_add_u32 v107, v107, v20
    v_cndmask_b32 v107, v107, v106, s[42:43]
    v_lshlrev_b32 v105, 11, v94
    v_lshl_or_b32 v20, v94, 28, v20
    v_mad_u32_u24 v107, v107, s39, v126
    v_lshrrev_b32 v94, 2, v94
    v_bitop3_b32 v20, v105, v125, v20 bitop3:0xea
    v_and_b32_sdwa v107, v107, s38 dst_sel:DWORD dst_unused:UNUSED_PAD src0_sel:WORD_1 src1_sel:DWORD
    v_lshl_or_b32 v107, v104, 7, v107
    v_bitop3_b32 v94, v94, v124, v107 bitop3:0xea
    ds_add_u32 v94, v3 offset:16
    v_and_b32 v108, -16, v95
    v_mul_hi_u32_u24 v108, 42950, v108
    v_mul_u32_u24 v109, 100000, v108
    v_sub_u32 v110, v21, v109
    v_sub_u32 v95, v95, v109
    v_cmp_gt_u32 s[42:43], s5, v110
    v_ashrrev_i32 v111, 31, v110
    v_add_u32 v110, 800000, v110
    v_and_b32 v111, 100000, v111
    v_add_u32 v111, v111, v21
    v_cndmask_b32 v111, v111, v110, s[42:43]
    v_lshlrev_b32 v109, 11, v95
    v_lshl_or_b32 v21, v95, 28, v21
    v_mad_u32_u24 v111, v111, s39, v126
    v_lshrrev_b32 v95, 2, v95
    v_bitop3_b32 v21, v109, v125, v21 bitop3:0xea
    v_and_b32_sdwa v111, v111, s38 dst_sel:DWORD dst_unused:UNUSED_PAD src0_sel:WORD_1 src1_sel:DWORD
    v_lshl_or_b32 v111, v108, 7, v111
    v_bitop3_b32 v95, v95, v124, v111 bitop3:0xea
    ds_add_u32 v95, v3 offset:16
    v_and_b32 v112, -16, v96
    v_mul_hi_u32_u24 v112, 42950, v112
    v_mul_u32_u24 v113, 100000, v112
    v_sub_u32 v114, v22, v113
    v_sub_u32 v96, v96, v113
    v_cmp_gt_u32 s[42:43], s5, v114
    v_ashrrev_i32 v115, 31, v114
    v_add_u32 v114, 800000, v114
    v_and_b32 v115, 100000, v115
    v_add_u32 v115, v115, v22
    v_cndmask_b32 v115, v115, v114, s[42:43]
    v_lshlrev_b32 v113, 11, v96
    v_lshl_or_b32 v22, v96, 28, v22
    v_mad_u32_u24 v115, v115, s39, v126
    v_lshrrev_b32 v96, 2, v96
    v_bitop3_b32 v22, v113, v125, v22 bitop3:0xea
    v_and_b32_sdwa v115, v115, s38 dst_sel:DWORD dst_unused:UNUSED_PAD src0_sel:WORD_1 src1_sel:DWORD
    v_lshl_or_b32 v115, v112, 7, v115
    v_bitop3_b32 v96, v96, v124, v115 bitop3:0xea
    ds_add_u32 v96, v3 offset:16
    v_and_b32 v116, -16, v97
    v_mul_hi_u32_u24 v116, 42950, v116
    v_mul_u32_u24 v117, 100000, v116
    v_sub_u32 v118, v23, v117
    v_sub_u32 v97, v97, v117
    v_cmp_gt_u32 s[42:43], s5, v118
    v_ashrrev_i32 v119, 31, v118
    v_add_u32 v118, 800000, v118
    v_and_b32 v119, 100000, v119
    v_add_u32 v119, v119, v23
    v_cndmask_b32 v119, v119, v118, s[42:43]
    v_lshlrev_b32 v117, 11, v97
    v_lshl_or_b32 v23, v97, 28, v23
    v_mad_u32_u24 v119, v119, s39, v126
    v_lshrrev_b32 v97, 2, v97
    v_bitop3_b32 v23, v117, v125, v23 bitop3:0xea
    v_and_b32_sdwa v119, v119, s38 dst_sel:DWORD dst_unused:UNUSED_PAD src0_sel:WORD_1 src1_sel:DWORD
    v_lshl_or_b32 v119, v116, 7, v119
    v_bitop3_b32 v97, v97, v124, v119 bitop3:0xea
    ds_add_u32 v97, v3 offset:16
    v_lshl_or_b32 v61, v95, 16, v94
    v_lshl_or_b32 v62, v97, 16, v96
    s_waitcnt vmcnt(0)
    buffer_load_dwordx4 v[78:81], v2, s[12:15], s36 offen nt
    s_add_u32 s36, s36, 4194304
    buffer_load_dwordx4 v[28:31], v2, s[8:11], s4 offen nt
    s_add_u32 s4, s4, 4194304
    v_and_b32 v104, -16, v98
    v_mul_hi_u32_u24 v104, 42950, v104
    v_mul_u32_u24 v105, 100000, v104
    v_sub_u32 v106, v24, v105
    v_sub_u32 v98, v98, v105
    v_cmp_gt_u32 s[42:43], s5, v106
    v_ashrrev_i32 v107, 31, v106
    v_add_u32 v106, 800000, v106
    v_and_b32 v107, 100000, v107
    v_add_u32 v107, v107, v24
    v_cndmask_b32 v107, v107, v106, s[42:43]
    v_lshlrev_b32 v105, 11, v98
    v_lshl_or_b32 v24, v98, 28, v24
    v_mad_u32_u24 v107, v107, s39, v126
    v_lshrrev_b32 v98, 2, v98
    v_bitop3_b32 v24, v105, v125, v24 bitop3:0xea
    v_and_b32_sdwa v107, v107, s38 dst_sel:DWORD dst_unused:UNUSED_PAD src0_sel:WORD_1 src1_sel:DWORD
    v_lshl_or_b32 v107, v104, 7, v107
    v_bitop3_b32 v98, v98, v124, v107 bitop3:0xea
    ds_add_u32 v98, v3 offset:16
    v_and_b32 v108, -16, v99
    v_mul_hi_u32_u24 v108, 42950, v108
    v_mul_u32_u24 v109, 100000, v108
    v_sub_u32 v110, v25, v109
    v_sub_u32 v99, v99, v109
    v_cmp_gt_u32 s[42:43], s5, v110
    v_ashrrev_i32 v111, 31, v110
    v_add_u32 v110, 800000, v110
    v_and_b32 v111, 100000, v111
    v_add_u32 v111, v111, v25
    v_cndmask_b32 v111, v111, v110, s[42:43]
    v_lshlrev_b32 v109, 11, v99
    v_lshl_or_b32 v25, v99, 28, v25
    v_mad_u32_u24 v111, v111, s39, v126
    v_lshrrev_b32 v99, 2, v99
    v_bitop3_b32 v25, v109, v125, v25 bitop3:0xea
    v_and_b32_sdwa v111, v111, s38 dst_sel:DWORD dst_unused:UNUSED_PAD src0_sel:WORD_1 src1_sel:DWORD
    v_lshl_or_b32 v111, v108, 7, v111
    v_bitop3_b32 v99, v99, v124, v111 bitop3:0xea
    ds_add_u32 v99, v3 offset:16
    v_and_b32 v112, -16, v100
    v_mul_hi_u32_u24 v112, 42950, v112
    v_mul_u32_u24 v113, 100000, v112
    v_sub_u32 v114, v26, v113
    v_sub_u32 v100, v100, v113
    v_cmp_gt_u32 s[42:43], s5, v114
    v_ashrrev_i32 v115, 31, v114
    v_add_u32 v114, 800000, v114
    v_and_b32 v115, 100000, v115
    v_add_u32 v115, v115, v26
    v_cndmask_b32 v115, v115, v114, s[42:43]
    v_lshlrev_b32 v113, 11, v100
    v_lshl_or_b32 v26, v100, 28, v26
    v_mad_u32_u24 v115, v115, s39, v126
    v_lshrrev_b32 v100, 2, v100
    v_bitop3_b32 v26, v113, v125, v26 bitop3:0xea
    v_and_b32_sdwa v115, v115, s38 dst_sel:DWORD dst_unused:UNUSED_PAD src0_sel:WORD_1 src1_sel:DWORD
    v_lshl_or_b32 v115, v112, 7, v115
    v_bitop3_b32 v100, v100, v124, v115 bitop3:0xea
    ds_add_u32 v100, v3 offset:16
    v_and_b32 v116, -16, v101
    v_mul_hi_u32_u24 v116, 42950, v116
    v_mul_u32_u24 v117, 100000, v116
    v_sub_u32 v118, v27, v117
    v_sub_u32 v101, v101, v117
    v_cmp_gt_u32 s[42:43], s5, v118
    v_ashrrev_i32 v119, 31, v118
    v_add_u32 v118, 800000, v118
    v_and_b32 v119, 100000, v119
    v_add_u32 v119, v119, v27
    v_cndmask_b32 v119, v119, v118, s[42:43]
    v_lshlrev_b32 v117, 11, v101
    v_lshl_or_b32 v27, v101, 28, v27
    v_mad_u32_u24 v119, v119, s39, v126
    v_lshrrev_b32 v101, 2, v101
    v_bitop3_b32 v27, v117, v125, v27 bitop3:0xea
    v_and_b32_sdwa v119, v119, s38 dst_sel:DWORD dst_unused:UNUSED_PAD src0_sel:WORD_1 src1_sel:DWORD
    v_lshl_or_b32 v119, v116, 7, v119
    v_bitop3_b32 v101, v101, v124, v119 bitop3:0xea
    ds_add_u32 v101, v3 offset:16
    v_lshl_or_b32 v63, v99, 16, v98
    v_lshl_or_b32 v64, v101, 16, v100
    s_waitcnt vmcnt(0)
    buffer_load_dwordx4 v[82:85], v2, s[12:15], s36 offen nt
    s_add_u32 s36, s36, 4194304
    buffer_load_dwordx4 v[32:35], v2, s[8:11], s4 offen nt
    s_add_u32 s4, s4, 4194304
    v_and_b32 v104, -16, v78
    v_mul_hi_u32_u24 v104, 42950, v104
    v_mul_u32_u24 v105, 100000, v104
    v_sub_u32 v106, v28, v105
    v_sub_u32 v78, v78, v105
    v_cmp_gt_u32 s[42:43], s5, v106
    v_ashrrev_i32 v107, 31, v106
    v_add_u32 v106, 800000, v106
    v_and_b32 v107, 100000, v107
    v_add_u32 v107, v107, v28
    v_cndmask_b32 v107, v107, v106, s[42:43]
    v_lshlrev_b32 v105, 11, v78
    v_lshl_or_b32 v28, v78, 28, v28
    v_mad_u32_u24 v107, v107, s39, v126
    v_lshrrev_b32 v78, 2, v78
    v_bitop3_b32 v28, v105, v125, v28 bitop3:0xea
    v_and_b32_sdwa v107, v107, s38 dst_sel:DWORD dst_unused:UNUSED_PAD src0_sel:WORD_1 src1_sel:DWORD
    v_lshl_or_b32 v107, v104, 7, v107
    v_bitop3_b32 v78, v78, v124, v107 bitop3:0xea
    ds_add_u32 v78, v3 offset:16
    v_and_b32 v108, -16, v79
    v_mul_hi_u32_u24 v108, 42950, v108
    v_mul_u32_u24 v109, 100000, v108
    v_sub_u32 v110, v29, v109
    v_sub_u32 v79, v79, v109
    v_cmp_gt_u32 s[42:43], s5, v110
    v_ashrrev_i32 v111, 31, v110
    v_add_u32 v110, 800000, v110
    v_and_b32 v111, 100000, v111
    v_add_u32 v111, v111, v29
    v_cndmask_b32 v111, v111, v110, s[42:43]
    v_lshlrev_b32 v109, 11, v79
    v_lshl_or_b32 v29, v79, 28, v29
    v_mad_u32_u24 v111, v111, s39, v126
    v_lshrrev_b32 v79, 2, v79
    v_bitop3_b32 v29, v109, v125, v29 bitop3:0xea
    v_and_b32_sdwa v111, v111, s38 dst_sel:DWORD dst_unused:UNUSED_PAD src0_sel:WORD_1 src1_sel:DWORD
    v_lshl_or_b32 v111, v108, 7, v111
    v_bitop3_b32 v79, v79, v124, v111 bitop3:0xea
    ds_add_u32 v79, v3 offset:16
    v_and_b32 v112, -16, v80
    v_mul_hi_u32_u24 v112, 42950, v112
    v_mul_u32_u24 v113, 100000, v112
    v_sub_u32 v114, v30, v113
    v_sub_u32 v80, v80, v113
    v_cmp_gt_u32 s[42:43], s5, v114
    v_ashrrev_i32 v115, 31, v114
    v_add_u32 v114, 800000, v114
    v_and_b32 v115, 100000, v115
    v_add_u32 v115, v115, v30
    v_cndmask_b32 v115, v115, v114, s[42:43]
    v_lshlrev_b32 v113, 11, v80
    v_lshl_or_b32 v30, v80, 28, v30
    v_mad_u32_u24 v115, v115, s39, v126
    v_lshrrev_b32 v80, 2, v80
    v_bitop3_b32 v30, v113, v125, v30 bitop3:0xea
    v_and_b32_sdwa v115, v115, s38 dst_sel:DWORD dst_unused:UNUSED_PAD src0_sel:WORD_1 src1_sel:DWORD
    v_lshl_or_b32 v115, v112, 7, v115
    v_bitop3_b32 v80, v80, v124, v115 bitop3:0xea
    ds_add_u32 v80, v3 offset:16
    v_and_b32 v116, -16, v81
    v_mul_hi_u32_u24 v116, 42950, v116
    v_mul_u32_u24 v117, 100000, v116
    v_sub_u32 v118, v31, v117
    v_sub_u32 v81, v81, v117
    v_cmp_gt_u32 s[42:43], s5, v118
    v_ashrrev_i32 v119, 31, v118
    v_add_u32 v118, 800000, v118
    v_and_b32 v119, 100000, v119
    v_add_u32 v119, v119, v31
    v_cndmask_b32 v119, v119, v118, s[42:43]
    v_lshlrev_b32 v117, 11, v81
    v_lshl_or_b32 v31, v81, 28, v31
    v_mad_u32_u24 v119, v119, s39, v126
    v_lshrrev_b32 v81, 2, v81
    v_bitop3_b32 v31, v117, v125, v31 bitop3:0xea
    v_and_b32_sdwa v119, v119, s38 dst_sel:DWORD dst_unused:UNUSED_PAD src0_sel:WORD_1 src1_sel:DWORD
    v_lshl_or_b32 v119, v116, 7, v119
    v_bitop3_b32 v81, v81, v124, v119 bitop3:0xea
    ds_add_u32 v81, v3 offset:16
    v_lshl_or_b32 v65, v79, 16, v78
    v_lshl_or_b32 v66, v81, 16, v80
    s_waitcnt vmcnt(0)
    buffer_load_dwordx4 v[86:89], v2, s[12:15], s36 offen nt
    s_add_u32 s36, s36, 4194304
    buffer_load_dwordx4 v[36:39], v2, s[8:11], s4 offen nt
    s_add_u32 s4, s4, 4194304
    v_and_b32 v104, -16, v82
    v_mul_hi_u32_u24 v104, 42950, v104
    v_mul_u32_u24 v105, 100000, v104
    v_sub_u32 v106, v32, v105
    v_sub_u32 v82, v82, v105
    v_cmp_gt_u32 s[42:43], s5, v106
    v_ashrrev_i32 v107, 31, v106
    v_add_u32 v106, 800000, v106
    v_and_b32 v107, 100000, v107
    v_add_u32 v107, v107, v32
    v_cndmask_b32 v107, v107, v106, s[42:43]
    v_lshlrev_b32 v105, 11, v82
    v_lshl_or_b32 v32, v82, 28, v32
    v_mad_u32_u24 v107, v107, s39, v126
    v_lshrrev_b32 v82, 2, v82
    v_bitop3_b32 v32, v105, v125, v32 bitop3:0xea
    v_and_b32_sdwa v107, v107, s38 dst_sel:DWORD dst_unused:UNUSED_PAD src0_sel:WORD_1 src1_sel:DWORD
    v_lshl_or_b32 v107, v104, 7, v107
    v_bitop3_b32 v82, v82, v124, v107 bitop3:0xea
    ds_add_u32 v82, v3 offset:16
    v_and_b32 v108, -16, v83
    v_mul_hi_u32_u24 v108, 42950, v108
    v_mul_u32_u24 v109, 100000, v108
    v_sub_u32 v110, v33, v109
    v_sub_u32 v83, v83, v109
    v_cmp_gt_u32 s[42:43], s5, v110
    v_ashrrev_i32 v111, 31, v110
    v_add_u32 v110, 800000, v110
    v_and_b32 v111, 100000, v111
    v_add_u32 v111, v111, v33
    v_cndmask_b32 v111, v111, v110, s[42:43]
    v_lshlrev_b32 v109, 11, v83
    v_lshl_or_b32 v33, v83, 28, v33
    v_mad_u32_u24 v111, v111, s39, v126
    v_lshrrev_b32 v83, 2, v83
    v_bitop3_b32 v33, v109, v125, v33 bitop3:0xea
    v_and_b32_sdwa v111, v111, s38 dst_sel:DWORD dst_unused:UNUSED_PAD src0_sel:WORD_1 src1_sel:DWORD
    v_lshl_or_b32 v111, v108, 7, v111
    v_bitop3_b32 v83, v83, v124, v111 bitop3:0xea
    ds_add_u32 v83, v3 offset:16
    v_and_b32 v112, -16, v84
    v_mul_hi_u32_u24 v112, 42950, v112
    v_mul_u32_u24 v113, 100000, v112
    v_sub_u32 v114, v34, v113
    v_sub_u32 v84, v84, v113
    v_cmp_gt_u32 s[42:43], s5, v114
    v_ashrrev_i32 v115, 31, v114
    v_add_u32 v114, 800000, v114
    v_and_b32 v115, 100000, v115
    v_add_u32 v115, v115, v34
    v_cndmask_b32 v115, v115, v114, s[42:43]
    v_lshlrev_b32 v113, 11, v84
    v_lshl_or_b32 v34, v84, 28, v34
    v_mad_u32_u24 v115, v115, s39, v126
    v_lshrrev_b32 v84, 2, v84
    v_bitop3_b32 v34, v113, v125, v34 bitop3:0xea
    v_and_b32_sdwa v115, v115, s38 dst_sel:DWORD dst_unused:UNUSED_PAD src0_sel:WORD_1 src1_sel:DWORD
    v_lshl_or_b32 v115, v112, 7, v115
    v_bitop3_b32 v84, v84, v124, v115 bitop3:0xea
    ds_add_u32 v84, v3 offset:16
    v_and_b32 v116, -16, v85
    v_mul_hi_u32_u24 v116, 42950, v116
    v_mul_u32_u24 v117, 100000, v116
    v_sub_u32 v118, v35, v117
    v_sub_u32 v85, v85, v117
    v_cmp_gt_u32 s[42:43], s5, v118
    v_ashrrev_i32 v119, 31, v118
    v_add_u32 v118, 800000, v118
    v_and_b32 v119, 100000, v119
    v_add_u32 v119, v119, v35
    v_cndmask_b32 v119, v119, v118, s[42:43]
    v_lshlrev_b32 v117, 11, v85
    v_lshl_or_b32 v35, v85, 28, v35
    v_mad_u32_u24 v119, v119, s39, v126
    v_lshrrev_b32 v85, 2, v85
    v_bitop3_b32 v35, v117, v125, v35 bitop3:0xea
    v_and_b32_sdwa v119, v119, s38 dst_sel:DWORD dst_unused:UNUSED_PAD src0_sel:WORD_1 src1_sel:DWORD
    v_lshl_or_b32 v119, v116, 7, v119
    v_bitop3_b32 v85, v85, v124, v119 bitop3:0xea
    ds_add_u32 v85, v3 offset:16
    v_lshl_or_b32 v67, v83, 16, v82
    v_lshl_or_b32 v68, v85, 16, v84
    s_waitcnt vmcnt(0)
    buffer_load_dwordx4 v[90:93], v2, s[12:15], s36 offen nt
    s_add_u32 s36, s36, 4194304
    buffer_load_dwordx4 v[40:43], v2, s[8:11], s4 offen nt
    s_add_u32 s4, s4, 4194304
    v_and_b32 v104, -16, v86
    v_mul_hi_u32_u24 v104, 42950, v104
    v_mul_u32_u24 v105, 100000, v104
    v_sub_u32 v106, v36, v105
    v_sub_u32 v86, v86, v105
    v_cmp_gt_u32 s[42:43], s5, v106
    v_ashrrev_i32 v107, 31, v106
    v_add_u32 v106, 800000, v106
    v_and_b32 v107, 100000, v107
    v_add_u32 v107, v107, v36
    v_cndmask_b32 v107, v107, v106, s[42:43]
    v_lshlrev_b32 v105, 11, v86
    v_lshl_or_b32 v36, v86, 28, v36
    v_mad_u32_u24 v107, v107, s39, v126
    v_lshrrev_b32 v86, 2, v86
    v_bitop3_b32 v36, v105, v125, v36 bitop3:0xea
    v_and_b32_sdwa v107, v107, s38 dst_sel:DWORD dst_unused:UNUSED_PAD src0_sel:WORD_1 src1_sel:DWORD
    v_lshl_or_b32 v107, v104, 7, v107
    v_bitop3_b32 v86, v86, v124, v107 bitop3:0xea
    ds_add_u32 v86, v3 offset:16
    v_and_b32 v108, -16, v87
    v_mul_hi_u32_u24 v108, 42950, v108
    v_mul_u32_u24 v109, 100000, v108
    v_sub_u32 v110, v37, v109
    v_sub_u32 v87, v87, v109
    v_cmp_gt_u32 s[42:43], s5, v110
    v_ashrrev_i32 v111, 31, v110
    v_add_u32 v110, 800000, v110
    v_and_b32 v111, 100000, v111
    v_add_u32 v111, v111, v37
    v_cndmask_b32 v111, v111, v110, s[42:43]
    v_lshlrev_b32 v109, 11, v87
    v_lshl_or_b32 v37, v87, 28, v37
    v_mad_u32_u24 v111, v111, s39, v126
    v_lshrrev_b32 v87, 2, v87
    v_bitop3_b32 v37, v109, v125, v37 bitop3:0xea
    v_and_b32_sdwa v111, v111, s38 dst_sel:DWORD dst_unused:UNUSED_PAD src0_sel:WORD_1 src1_sel:DWORD
    v_lshl_or_b32 v111, v108, 7, v111
    v_bitop3_b32 v87, v87, v124, v111 bitop3:0xea
    ds_add_u32 v87, v3 offset:16
    v_and_b32 v112, -16, v88
    v_mul_hi_u32_u24 v112, 42950, v112
    v_mul_u32_u24 v113, 100000, v112
    v_sub_u32 v114, v38, v113
    v_sub_u32 v88, v88, v113
    v_cmp_gt_u32 s[42:43], s5, v114
    v_ashrrev_i32 v115, 31, v114
    v_add_u32 v114, 800000, v114
    v_and_b32 v115, 100000, v115
    v_add_u32 v115, v115, v38
    v_cndmask_b32 v115, v115, v114, s[42:43]
    v_lshlrev_b32 v113, 11, v88
    v_lshl_or_b32 v38, v88, 28, v38
    v_mad_u32_u24 v115, v115, s39, v126
    v_lshrrev_b32 v88, 2, v88
    v_bitop3_b32 v38, v113, v125, v38 bitop3:0xea
    v_and_b32_sdwa v115, v115, s38 dst_sel:DWORD dst_unused:UNUSED_PAD src0_sel:WORD_1 src1_sel:DWORD
    v_lshl_or_b32 v115, v112, 7, v115
    v_bitop3_b32 v88, v88, v124, v115 bitop3:0xea
    ds_add_u32 v88, v3 offset:16
    v_and_b32 v116, -16, v89
    v_mul_hi_u32_u24 v116, 42950, v116
    v_mul_u32_u24 v117, 100000, v116
    v_sub_u32 v118, v39, v117
    v_sub_u32 v89, v89, v117
    v_cmp_gt_u32 s[42:43], s5, v118
    v_ashrrev_i32 v119, 31, v118
    v_add_u32 v118, 800000, v118
    v_and_b32 v119, 100000, v119
    v_add_u32 v119, v119, v39
    v_cndmask_b32 v119, v119, v118, s[42:43]
    v_lshlrev_b32 v117, 11, v89
    v_lshl_or_b32 v39, v89, 28, v39
    v_mad_u32_u24 v119, v119, s39, v126
    v_lshrrev_b32 v89, 2, v89
    v_bitop3_b32 v39, v117, v125, v39 bitop3:0xea
    v_and_b32_sdwa v119, v119, s38 dst_sel:DWORD dst_unused:UNUSED_PAD src0_sel:WORD_1 src1_sel:DWORD
    v_lshl_or_b32 v119, v116, 7, v119
    v_bitop3_b32 v89, v89, v124, v119 bitop3:0xea
    ds_add_u32 v89, v3 offset:16
    v_lshl_or_b32 v69, v87, 16, v86
    v_lshl_or_b32 v70, v89, 16, v88
    s_waitcnt vmcnt(0)
    buffer_load_dwordx4 v[94:97], v2, s[12:15], s36 offen nt
    s_add_u32 s36, s36, 4194304
    buffer_load_dwordx4 v[44:47], v2, s[8:11], s4 offen nt
    s_add_u32 s4, s4, 4194304
    v_and_b32 v104, -16, v90
    v_mul_hi_u32_u24 v104, 42950, v104
    v_mul_u32_u24 v105, 100000, v104
    v_sub_u32 v106, v40, v105
    v_sub_u32 v90, v90, v105
    v_cmp_gt_u32 s[42:43], s5, v106
    v_ashrrev_i32 v107, 31, v106
    v_add_u32 v106, 800000, v106
    v_and_b32 v107, 100000, v107
    v_add_u32 v107, v107, v40
    v_cndmask_b32 v107, v107, v106, s[42:43]
    v_lshlrev_b32 v105, 11, v90
    v_lshl_or_b32 v40, v90, 28, v40
    v_mad_u32_u24 v107, v107, s39, v126
    v_lshrrev_b32 v90, 2, v90
    v_bitop3_b32 v40, v105, v125, v40 bitop3:0xea
    v_and_b32_sdwa v107, v107, s38 dst_sel:DWORD dst_unused:UNUSED_PAD src0_sel:WORD_1 src1_sel:DWORD
    v_lshl_or_b32 v107, v104, 7, v107
    v_bitop3_b32 v90, v90, v124, v107 bitop3:0xea
    ds_add_u32 v90, v3 offset:16
    v_and_b32 v108, -16, v91
    v_mul_hi_u32_u24 v108, 42950, v108
    v_mul_u32_u24 v109, 100000, v108
    v_sub_u32 v110, v41, v109
    v_sub_u32 v91, v91, v109
    v_cmp_gt_u32 s[42:43], s5, v110
    v_ashrrev_i32 v111, 31, v110
    v_add_u32 v110, 800000, v110
    v_and_b32 v111, 100000, v111
    v_add_u32 v111, v111, v41
    v_cndmask_b32 v111, v111, v110, s[42:43]
    v_lshlrev_b32 v109, 11, v91
    v_lshl_or_b32 v41, v91, 28, v41
    v_mad_u32_u24 v111, v111, s39, v126
    v_lshrrev_b32 v91, 2, v91
    v_bitop3_b32 v41, v109, v125, v41 bitop3:0xea
    v_and_b32_sdwa v111, v111, s38 dst_sel:DWORD dst_unused:UNUSED_PAD src0_sel:WORD_1 src1_sel:DWORD
    v_lshl_or_b32 v111, v108, 7, v111
    v_bitop3_b32 v91, v91, v124, v111 bitop3:0xea
    ds_add_u32 v91, v3 offset:16
    v_and_b32 v112, -16, v92
    v_mul_hi_u32_u24 v112, 42950, v112
    v_mul_u32_u24 v113, 100000, v112
    v_sub_u32 v114, v42, v113
    v_sub_u32 v92, v92, v113
    v_cmp_gt_u32 s[42:43], s5, v114
    v_ashrrev_i32 v115, 31, v114
    v_add_u32 v114, 800000, v114
    v_and_b32 v115, 100000, v115
    v_add_u32 v115, v115, v42
    v_cndmask_b32 v115, v115, v114, s[42:43]
    v_lshlrev_b32 v113, 11, v92
    v_lshl_or_b32 v42, v92, 28, v42
    v_mad_u32_u24 v115, v115, s39, v126
    v_lshrrev_b32 v92, 2, v92
    v_bitop3_b32 v42, v113, v125, v42 bitop3:0xea
    v_and_b32_sdwa v115, v115, s38 dst_sel:DWORD dst_unused:UNUSED_PAD src0_sel:WORD_1 src1_sel:DWORD
    v_lshl_or_b32 v115, v112, 7, v115
    v_bitop3_b32 v92, v92, v124, v115 bitop3:0xea
    ds_add_u32 v92, v3 offset:16
    v_and_b32 v116, -16, v93
    v_mul_hi_u32_u24 v116, 42950, v116
    v_mul_u32_u24 v117, 100000, v116
    v_sub_u32 v118, v43, v117
    v_sub_u32 v93, v93, v117
    v_cmp_gt_u32 s[42:43], s5, v118
    v_ashrrev_i32 v119, 31, v118
    v_add_u32 v118, 800000, v118
    v_and_b32 v119, 100000, v119
    v_add_u32 v119, v119, v43
    v_cndmask_b32 v119, v119, v118, s[42:43]
    v_lshlrev_b32 v117, 11, v93
    v_lshl_or_b32 v43, v93, 28, v43
    v_mad_u32_u24 v119, v119, s39, v126
    v_lshrrev_b32 v93, 2, v93
    v_bitop3_b32 v43, v117, v125, v43 bitop3:0xea
    v_and_b32_sdwa v119, v119, s38 dst_sel:DWORD dst_unused:UNUSED_PAD src0_sel:WORD_1 src1_sel:DWORD
    v_lshl_or_b32 v119, v116, 7, v119
    v_bitop3_b32 v93, v93, v124, v119 bitop3:0xea
    ds_add_u32 v93, v3 offset:16
    v_lshl_or_b32 v71, v91, 16, v90
    v_lshl_or_b32 v72, v93, 16, v92
    s_waitcnt vmcnt(0)
    buffer_load_dwordx4 v[98:101], v2, s[12:15], s36 offen nt
    s_add_u32 s36, s36, 4194304
    buffer_load_dwordx4 v[48:51], v2, s[8:11], s4 offen nt
    s_add_u32 s4, s4, 4194304
    v_and_b32 v104, -16, v94
    v_mul_hi_u32_u24 v104, 42950, v104
    v_mul_u32_u24 v105, 100000, v104
    v_sub_u32 v106, v44, v105
    v_sub_u32 v94, v94, v105
    v_cmp_gt_u32 s[42:43], s5, v106
    v_ashrrev_i32 v107, 31, v106
    v_add_u32 v106, 800000, v106
    v_and_b32 v107, 100000, v107
    v_add_u32 v107, v107, v44
    v_cndmask_b32 v107, v107, v106, s[42:43]
    v_lshlrev_b32 v105, 11, v94
    v_lshl_or_b32 v44, v94, 28, v44
    v_mad_u32_u24 v107, v107, s39, v126
    v_lshrrev_b32 v94, 2, v94
    v_bitop3_b32 v44, v105, v125, v44 bitop3:0xea
    v_and_b32_sdwa v107, v107, s38 dst_sel:DWORD dst_unused:UNUSED_PAD src0_sel:WORD_1 src1_sel:DWORD
    v_lshl_or_b32 v107, v104, 7, v107
    v_bitop3_b32 v94, v94, v124, v107 bitop3:0xea
    ds_add_u32 v94, v3 offset:16
    v_and_b32 v108, -16, v95
    v_mul_hi_u32_u24 v108, 42950, v108
    v_mul_u32_u24 v109, 100000, v108
    v_sub_u32 v110, v45, v109
    v_sub_u32 v95, v95, v109
    v_cmp_gt_u32 s[42:43], s5, v110
    v_ashrrev_i32 v111, 31, v110
    v_add_u32 v110, 800000, v110
    v_and_b32 v111, 100000, v111
    v_add_u32 v111, v111, v45
    v_cndmask_b32 v111, v111, v110, s[42:43]
    v_lshlrev_b32 v109, 11, v95
    v_lshl_or_b32 v45, v95, 28, v45
    v_mad_u32_u24 v111, v111, s39, v126
    v_lshrrev_b32 v95, 2, v95
    v_bitop3_b32 v45, v109, v125, v45 bitop3:0xea
    v_and_b32_sdwa v111, v111, s38 dst_sel:DWORD dst_unused:UNUSED_PAD src0_sel:WORD_1 src1_sel:DWORD
    v_lshl_or_b32 v111, v108, 7, v111
    v_bitop3_b32 v95, v95, v124, v111 bitop3:0xea
    ds_add_u32 v95, v3 offset:16
    v_and_b32 v112, -16, v96
    v_mul_hi_u32_u24 v112, 42950, v112
    v_mul_u32_u24 v113, 100000, v112
    v_sub_u32 v114, v46, v113
    v_sub_u32 v96, v96, v113
    v_cmp_gt_u32 s[42:43], s5, v114
    v_ashrrev_i32 v115, 31, v114
    v_add_u32 v114, 800000, v114
    v_and_b32 v115, 100000, v115
    v_add_u32 v115, v115, v46
    v_cndmask_b32 v115, v115, v114, s[42:43]
    v_lshlrev_b32 v113, 11, v96
    v_lshl_or_b32 v46, v96, 28, v46
    v_mad_u32_u24 v115, v115, s39, v126
    v_lshrrev_b32 v96, 2, v96
    v_bitop3_b32 v46, v113, v125, v46 bitop3:0xea
    v_and_b32_sdwa v115, v115, s38 dst_sel:DWORD dst_unused:UNUSED_PAD src0_sel:WORD_1 src1_sel:DWORD
    v_lshl_or_b32 v115, v112, 7, v115
    v_bitop3_b32 v96, v96, v124, v115 bitop3:0xea
    ds_add_u32 v96, v3 offset:16
    v_and_b32 v116, -16, v97
    v_mul_hi_u32_u24 v116, 42950, v116
    v_mul_u32_u24 v117, 100000, v116
    v_sub_u32 v118, v47, v117
    v_sub_u32 v97, v97, v117
    v_cmp_gt_u32 s[42:43], s5, v118
    v_ashrrev_i32 v119, 31, v118
    v_add_u32 v118, 800000, v118
    v_and_b32 v119, 100000, v119
    v_add_u32 v119, v119, v47
    v_cndmask_b32 v119, v119, v118, s[42:43]
    v_lshlrev_b32 v117, 11, v97
    v_lshl_or_b32 v47, v97, 28, v47
    v_mad_u32_u24 v119, v119, s39, v126
    v_lshrrev_b32 v97, 2, v97
    v_bitop3_b32 v47, v117, v125, v47 bitop3:0xea
    v_and_b32_sdwa v119, v119, s38 dst_sel:DWORD dst_unused:UNUSED_PAD src0_sel:WORD_1 src1_sel:DWORD
    v_lshl_or_b32 v119, v116, 7, v119
    v_bitop3_b32 v97, v97, v124, v119 bitop3:0xea
    ds_add_u32 v97, v3 offset:16
    v_lshl_or_b32 v73, v95, 16, v94
    v_lshl_or_b32 v74, v97, 16, v96
    s_waitcnt vmcnt(0)
    v_and_b32 v104, -16, v98
    v_mul_hi_u32_u24 v104, 42950, v104
    v_mul_u32_u24 v105, 100000, v104
    v_sub_u32 v106, v48, v105
    v_sub_u32 v98, v98, v105
    v_cmp_gt_u32 s[42:43], s5, v106
    v_ashrrev_i32 v107, 31, v106
    v_add_u32 v106, 800000, v106
    v_and_b32 v107, 100000, v107
    v_add_u32 v107, v107, v48
    v_cndmask_b32 v107, v107, v106, s[42:43]
    v_lshlrev_b32 v105, 11, v98
    v_lshl_or_b32 v48, v98, 28, v48
    v_mad_u32_u24 v107, v107, s39, v126
    v_lshrrev_b32 v98, 2, v98
    v_bitop3_b32 v48, v105, v125, v48 bitop3:0xea
    v_and_b32_sdwa v107, v107, s38 dst_sel:DWORD dst_unused:UNUSED_PAD src0_sel:WORD_1 src1_sel:DWORD
    v_lshl_or_b32 v107, v104, 7, v107
    v_bitop3_b32 v98, v98, v124, v107 bitop3:0xea
    ds_add_u32 v98, v3 offset:16
    v_and_b32 v108, -16, v99
    v_mul_hi_u32_u24 v108, 42950, v108
    v_mul_u32_u24 v109, 100000, v108
    v_sub_u32 v110, v49, v109
    v_sub_u32 v99, v99, v109
    v_cmp_gt_u32 s[42:43], s5, v110
    v_ashrrev_i32 v111, 31, v110
    v_add_u32 v110, 800000, v110
    v_and_b32 v111, 100000, v111
    v_add_u32 v111, v111, v49
    v_cndmask_b32 v111, v111, v110, s[42:43]
    v_lshlrev_b32 v109, 11, v99
    v_lshl_or_b32 v49, v99, 28, v49
    v_mad_u32_u24 v111, v111, s39, v126
    v_lshrrev_b32 v99, 2, v99
    v_bitop3_b32 v49, v109, v125, v49 bitop3:0xea
    v_and_b32_sdwa v111, v111, s38 dst_sel:DWORD dst_unused:UNUSED_PAD src0_sel:WORD_1 src1_sel:DWORD
    v_lshl_or_b32 v111, v108, 7, v111
    v_bitop3_b32 v99, v99, v124, v111 bitop3:0xea
    ds_add_u32 v99, v3 offset:16
    v_and_b32 v112, -16, v100
    v_mul_hi_u32_u24 v112, 42950, v112
    v_mul_u32_u24 v113, 100000, v112
    v_sub_u32 v114, v50, v113
    v_sub_u32 v100, v100, v113
    v_cmp_gt_u32 s[42:43], s5, v114
    v_ashrrev_i32 v115, 31, v114
    v_add_u32 v114, 800000, v114
    v_and_b32 v115, 100000, v115
    v_add_u32 v115, v115, v50
    v_cndmask_b32 v115, v115, v114, s[42:43]
    v_lshlrev_b32 v113, 11, v100
    v_lshl_or_b32 v50, v100, 28, v50
    v_mad_u32_u24 v115, v115, s39, v126
    v_lshrrev_b32 v100, 2, v100
    v_bitop3_b32 v50, v113, v125, v50 bitop3:0xea
    v_and_b32_sdwa v115, v115, s38 dst_sel:DWORD dst_unused:UNUSED_PAD src0_sel:WORD_1 src1_sel:DWORD
    v_lshl_or_b32 v115, v112, 7, v115
    v_bitop3_b32 v100, v100, v124, v115 bitop3:0xea
    ds_add_u32 v100, v3 offset:16
    v_and_b32 v116, -16, v101
    v_mul_hi_u32_u24 v116, 42950, v116
    v_mul_u32_u24 v117, 100000, v116
    v_sub_u32 v118, v51, v117
    v_sub_u32 v101, v101, v117
    v_cmp_gt_u32 s[42:43], s5, v118
    v_ashrrev_i32 v119, 31, v118
    v_add_u32 v118, 800000, v118
    v_and_b32 v119, 100000, v119
    v_add_u32 v119, v119, v51
    v_cndmask_b32 v119, v119, v118, s[42:43]
    v_lshlrev_b32 v117, 11, v101
    v_lshl_or_b32 v51, v101, 28, v51
    v_mad_u32_u24 v119, v119, s39, v126
    v_lshrrev_b32 v101, 2, v101
    v_bitop3_b32 v51, v117, v125, v51 bitop3:0xea
    v_and_b32_sdwa v119, v119, s38 dst_sel:DWORD dst_unused:UNUSED_PAD src0_sel:WORD_1 src1_sel:DWORD
    v_lshl_or_b32 v119, v116, 7, v119
    v_bitop3_b32 v101, v101, v124, v119 bitop3:0xea
    ds_add_u32 v101, v3 offset:16
    v_lshl_or_b32 v75, v99, 16, v98
    v_lshl_or_b32 v76, v101, 16, v100
    v_lshrrev_b32 v2, 1, v2
    s_waitcnt lgkmcnt(0)
    s_barrier
    s_cmp_ge_u32 s3, 11
    s_cbranch_scc1 P1_scan1
    ds_read_b128 v[104:107], v1 offset:16
    s_waitcnt lgkmcnt(0)
    v_add_u32 v105, v104, v105
    v_add_u32 v106, v105, v106
    v_add_u32 v107, v106, v107
    v_mov_b32 v108, v107
    s_nop 1
    v_add_u32_dpp v108, v108, v108 row_shr:1 row_mask:0xf bank_mask:0xf bound_ctrl:1
    s_nop 1
    v_add_u32_dpp v108, v108, v108 row_shr:2 row_mask:0xf bank_mask:0xf bound_ctrl:1
    s_nop 1
    v_add_u32_dpp v108, v108, v108 row_shr:4 row_mask:0xf bank_mask:0xf bound_ctrl:1
    s_nop 1
    v_add_u32_dpp v108, v108, v108 row_shr:8 row_mask:0xf bank_mask:0xf bound_ctrl:1
    s_nop 1
    v_add_u32_dpp v108, v108, v108 row_bcast:15 row_mask:0xa bank_mask:0xf
    s_nop 1
    v_add_u32_dpp v108, v108, v108 row_bcast:31 row_mask:0xc bank_mask:0xf
    s_nop 0
    v_readlane_b32 s40, v108, 63
    s_lshl_b32 s41, s3, 2
    v_mov_b32 v110, s41
    v_mov_b32 v111, s40
    ds_write_b32 v110, v111 offset:11280
    s_waitcnt lgkmcnt(0)
P1_scan1:
    s_barrier
    s_cmp_ge_u32 s3, 11
    s_cbranch_scc1 P1_scan2
    v_and_b32 v110, 63, v0
    v_lshlrev_b32 v111, 2, v110
    ds_read_b32 v112, v111 offset:11280
    v_cmp_gt_u32 s[42:43], s3, v110
    v_sub_u32 v108, v108, v107
    s_waitcnt lgkmcnt(0)
    v_cndmask_b32 v112, 0, v112, s[42:43]
    s_nop 1
    v_add_u32_dpp v112, v112, v112 row_shr:1 row_mask:0xf bank_mask:0xf bound_ctrl:1
    s_nop 1
    v_add_u32_dpp v112, v112, v112 row_shr:2 row_mask:0xf bank_mask:0xf bound_ctrl:1
    s_nop 1
    v_add_u32_dpp v112, v112, v112 row_shr:4 row_mask:0xf bank_mask:0xf bound_ctrl:1
    s_nop 1
    v_add_u32_dpp v112, v112, v112 row_shr:8 row_mask:0xf bank_mask:0xf bound_ctrl:1
    s_nop 0
    v_readlane_b32 s40, v112, 15
    s_nop 1
    v_add_u32 v116, s40, v108
    v_add_u32 v117, v116, v104
    v_add_u32 v118, v116, v105
    v_add_u32 v119, v116, v106
    ds_write_b128 v1, v[116:119] offset:16
    ds_write_b128 v1, v[116:119] offset:11344
    v_mov_b32 v104, 22608
    v_mov_b32 v105, 50000
    ds_write_b32 v104, v105
    s_waitcnt lgkmcnt(0)
P1_scan2:
    s_barrier
    s_cmp_ge_u32 s3, 11
    s_cbranch_scc1 P1_nodesc
    ds_read2_b32 v[104:105], v120 offset0:0 offset1:1
    ds_read2_b32 v[106:107], v121 offset0:0 offset1:1
    ds_read2_b32 v[108:109], v122 offset0:0 offset1:1
    ds_read2_b32 v[110:111], v123 offset0:0 offset1:1
    s_mul_i32 s40, s2, 11264
    v_mov_b32 v112, 4
    v_mov_b32 v113, 1
    s_mov_b64 exec, 1
    s_waitcnt lgkmcnt(0)
    ds_add_u32 v112, v113
    s_mov_b64 exec, -1
    v_lshl_or_b32 v116, v105, 16, v104
    v_lshl_or_b32 v117, v107, 16, v106
    v_lshl_or_b32 v118, v109, 16, v108
    v_lshl_or_b32 v119, v111, 16, v110
    buffer_store_dwordx4 v[116:119], v1, s[20:23], s40 offen sc1
P1_nodesc:
    s_mul_i32 s40, s3, 8448
    s_add_u32 s40, s40, 9216
    v_add_u32 v103, s40, v1
    s_mov_b32 s8, s48
    s_mov_b32 s9, s49
    s_mov_b32 s10, 25600000
    s_mov_b32 s11, 0x20000
    s_mul_i32 s41, s2, 384
    s_sub_u32 s41, s41, 0
    v_add_lshl_u32 v1, v0, s41, 7
    s_setprio 3
    s_cmp_ge_u32 s3, 12
    s_cbranch_scc1 P1_ang1
    buffer_load_dwordx2 v[78:79], v2, s[16:19], s37 offen nt
    s_add_u32 s37, s37, 2097152
    buffer_load_dwordx2 v[80:81], v2, s[16:19], s37 offen nt
    s_add_u32 s37, s37, 2097152
    buffer_load_dwordx2 v[82:83], v2, s[16:19], s37 offen nt
    s_add_u32 s37, s37, 2097152
    buffer_load_dwordx2 v[84:85], v2, s[16:19], s37 offen nt
    s_add_u32 s37, s37, 2097152
    buffer_load_dwordx2 v[86:87], v2, s[16:19], s37 offen nt
    s_add_u32 s37, s37, 2097152
    buffer_load_dwordx2 v[88:89], v2, s[16:19], s37 offen nt
    s_add_u32 s37, s37, 2097152
    buffer_load_dwordx2 v[90:91], v2, s[16:19], s37 offen nt
    s_add_u32 s37, s37, 2097152
    buffer_load_dwordx2 v[92:93], v2, s[16:19], s37 offen nt
    s_add_u32 s37, s37, 2097152
    buffer_load_dwordx2 v[94:95], v2, s[16:19], s37 offen nt
    s_add_u32 s37, s37, 2097152
    buffer_load_dwordx2 v[96:97], v2, s[16:19], s37 offen nt
    s_add_u32 s37, s37, 2097152
    buffer_load_dwordx2 v[98:99], v2, s[16:19], s37 offen nt
    s_add_u32 s37, s37, 2097152
    buffer_load_dwordx2 v[100:101], v2, s[16:19], s37 offen nt
    s_add_u32 s37, s37, 2097152
P1_ang1:
    v_and_b32 v104, 0xffff, v53
    ds_add_rtn_u32 v104, v104, v3 offset:16
    v_lshrrev_b32 v105, 16, v53
    ds_add_rtn_u32 v105, v105, v3 offset:16
    v_and_b32 v106, 0xffff, v54
    ds_add_rtn_u32 v106, v106, v3 offset:16
    v_lshrrev_b32 v107, 16, v54
    ds_add_rtn_u32 v107, v107, v3 offset:16
    v_and_b32 v108, 0xffff, v55
    ds_add_rtn_u32 v108, v108, v3 offset:16
    v_lshrrev_b32 v109, 16, v55
    ds_add_rtn_u32 v109, v109, v3 offset:16
    v_and_b32 v110, 0xffff, v56
    ds_add_rtn_u32 v110, v110, v3 offset:16
    v_lshrrev_b32 v111, 16, v56
    ds_add_rtn_u32 v111, v111, v3 offset:16
    s_waitcnt lgkmcnt(4)
    v_lshl_or_b32 v53, v105, 16, v104
    v_lshl_or_b32 v54, v107, 16, v106
    v_and_b32 v104, 0xffff, v57
    ds_add_rtn_u32 v104, v104, v3 offset:16
    v_lshrrev_b32 v105, 16, v57
    ds_add_rtn_u32 v105, v105, v3 offset:16
    v_and_b32 v106, 0xffff, v58
    ds_add_rtn_u32 v106, v106, v3 offset:16
    v_lshrrev_b32 v107, 16, v58
    ds_add_rtn_u32 v107, v107, v3 offset:16
    s_waitcnt lgkmcnt(4)
    v_lshl_or_b32 v55, v109, 16, v108
    v_lshl_or_b32 v56, v111, 16, v110
    v_and_b32 v108, 0xffff, v59
    ds_add_rtn_u32 v108, v108, v3 offset:16
    v_lshrrev_b32 v109, 16, v59
    ds_add_rtn_u32 v109, v109, v3 offset:16
    v_and_b32 v110, 0xffff, v60
    ds_add_rtn_u32 v110, v110, v3 offset:16
    v_lshrrev_b32 v111, 16, v60
    ds_add_rtn_u32 v111, v111, v3 offset:16
    s_waitcnt lgkmcnt(4)
    v_lshl_or_b32 v57, v105, 16, v104
    v_lshl_or_b32 v58, v107, 16, v106
    v_and_b32 v104, 0xffff, v61
    ds_add_rtn_u32 v104, v104, v3 offset:16
    v_lshrrev_b32 v105, 16, v61
    ds_add_rtn_u32 v105, v105, v3 offset:16
    v_and_b32 v106, 0xffff, v62
    ds_add_rtn_u32 v106, v106, v3 offset:16
    v_lshrrev_b32 v107, 16, v62
    ds_add_rtn_u32 v107, v107, v3 offset:16
    s_waitcnt lgkmcnt(4)
    v_lshl_or_b32 v59, v109, 16, v108
    v_lshl_or_b32 v60, v111, 16, v110
    v_and_b32 v108, 0xffff, v63
    ds_add_rtn_u32 v108, v108, v3 offset:16
    v_lshrrev_b32 v109, 16, v63
    ds_add_rtn_u32 v109, v109, v3 offset:16
    v_and_b32 v110, 0xffff, v64
    ds_add_rtn_u32 v110, v110, v3 offset:16
    v_lshrrev_b32 v111, 16, v64
    ds_add_rtn_u32 v111, v111, v3 offset:16
    s_waitcnt lgkmcnt(4)
    v_lshl_or_b32 v61, v105, 16, v104
    v_lshl_or_b32 v62, v107, 16, v106
    v_and_b32 v104, 0xffff, v65
    ds_add_rtn_u32 v104, v104, v3 offset:16
    v_lshrrev_b32 v105, 16, v65
    ds_add_rtn_u32 v105, v105, v3 offset:16
    v_and_b32 v106, 0xffff, v66
    ds_add_rtn_u32 v106, v106, v3 offset:16
    v_lshrrev_b32 v107, 16, v66
    ds_add_rtn_u32 v107, v107, v3 offset:16
    s_waitcnt lgkmcnt(4)
    v_lshl_or_b32 v63, v109, 16, v108
    v_lshl_or_b32 v64, v111, 16, v110
    v_and_b32 v108, 0xffff, v67
    ds_add_rtn_u32 v108, v108, v3 offset:16
    v_lshrrev_b32 v109, 16, v67
    ds_add_rtn_u32 v109, v109, v3 offset:16
    v_and_b32 v110, 0xffff, v68
    ds_add_rtn_u32 v110, v110, v3 offset:16
    v_lshrrev_b32 v111, 16, v68
    ds_add_rtn_u32 v111, v111, v3 offset:16
    s_waitcnt lgkmcnt(4)
    v_lshl_or_b32 v65, v105, 16, v104
    v_lshl_or_b32 v66, v107, 16, v106
    v_and_b32 v104, 0xffff, v69
    ds_add_rtn_u32 v104, v104, v3 offset:16
    v_lshrrev_b32 v105, 16, v69
    ds_add_rtn_u32 v105, v105, v3 offset:16
    v_and_b32 v106, 0xffff, v70
    ds_add_rtn_u32 v106, v106, v3 offset:16
    v_lshrrev_b32 v107, 16, v70
    ds_add_rtn_u32 v107, v107, v3 offset:16
    s_waitcnt lgkmcnt(4)
    v_lshl_or_b32 v67, v109, 16, v108
    v_lshl_or_b32 v68, v111, 16, v110
    v_and_b32 v108, 0xffff, v71
    ds_add_rtn_u32 v108, v108, v3 offset:16
    v_lshrrev_b32 v109, 16, v71
    ds_add_rtn_u32 v109, v109, v3 offset:16
    v_and_b32 v110, 0xffff, v72
    ds_add_rtn_u32 v110, v110, v3 offset:16
    v_lshrrev_b32 v111, 16, v72
    ds_add_rtn_u32 v111, v111, v3 offset:16
    s_waitcnt lgkmcnt(4)
    v_lshl_or_b32 v69, v105, 16, v104
    v_lshl_or_b32 v70, v107, 16, v106
    v_and_b32 v104, 0xffff, v73
    ds_add_rtn_u32 v104, v104, v3 offset:16
    v_lshrrev_b32 v105, 16, v73
    ds_add_rtn_u32 v105, v105, v3 offset:16
    v_and_b32 v106, 0xffff, v74
    ds_add_rtn_u32 v106, v106, v3 offset:16
    v_lshrrev_b32 v107, 16, v74
    ds_add_rtn_u32 v107, v107, v3 offset:16
    s_waitcnt lgkmcnt(4)
    v_lshl_or_b32 v71, v109, 16, v108
    v_lshl_or_b32 v72, v111, 16, v110
    v_and_b32 v108, 0xffff, v75
    ds_add_rtn_u32 v108, v108, v3 offset:16
    v_lshrrev_b32 v109, 16, v75
    ds_add_rtn_u32 v109, v109, v3 offset:16
    v_and_b32 v110, 0xffff, v76
    ds_add_rtn_u32 v110, v110, v3 offset:16
    v_lshrrev_b32 v111, 16, v76
    ds_add_rtn_u32 v111, v111, v3 offset:16
    s_waitcnt lgkmcnt(4)
    v_lshl_or_b32 v73, v105, 16, v104
    v_lshl_or_b32 v74, v107, 16, v106
    ds_add_rtn_u32 v104, v77, v3 offset:16
    s_waitcnt lgkmcnt(1)
    v_lshl_or_b32 v75, v109, 16, v108
    v_lshl_or_b32 v76, v111, 16, v110
    s_waitcnt lgkmcnt(0)
    v_mov_b32 v112, 0xffff
    v_cndmask_b32 v77, v112, v104, vcc
    s_cmp_lt_u32 s3, 12
    s_cbranch_scc1 P1_ang2
    buffer_load_dwordx2 v[78:79], v2, s[16:19], s37 offen nt
    s_add_u32 s37, s37, 2097152
    buffer_load_dwordx2 v[80:81], v2, s[16:19], s37 offen nt
    s_add_u32 s37, s37, 2097152
    buffer_load_dwordx2 v[82:83], v2, s[16:19], s37 offen nt
    s_add_u32 s37, s37, 2097152
    buffer_load_dwordx2 v[84:85], v2, s[16:19], s37 offen nt
    s_add_u32 s37, s37, 2097152
    buffer_load_dwordx2 v[86:87], v2, s[16:19], s37 offen nt
    s_add_u32 s37, s37, 2097152
    buffer_load_dwordx2 v[88:89], v2, s[16:19], s37 offen nt
    s_add_u32 s37, s37, 2097152
    buffer_load_dwordx2 v[90:91], v2, s[16:19], s37 offen nt
    s_add_u32 s37, s37, 2097152
    buffer_load_dwordx2 v[92:93], v2, s[16:19], s37 offen nt
    s_add_u32 s37, s37, 2097152
    buffer_load_dwordx2 v[94:95], v2, s[16:19], s37 offen nt
    s_add_u32 s37, s37, 2097152
    buffer_load_dwordx2 v[96:97], v2, s[16:19], s37 offen nt
    s_add_u32 s37, s37, 2097152
    buffer_load_dwordx2 v[98:99], v2, s[16:19], s37 offen nt
    s_add_u32 s37, s37, 2097152
    buffer_load_dwordx2 v[100:101], v2, s[16:19], s37 offen nt
    s_add_u32 s37, s37, 2097152
P1_ang2:
    s_lshl_b32 s35, s35, 16
    s_cmp_eq_u32 s35, 1.0
    s_cbranch_scc1 P1_f1
    s_waitcnt vmcnt(0)
    v_lshlrev_b32 v104, 16, v78
    v_and_b32 v105, 0xffff0000, v78
    v_mul_f32 v104, s35, v104
    v_mul_f32 v105, s35, v105
    v_cvt_pk_bf16_f32 v78, v104, v105
    v_lshlrev_b32 v104, 16, v79
    v_and_b32 v105, 0xffff0000, v79
    v_mul_f32 v104, s35, v104
    v_mul_f32 v105, s35, v105
    v_cvt_pk_bf16_f32 v79, v104, v105
    v_lshlrev_b32 v104, 16, v80
    v_and_b32 v105, 0xffff0000, v80
    v_mul_f32 v104, s35, v104
    v_mul_f32 v105, s35, v105
    v_cvt_pk_bf16_f32 v80, v104, v105
    v_lshlrev_b32 v104, 16, v81
    v_and_b32 v105, 0xffff0000, v81
    v_mul_f32 v104, s35, v104
    v_mul_f32 v105, s35, v105
    v_cvt_pk_bf16_f32 v81, v104, v105
    v_lshlrev_b32 v104, 16, v82
    v_and_b32 v105, 0xffff0000, v82
    v_mul_f32 v104, s35, v104
    v_mul_f32 v105, s35, v105
    v_cvt_pk_bf16_f32 v82, v104, v105
    v_lshlrev_b32 v104, 16, v83
    v_and_b32 v105, 0xffff0000, v83
    v_mul_f32 v104, s35, v104
    v_mul_f32 v105, s35, v105
    v_cvt_pk_bf16_f32 v83, v104, v105
    v_lshlrev_b32 v104, 16, v84
    v_and_b32 v105, 0xffff0000, v84
    v_mul_f32 v104, s35, v104
    v_mul_f32 v105, s35, v105
    v_cvt_pk_bf16_f32 v84, v104, v105
    v_lshlrev_b32 v104, 16, v85
    v_and_b32 v105, 0xffff0000, v85
    v_mul_f32 v104, s35, v104
    v_mul_f32 v105, s35, v105
    v_cvt_pk_bf16_f32 v85, v104, v105
    v_lshlrev_b32 v104, 16, v86
    v_and_b32 v105, 0xffff0000, v86
    v_mul_f32 v104, s35, v104
    v_mul_f32 v105, s35, v105
    v_cvt_pk_bf16_f32 v86, v104, v105
    v_lshlrev_b32 v104, 16, v87
    v_and_b32 v105, 0xffff0000, v87
    v_mul_f32 v104, s35, v104
    v_mul_f32 v105, s35, v105
    v_cvt_pk_bf16_f32 v87, v104, v105
    v_lshlrev_b32 v104, 16, v88
    v_and_b32 v105, 0xffff0000, v88
    v_mul_f32 v104, s35, v104
    v_mul_f32 v105, s35, v105
    v_cvt_pk_bf16_f32 v88, v104, v105
    v_lshlrev_b32 v104, 16, v89
    v_and_b32 v105, 0xffff0000, v89
    v_mul_f32 v104, s35, v104
    v_mul_f32 v105, s35, v105
    v_cvt_pk_bf16_f32 v89, v104, v105
    v_lshlrev_b32 v104, 16, v90
    v_and_b32 v105, 0xffff0000, v90
    v_mul_f32 v104, s35, v104
    v_mul_f32 v105, s35, v105
    v_cvt_pk_bf16_f32 v90, v104, v105
    v_lshlrev_b32 v104, 16, v91
    v_and_b32 v105, 0xffff0000, v91
    v_mul_f32 v104, s35, v104
    v_mul_f32 v105, s35, v105
    v_cvt_pk_bf16_f32 v91, v104, v105
    v_lshlrev_b32 v104, 16, v92
    v_and_b32 v105, 0xffff0000, v92
    v_mul_f32 v104, s35, v104
    v_mul_f32 v105, s35, v105
    v_cvt_pk_bf16_f32 v92, v104, v105
    v_lshlrev_b32 v104, 16, v93
    v_and_b32 v105, 0xffff0000, v93
    v_mul_f32 v104, s35, v104
    v_mul_f32 v105, s35, v105
    v_cvt_pk_bf16_f32 v93, v104, v105
    v_lshlrev_b32 v104, 16, v94
    v_and_b32 v105, 0xffff0000, v94
    v_mul_f32 v104, s35, v104
    v_mul_f32 v105, s35, v105
    v_cvt_pk_bf16_f32 v94, v104, v105
    v_lshlrev_b32 v104, 16, v95
    v_and_b32 v105, 0xffff0000, v95
    v_mul_f32 v104, s35, v104
    v_mul_f32 v105, s35, v105
    v_cvt_pk_bf16_f32 v95, v104, v105
    v_lshlrev_b32 v104, 16, v96
    v_and_b32 v105, 0xffff0000, v96
    v_mul_f32 v104, s35, v104
    v_mul_f32 v105, s35, v105
    v_cvt_pk_bf16_f32 v96, v104, v105
    v_lshlrev_b32 v104, 16, v97
    v_and_b32 v105, 0xffff0000, v97
    v_mul_f32 v104, s35, v104
    v_mul_f32 v105, s35, v105
    v_cvt_pk_bf16_f32 v97, v104, v105
    v_lshlrev_b32 v104, 16, v98
    v_and_b32 v105, 0xffff0000, v98
    v_mul_f32 v104, s35, v104
    v_mul_f32 v105, s35, v105
    v_cvt_pk_bf16_f32 v98, v104, v105
    v_lshlrev_b32 v104, 16, v99
    v_and_b32 v105, 0xffff0000, v99
    v_mul_f32 v104, s35, v104
    v_mul_f32 v105, s35, v105
    v_cvt_pk_bf16_f32 v99, v104, v105
    v_lshlrev_b32 v104, 16, v100
    v_and_b32 v105, 0xffff0000, v100
    v_mul_f32 v104, s35, v104
    v_mul_f32 v105, s35, v105
    v_cvt_pk_bf16_f32 v100, v104, v105
    v_lshlrev_b32 v104, 16, v101
    v_and_b32 v105, 0xffff0000, v101
    v_mul_f32 v104, s35, v104
    v_mul_f32 v105, s35, v105
    v_cvt_pk_bf16_f32 v101, v104, v105
    v_lshlrev_b32 v104, 16, v102
    v_and_b32 v105, 0xffff0000, v102
    v_mul_f32 v104, s35, v104
    v_mul_f32 v105, s35, v105
    v_cvt_pk_bf16_f32 v102, v104, v105
P1_f1:
    v_mov_b32 v104, 4
P2_lwq:
    ds_read_b32 v105, v104
    s_waitcnt lgkmcnt(0)
    v_readfirstlane_b32 s40, v105
    s_cmp_ge_u32 s40, 11
    s_cbranch_scc1 P2_lgq
    s_branch P2_lwq
P2_lgq:
    s_setprio 2
    s_waitcnt vmcnt(0)
    s_cmp_ge_u32 s3, 11
    s_cbranch_scc1 P1_noe
    s_waitcnt vmcnt(0)
    v_mov_b32 v2, 8
    v_mov_b32 v3, 1
    s_mov_b64 exec, 1
    ds_add_rtn_u32 v3, v2, v3
    s_mov_b64 exec, -1
    s_waitcnt lgkmcnt(0)
    v_readfirstlane_b32 s40, v3
    s_cmp_lg_u32 s40, 10
    s_cbranch_scc1 P1_noe
    v_mov_b32 v2, 0
    v_mov_b32 v3, 1
    s_mov_b64 exec, 1
    buffer_atomic_add v3, v2, s[24:27], 0 offen offset:96 sc0 sc1
    s_mov_b64 exec, -1
    s_mov_b32 s44, 1
P1_noe:
    v_lshlrev_b32 v104, 16, v78
    v_and_b32 v105, 0xffff0000, v78
    v_mul_f32 v104, 0.15915494, v104
    v_mul_f32 v105, 0.15915494, v105
    v_fract_f32 v104, v104
    v_fract_f32 v105, v105
    v_cos_f32 v104, v104
    v_cos_f32 v105, v105
    v_mad_u32_u16 v106, v53, 6, 0
    v_and_b32 v107, 2, v106
    v_sub_u32 v106, v106, v107
    v_sub_u32 v107, v106, v107
    ds_write_b32 v106, v4 offset:11344
    v_mad_u32_u16 v108, v53, 6, 0 op_sel:[1,0,0,0]
    v_and_b32 v109, 2, v108
    v_sub_u32 v108, v108, v109
    v_sub_u32 v109, v108, v109
    ds_write_b32 v108, v5 offset:11344
    v_cvt_pk_bf16_f32 v78, v104, v105
    ds_write_b16 v107, v78 offset:11352
    ds_write_b16_d16_hi v109, v78 offset:11352
    v_lshlrev_b32 v110, 16, v79
    v_and_b32 v111, 0xffff0000, v79
    v_mul_f32 v110, 0.15915494, v110
    v_mul_f32 v111, 0.15915494, v111
    v_fract_f32 v110, v110
    v_fract_f32 v111, v111
    v_cos_f32 v110, v110
    v_cos_f32 v111, v111
    v_mad_u32_u16 v112, v54, 6, 0
    v_and_b32 v113, 2, v112
    v_sub_u32 v112, v112, v113
    v_sub_u32 v113, v112, v113
    ds_write_b32 v112, v6 offset:11344
    v_mad_u32_u16 v114, v54, 6, 0 op_sel:[1,0,0,0]
    v_and_b32 v115, 2, v114
    v_sub_u32 v114, v114, v115
    v_sub_u32 v115, v114, v115
    ds_write_b32 v114, v7 offset:11344
    v_cvt_pk_bf16_f32 v79, v110, v111
    ds_write_b16 v113, v79 offset:11352
    ds_write_b16_d16_hi v115, v79 offset:11352
    v_lshlrev_b32 v104, 16, v80
    v_and_b32 v105, 0xffff0000, v80
    v_mul_f32 v104, 0.15915494, v104
    v_mul_f32 v105, 0.15915494, v105
    v_fract_f32 v104, v104
    v_fract_f32 v105, v105
    v_cos_f32 v104, v104
    v_cos_f32 v105, v105
    v_mad_u32_u16 v106, v55, 6, 0
    v_and_b32 v107, 2, v106
    v_sub_u32 v106, v106, v107
    v_sub_u32 v107, v106, v107
    ds_write_b32 v106, v8 offset:11344
    v_mad_u32_u16 v108, v55, 6, 0 op_sel:[1,0,0,0]
    v_and_b32 v109, 2, v108
    v_sub_u32 v108, v108, v109
    v_sub_u32 v109, v108, v109
    ds_write_b32 v108, v9 offset:11344
    v_cvt_pk_bf16_f32 v80, v104, v105
    ds_write_b16 v107, v80 offset:11352
    ds_write_b16_d16_hi v109, v80 offset:11352
    v_lshlrev_b32 v110, 16, v81
    v_and_b32 v111, 0xffff0000, v81
    v_mul_f32 v110, 0.15915494, v110
    v_mul_f32 v111, 0.15915494, v111
    v_fract_f32 v110, v110
    v_fract_f32 v111, v111
    v_cos_f32 v110, v110
    v_cos_f32 v111, v111
    v_mad_u32_u16 v112, v56, 6, 0
    v_and_b32 v113, 2, v112
    v_sub_u32 v112, v112, v113
    v_sub_u32 v113, v112, v113
    ds_write_b32 v112, v10 offset:11344
    v_mad_u32_u16 v114, v56, 6, 0 op_sel:[1,0,0,0]
    v_and_b32 v115, 2, v114
    v_sub_u32 v114, v114, v115
    v_sub_u32 v115, v114, v115
    ds_write_b32 v114, v11 offset:11344
    v_cvt_pk_bf16_f32 v81, v110, v111
    ds_write_b16 v113, v81 offset:11352
    ds_write_b16_d16_hi v115, v81 offset:11352
    v_lshlrev_b32 v104, 16, v82
    v_and_b32 v105, 0xffff0000, v82
    v_mul_f32 v104, 0.15915494, v104
    v_mul_f32 v105, 0.15915494, v105
    v_fract_f32 v104, v104
    v_fract_f32 v105, v105
    v_cos_f32 v104, v104
    v_cos_f32 v105, v105
    v_mad_u32_u16 v106, v57, 6, 0
    v_and_b32 v107, 2, v106
    v_sub_u32 v106, v106, v107
    v_sub_u32 v107, v106, v107
    ds_write_b32 v106, v12 offset:11344
    v_mad_u32_u16 v108, v57, 6, 0 op_sel:[1,0,0,0]
    v_and_b32 v109, 2, v108
    v_sub_u32 v108, v108, v109
    v_sub_u32 v109, v108, v109
    ds_write_b32 v108, v13 offset:11344
    v_cvt_pk_bf16_f32 v82, v104, v105
    ds_write_b16 v107, v82 offset:11352
    ds_write_b16_d16_hi v109, v82 offset:11352
    v_lshlrev_b32 v110, 16, v83
    v_and_b32 v111, 0xffff0000, v83
    v_mul_f32 v110, 0.15915494, v110
    v_mul_f32 v111, 0.15915494, v111
    v_fract_f32 v110, v110
    v_fract_f32 v111, v111
    v_cos_f32 v110, v110
    v_cos_f32 v111, v111
    v_mad_u32_u16 v112, v58, 6, 0
    v_and_b32 v113, 2, v112
    v_sub_u32 v112, v112, v113
    v_sub_u32 v113, v112, v113
    ds_write_b32 v112, v14 offset:11344
    v_mad_u32_u16 v114, v58, 6, 0 op_sel:[1,0,0,0]
    v_and_b32 v115, 2, v114
    v_sub_u32 v114, v114, v115
    v_sub_u32 v115, v114, v115
    ds_write_b32 v114, v15 offset:11344
    v_cvt_pk_bf16_f32 v83, v110, v111
    ds_write_b16 v113, v83 offset:11352
    ds_write_b16_d16_hi v115, v83 offset:11352
    v_lshlrev_b32 v104, 16, v84
    v_and_b32 v105, 0xffff0000, v84
    v_mul_f32 v104, 0.15915494, v104
    v_mul_f32 v105, 0.15915494, v105
    v_fract_f32 v104, v104
    v_fract_f32 v105, v105
    v_cos_f32 v104, v104
    v_cos_f32 v105, v105
    v_mad_u32_u16 v106, v59, 6, 0
    v_and_b32 v107, 2, v106
    v_sub_u32 v106, v106, v107
    v_sub_u32 v107, v106, v107
    ds_write_b32 v106, v16 offset:11344
    v_mad_u32_u16 v108, v59, 6, 0 op_sel:[1,0,0,0]
    v_and_b32 v109, 2, v108
    v_sub_u32 v108, v108, v109
    v_sub_u32 v109, v108, v109
    ds_write_b32 v108, v17 offset:11344
    v_cvt_pk_bf16_f32 v84, v104, v105
    ds_write_b16 v107, v84 offset:11352
    ds_write_b16_d16_hi v109, v84 offset:11352
    v_lshlrev_b32 v110, 16, v85
    v_and_b32 v111, 0xffff0000, v85
    v_mul_f32 v110, 0.15915494, v110
    v_mul_f32 v111, 0.15915494, v111
    v_fract_f32 v110, v110
    v_fract_f32 v111, v111
    v_cos_f32 v110, v110
    v_cos_f32 v111, v111
    v_mad_u32_u16 v112, v60, 6, 0
    v_and_b32 v113, 2, v112
    v_sub_u32 v112, v112, v113
    v_sub_u32 v113, v112, v113
    ds_write_b32 v112, v18 offset:11344
    v_mad_u32_u16 v114, v60, 6, 0 op_sel:[1,0,0,0]
    v_and_b32 v115, 2, v114
    v_sub_u32 v114, v114, v115
    v_sub_u32 v115, v114, v115
    ds_write_b32 v114, v19 offset:11344
    v_cvt_pk_bf16_f32 v85, v110, v111
    ds_write_b16 v113, v85 offset:11352
    ds_write_b16_d16_hi v115, v85 offset:11352
    v_lshlrev_b32 v104, 16, v86
    v_and_b32 v105, 0xffff0000, v86
    v_mul_f32 v104, 0.15915494, v104
    v_mul_f32 v105, 0.15915494, v105
    v_fract_f32 v104, v104
    v_fract_f32 v105, v105
    v_cos_f32 v104, v104
    v_cos_f32 v105, v105
    v_mad_u32_u16 v106, v61, 6, 0
    v_and_b32 v107, 2, v106
    v_sub_u32 v106, v106, v107
    v_sub_u32 v107, v106, v107
    ds_write_b32 v106, v20 offset:11344
    v_mad_u32_u16 v108, v61, 6, 0 op_sel:[1,0,0,0]
    v_and_b32 v109, 2, v108
    v_sub_u32 v108, v108, v109
    v_sub_u32 v109, v108, v109
    ds_write_b32 v108, v21 offset:11344
    v_cvt_pk_bf16_f32 v86, v104, v105
    ds_write_b16 v107, v86 offset:11352
    ds_write_b16_d16_hi v109, v86 offset:11352
    s_setprio 1
    v_lshlrev_b32 v110, 16, v87
    v_and_b32 v111, 0xffff0000, v87
    v_mul_f32 v110, 0.15915494, v110
    v_mul_f32 v111, 0.15915494, v111
    v_fract_f32 v110, v110
    v_fract_f32 v111, v111
    v_cos_f32 v110, v110
    v_cos_f32 v111, v111
    v_mad_u32_u16 v112, v62, 6, 0
    v_and_b32 v113, 2, v112
    v_sub_u32 v112, v112, v113
    v_sub_u32 v113, v112, v113
    ds_write_b32 v112, v22 offset:11344
    v_mad_u32_u16 v114, v62, 6, 0 op_sel:[1,0,0,0]
    v_and_b32 v115, 2, v114
    v_sub_u32 v114, v114, v115
    v_sub_u32 v115, v114, v115
    ds_write_b32 v114, v23 offset:11344
    v_cvt_pk_bf16_f32 v87, v110, v111
    ds_write_b16 v113, v87 offset:11352
    ds_write_b16_d16_hi v115, v87 offset:11352
    v_lshlrev_b32 v104, 16, v88
    v_and_b32 v105, 0xffff0000, v88
    v_mul_f32 v104, 0.15915494, v104
    v_mul_f32 v105, 0.15915494, v105
    v_fract_f32 v104, v104
    v_fract_f32 v105, v105
    v_cos_f32 v104, v104
    v_cos_f32 v105, v105
    v_mad_u32_u16 v106, v63, 6, 0
    v_and_b32 v107, 2, v106
    v_sub_u32 v106, v106, v107
    v_sub_u32 v107, v106, v107
    ds_write_b32 v106, v24 offset:11344
    v_mad_u32_u16 v108, v63, 6, 0 op_sel:[1,0,0,0]
    v_and_b32 v109, 2, v108
    v_sub_u32 v108, v108, v109
    v_sub_u32 v109, v108, v109
    ds_write_b32 v108, v25 offset:11344
    v_cvt_pk_bf16_f32 v88, v104, v105
    ds_write_b16 v107, v88 offset:11352
    ds_write_b16_d16_hi v109, v88 offset:11352
    v_lshlrev_b32 v110, 16, v89
    v_and_b32 v111, 0xffff0000, v89
    v_mul_f32 v110, 0.15915494, v110
    v_mul_f32 v111, 0.15915494, v111
    v_fract_f32 v110, v110
    v_fract_f32 v111, v111
    v_cos_f32 v110, v110
    v_cos_f32 v111, v111
    v_mad_u32_u16 v112, v64, 6, 0
    v_and_b32 v113, 2, v112
    v_sub_u32 v112, v112, v113
    v_sub_u32 v113, v112, v113
    ds_write_b32 v112, v26 offset:11344
    v_mad_u32_u16 v114, v64, 6, 0 op_sel:[1,0,0,0]
    v_and_b32 v115, 2, v114
    v_sub_u32 v114, v114, v115
    v_sub_u32 v115, v114, v115
    ds_write_b32 v114, v27 offset:11344
    v_cvt_pk_bf16_f32 v89, v110, v111
    ds_write_b16 v113, v89 offset:11352
    ds_write_b16_d16_hi v115, v89 offset:11352
    v_lshlrev_b32 v104, 16, v90
    v_and_b32 v105, 0xffff0000, v90
    v_mul_f32 v104, 0.15915494, v104
    v_mul_f32 v105, 0.15915494, v105
    v_fract_f32 v104, v104
    v_fract_f32 v105, v105
    v_cos_f32 v104, v104
    v_cos_f32 v105, v105
    v_mad_u32_u16 v106, v65, 6, 0
    v_and_b32 v107, 2, v106
    v_sub_u32 v106, v106, v107
    v_sub_u32 v107, v106, v107
    ds_write_b32 v106, v28 offset:11344
    v_mad_u32_u16 v108, v65, 6, 0 op_sel:[1,0,0,0]
    v_and_b32 v109, 2, v108
    v_sub_u32 v108, v108, v109
    v_sub_u32 v109, v108, v109
    ds_write_b32 v108, v29 offset:11344
    v_cvt_pk_bf16_f32 v90, v104, v105
    ds_write_b16 v107, v90 offset:11352
    ds_write_b16_d16_hi v109, v90 offset:11352
    v_lshlrev_b32 v110, 16, v91
    v_and_b32 v111, 0xffff0000, v91
    v_mul_f32 v110, 0.15915494, v110
    v_mul_f32 v111, 0.15915494, v111
    v_fract_f32 v110, v110
    v_fract_f32 v111, v111
    v_cos_f32 v110, v110
    v_cos_f32 v111, v111
    v_mad_u32_u16 v112, v66, 6, 0
    v_and_b32 v113, 2, v112
    v_sub_u32 v112, v112, v113
    v_sub_u32 v113, v112, v113
    ds_write_b32 v112, v30 offset:11344
    v_mad_u32_u16 v114, v66, 6, 0 op_sel:[1,0,0,0]
    v_and_b32 v115, 2, v114
    v_sub_u32 v114, v114, v115
    v_sub_u32 v115, v114, v115
    ds_write_b32 v114, v31 offset:11344
    v_cvt_pk_bf16_f32 v91, v110, v111
    ds_write_b16 v113, v91 offset:11352
    ds_write_b16_d16_hi v115, v91 offset:11352
    s_cmp_eq_u32 s44, 0
    s_cbranch_scc1 P2_norele
    s_waitcnt vmcnt(0)
    v_readfirstlane_b32 s40, v3
    s_cmp_lg_u32 s40, 255
    s_cbranch_scc1 P2_norele
    s_mov_b64 exec, 1
    buffer_store_dword v3, v2, s[24:27], 0 offen offset:140 sc1
    s_mov_b64 exec, -1
P2_norele:
    v_lshlrev_b32 v104, 16, v92
    v_and_b32 v105, 0xffff0000, v92
    v_mul_f32 v104, 0.15915494, v104
    v_mul_f32 v105, 0.15915494, v105
    v_fract_f32 v104, v104
    v_fract_f32 v105, v105
    v_cos_f32 v104, v104
    v_cos_f32 v105, v105
    v_mad_u32_u16 v106, v67, 6, 0
    v_and_b32 v107, 2, v106
    v_sub_u32 v106, v106, v107
    v_sub_u32 v107, v106, v107
    ds_write_b32 v106, v32 offset:11344
    v_mad_u32_u16 v108, v67, 6, 0 op_sel:[1,0,0,0]
    v_and_b32 v109, 2, v108
    v_sub_u32 v108, v108, v109
    v_sub_u32 v109, v108, v109
    ds_write_b32 v108, v33 offset:11344
    v_cvt_pk_bf16_f32 v92, v104, v105
    ds_write_b16 v107, v92 offset:11352
    ds_write_b16_d16_hi v109, v92 offset:11352
    v_lshlrev_b32 v110, 16, v93
    v_and_b32 v111, 0xffff0000, v93
    v_mul_f32 v110, 0.15915494, v110
    v_mul_f32 v111, 0.15915494, v111
    v_fract_f32 v110, v110
    v_fract_f32 v111, v111
    v_cos_f32 v110, v110
    v_cos_f32 v111, v111
    v_mad_u32_u16 v112, v68, 6, 0
    v_and_b32 v113, 2, v112
    v_sub_u32 v112, v112, v113
    v_sub_u32 v113, v112, v113
    ds_write_b32 v112, v34 offset:11344
    v_mad_u32_u16 v114, v68, 6, 0 op_sel:[1,0,0,0]
    v_and_b32 v115, 2, v114
    v_sub_u32 v114, v114, v115
    v_sub_u32 v115, v114, v115
    ds_write_b32 v114, v35 offset:11344
    v_cvt_pk_bf16_f32 v93, v110, v111
    ds_write_b16 v113, v93 offset:11352
    ds_write_b16_d16_hi v115, v93 offset:11352
    s_cmp_lg_u32 s3, 0
    s_cbranch_scc1 P1_npf0
    buffer_load_dword v1, v1, s[8:11], 0 offen
P1_npf0:
    s_cmp_lg_u32 s3, 1
    s_cbranch_scc1 P1_npf1
    buffer_load_dword v1, v1, s[8:11], 0 offen
P1_npf1:
    v_lshlrev_b32 v104, 16, v94
    v_and_b32 v105, 0xffff0000, v94
    v_mul_f32 v104, 0.15915494, v104
    v_mul_f32 v105, 0.15915494, v105
    v_fract_f32 v104, v104
    v_fract_f32 v105, v105
    v_cos_f32 v104, v104
    v_cos_f32 v105, v105
    v_mad_u32_u16 v106, v69, 6, 0
    v_and_b32 v107, 2, v106
    v_sub_u32 v106, v106, v107
    v_sub_u32 v107, v106, v107
    ds_write_b32 v106, v36 offset:11344
    v_mad_u32_u16 v108, v69, 6, 0 op_sel:[1,0,0,0]
    v_and_b32 v109, 2, v108
    v_sub_u32 v108, v108, v109
    v_sub_u32 v109, v108, v109
    ds_write_b32 v108, v37 offset:11344
    v_cvt_pk_bf16_f32 v94, v104, v105
    ds_write_b16 v107, v94 offset:11352
    ds_write_b16_d16_hi v109, v94 offset:11352
    s_setprio 0
    s_cmp_lg_u32 s3, 2
    s_cbranch_scc1 P1_npf2
    buffer_load_dword v1, v1, s[8:11], 0 offen
P1_npf2:
    s_cmp_lg_u32 s3, 3
    s_cbranch_scc1 P1_npf3
    buffer_load_dword v1, v1, s[8:11], 0 offen
P1_npf3:
    v_lshlrev_b32 v110, 16, v95
    v_and_b32 v111, 0xffff0000, v95
    v_mul_f32 v110, 0.15915494, v110
    v_mul_f32 v111, 0.15915494, v111
    v_fract_f32 v110, v110
    v_fract_f32 v111, v111
    v_cos_f32 v110, v110
    v_cos_f32 v111, v111
    v_mad_u32_u16 v112, v70, 6, 0
    v_and_b32 v113, 2, v112
    v_sub_u32 v112, v112, v113
    v_sub_u32 v113, v112, v113
    ds_write_b32 v112, v38 offset:11344
    v_mad_u32_u16 v114, v70, 6, 0 op_sel:[1,0,0,0]
    v_and_b32 v115, 2, v114
    v_sub_u32 v114, v114, v115
    v_sub_u32 v115, v114, v115
    ds_write_b32 v114, v39 offset:11344
    v_cvt_pk_bf16_f32 v95, v110, v111
    ds_write_b16 v113, v95 offset:11352
    ds_write_b16_d16_hi v115, v95 offset:11352
    s_cmp_lg_u32 s3, 4
    s_cbranch_scc1 P1_npf4
    buffer_load_dword v1, v1, s[8:11], 0 offen
P1_npf4:
    s_cmp_lg_u32 s3, 5
    s_cbranch_scc1 P1_npf5
    buffer_load_dword v1, v1, s[8:11], 0 offen
P1_npf5:
    v_lshlrev_b32 v104, 16, v96
    v_and_b32 v105, 0xffff0000, v96
    v_mul_f32 v104, 0.15915494, v104
    v_mul_f32 v105, 0.15915494, v105
    v_fract_f32 v104, v104
    v_fract_f32 v105, v105
    v_cos_f32 v104, v104
    v_cos_f32 v105, v105
    v_mad_u32_u16 v106, v71, 6, 0
    v_and_b32 v107, 2, v106
    v_sub_u32 v106, v106, v107
    v_sub_u32 v107, v106, v107
    ds_write_b32 v106, v40 offset:11344
    v_mad_u32_u16 v108, v71, 6, 0 op_sel:[1,0,0,0]
    v_and_b32 v109, 2, v108
    v_sub_u32 v108, v108, v109
    v_sub_u32 v109, v108, v109
    ds_write_b32 v108, v41 offset:11344
    v_cvt_pk_bf16_f32 v96, v104, v105
    ds_write_b16 v107, v96 offset:11352
    ds_write_b16_d16_hi v109, v96 offset:11352
    v_lshlrev_b32 v110, 16, v97
    v_and_b32 v111, 0xffff0000, v97
    v_mul_f32 v110, 0.15915494, v110
    v_mul_f32 v111, 0.15915494, v111
    v_fract_f32 v110, v110
    v_fract_f32 v111, v111
    v_cos_f32 v110, v110
    v_cos_f32 v111, v111
    v_mad_u32_u16 v112, v72, 6, 0
    v_and_b32 v113, 2, v112
    v_sub_u32 v112, v112, v113
    v_sub_u32 v113, v112, v113
    ds_write_b32 v112, v42 offset:11344
    v_mad_u32_u16 v114, v72, 6, 0 op_sel:[1,0,0,0]
    v_and_b32 v115, 2, v114
    v_sub_u32 v114, v114, v115
    v_sub_u32 v115, v114, v115
    ds_write_b32 v114, v43 offset:11344
    v_cvt_pk_bf16_f32 v97, v110, v111
    ds_write_b16 v113, v97 offset:11352
    ds_write_b16_d16_hi v115, v97 offset:11352
    v_lshlrev_b32 v104, 16, v98
    v_and_b32 v105, 0xffff0000, v98
    v_mul_f32 v104, 0.15915494, v104
    v_mul_f32 v105, 0.15915494, v105
    v_fract_f32 v104, v104
    v_fract_f32 v105, v105
    v_cos_f32 v104, v104
    v_cos_f32 v105, v105
    v_mad_u32_u16 v106, v73, 6, 0
    v_and_b32 v107, 2, v106
    v_sub_u32 v106, v106, v107
    v_sub_u32 v107, v106, v107
    ds_write_b32 v106, v44 offset:11344
    v_mad_u32_u16 v108, v73, 6, 0 op_sel:[1,0,0,0]
    v_and_b32 v109, 2, v108
    v_sub_u32 v108, v108, v109
    v_sub_u32 v109, v108, v109
    ds_write_b32 v108, v45 offset:11344
    v_cvt_pk_bf16_f32 v98, v104, v105
    ds_write_b16 v107, v98 offset:11352
    ds_write_b16_d16_hi v109, v98 offset:11352
    v_lshlrev_b32 v110, 16, v99
    v_and_b32 v111, 0xffff0000, v99
    v_mul_f32 v110, 0.15915494, v110
    v_mul_f32 v111, 0.15915494, v111
    v_fract_f32 v110, v110
    v_fract_f32 v111, v111
    v_cos_f32 v110, v110
    v_cos_f32 v111, v111
    v_mad_u32_u16 v112, v74, 6, 0
    v_and_b32 v113, 2, v112
    v_sub_u32 v112, v112, v113
    v_sub_u32 v113, v112, v113
    ds_write_b32 v112, v46 offset:11344
    v_mad_u32_u16 v114, v74, 6, 0 op_sel:[1,0,0,0]
    v_and_b32 v115, 2, v114
    v_sub_u32 v114, v114, v115
    v_sub_u32 v115, v114, v115
    ds_write_b32 v114, v47 offset:11344
    v_cvt_pk_bf16_f32 v99, v110, v111
    ds_write_b16 v113, v99 offset:11352
    ds_write_b16_d16_hi v115, v99 offset:11352
    v_lshlrev_b32 v104, 16, v100
    v_and_b32 v105, 0xffff0000, v100
    v_mul_f32 v104, 0.15915494, v104
    v_mul_f32 v105, 0.15915494, v105
    v_fract_f32 v104, v104
    v_fract_f32 v105, v105
    v_cos_f32 v104, v104
    v_cos_f32 v105, v105
    v_mad_u32_u16 v106, v75, 6, 0
    v_and_b32 v107, 2, v106
    v_sub_u32 v106, v106, v107
    v_sub_u32 v107, v106, v107
    ds_write_b32 v106, v48 offset:11344
    v_mad_u32_u16 v108, v75, 6, 0 op_sel:[1,0,0,0]
    v_and_b32 v109, 2, v108
    v_sub_u32 v108, v108, v109
    v_sub_u32 v109, v108, v109
    ds_write_b32 v108, v49 offset:11344
    v_cvt_pk_bf16_f32 v100, v104, v105
    ds_write_b16 v107, v100 offset:11352
    ds_write_b16_d16_hi v109, v100 offset:11352
    v_lshlrev_b32 v110, 16, v101
    v_and_b32 v111, 0xffff0000, v101
    v_mul_f32 v110, 0.15915494, v110
    v_mul_f32 v111, 0.15915494, v111
    v_fract_f32 v110, v110
    v_fract_f32 v111, v111
    v_cos_f32 v110, v110
    v_cos_f32 v111, v111
    v_mad_u32_u16 v112, v76, 6, 0
    v_and_b32 v113, 2, v112
    v_sub_u32 v112, v112, v113
    v_sub_u32 v113, v112, v113
    ds_write_b32 v112, v50 offset:11344
    v_mad_u32_u16 v114, v76, 6, 0 op_sel:[1,0,0,0]
    v_and_b32 v115, 2, v114
    v_sub_u32 v114, v114, v115
    v_sub_u32 v115, v114, v115
    ds_write_b32 v114, v51 offset:11344
    v_cvt_pk_bf16_f32 v101, v110, v111
    ds_write_b16 v113, v101 offset:11352
    ds_write_b16_d16_hi v115, v101 offset:11352
    v_lshlrev_b32 v104, 16, v102
    v_and_b32 v105, 0xffff0000, v102
    v_mul_f32 v104, 0.15915494, v104
    v_mul_f32 v105, 0.15915494, v105
    v_fract_f32 v104, v104
    v_fract_f32 v105, v105
    v_cos_f32 v104, v104
    v_cos_f32 v105, v105
    v_mad_u32_u16 v106, v77, 6, 0
    v_and_b32 v107, 2, v106
    v_sub_u32 v106, v106, v107
    v_sub_u32 v107, v106, v107
    ds_write_b32 v106, v52 offset:11344
    v_cvt_pk_bf16_f32 v102, v104, v105
    ds_write_b16 v107, v102 offset:11352
    s_mul_i32 s40, s2, 300032
    s_add_u32 s20, s32, s40
    s_addc_u32 s21, s33, 0
    s_mov_b32 s22, 150528
    s_mov_b32 s23, 0x20000
    v_subrev_u32 v2, 9216, v103
    s_mov_b32 s44, 0
    s_waitcnt lgkmcnt(0)
    s_barrier
    s_cmp_lg_u32 s3, 15
    s_cbranch_scc1 P1_noclr
    v_and_b32 v3, 15, v0
    v_lshlrev_b32 v3, 2, v3
    v_add_u32 v3, 161872, v3
    v_mov_b32 v104, 0
    ds_write_b32 v3, v104
P1_noclr:
    ds_read_b128 v[104:107], v2 offset:20560
    ds_read_b128 v[108:111], v2 offset:19536
    ds_read_b128 v[112:115], v2 offset:18512
    ds_read_b128 v[116:119], v2 offset:17488
    ds_read_b128 v[120:123], v2 offset:16464
    ds_read_b128 v[124:127], v2 offset:15440
    s_waitcnt lgkmcnt(5)
    s_mov_b64 exec, 0xffff
    buffer_store_dwordx4 v[104:107], v103, s[20:23], 0 offen sc1
    s_mov_b64 exec, -1
    v_subrev_u32 v103, 1024, v103
    ds_read_b128 v[104:107], v2 offset:14416
    s_waitcnt lgkmcnt(5)
    buffer_store_dwordx4 v[108:111], v103, s[20:23], 0 offen sc1
    v_subrev_u32 v103, 1024, v103
    ds_read_b128 v[108:111], v2 offset:13392
    s_waitcnt lgkmcnt(5)
    buffer_store_dwordx4 v[112:115], v103, s[20:23], 0 offen sc1
    v_subrev_u32 v103, 1024, v103
    ds_read_b128 v[112:115], v2 offset:12368
    s_waitcnt lgkmcnt(5)
    buffer_store_dwordx4 v[116:119], v103, s[20:23], 0 offen sc1
    v_subrev_u32 v103, 1024, v103
    ds_read_b128 v[116:119], v2 offset:11344
    s_waitcnt lgkmcnt(5)
    buffer_store_dwordx4 v[120:123], v103, s[20:23], 0 offen sc1
    v_subrev_u32 v103, 1024, v103
    s_waitcnt vmcnt(5) lgkmcnt(0)
    s_cmp_ge_u32 s3, 4
    s_cbranch_scc1 P1_nod
    buffer_store_dwordx4 v[124:127], v103, s[20:23], 0 offen sc1
    v_subrev_u32 v103, 1024, v103
    buffer_store_dwordx4 v[104:107], v103, s[20:23], 0 offen sc1
    v_subrev_u32 v103, 1024, v103
    buffer_store_dwordx4 v[108:111], v103, s[20:23], 0 offen sc1
    v_subrev_u32 v103, 1024, v103
    buffer_store_dwordx4 v[112:115], v103, s[20:23], 0 offen sc1
    v_subrev_u32 v103, 1024, v103
    buffer_store_dwordx4 v[116:119], v103, s[20:23], 0 offen sc1
    v_subrev_u32 v103, 1024, v103
    s_waitcnt vmcnt(0)
    v_mov_b32 v104, 0
    v_mov_b32 v105, 1
    s_mov_b64 exec, 1
    ds_add_rtn_u32 v105, v104, v105
    s_mov_b64 exec, -1
    s_waitcnt lgkmcnt(0)
    v_readfirstlane_b32 s40, v105
    s_cmp_lg_u32 s40, 3
    s_cbranch_scc1 P1_nod
    v_mov_b32 v104, 0
    v_mov_b32 v105, 1
    s_mov_b64 exec, 1
    buffer_atomic_add v105, v104, s[24:27], 0 offen offset:64 sc0 sc1
    s_mov_b64 exec, -1
    s_mov_b32 s44, 1
P1_nod:
    s_mov_b32 s45, 4294816768
    s_barrier
    s_setprio 3
    s_cmp_lt_u32 s3, 4
    s_cbranch_scc1 P1_pr0
    s_setprio 2
P1_pr0:
    v_mad_u32_u16 v0, v53, 6, s45
    v_and_b32 v1, 2, v0
    v_sub_u32 v0, v0, v1
    v_sub_u32 v1, v0, v1
    ds_write_b32 v0, v4 offset:11344
    ds_write_b16 v1, v78 offset:11352
    v_mad_u32_u16 v2, v53, 6, s45 op_sel:[1,0,0,0]
    v_and_b32 v3, 2, v2
    v_sub_u32 v2, v2, v3
    v_sub_u32 v3, v2, v3
    ds_write_b32 v2, v5 offset:11344
    ds_write_b16_d16_hi v3, v78 offset:11352
    s_cmp_eq_u32 s44, 0
    s_cbranch_scc1 P2_noreld
    s_waitcnt vmcnt(0)
    v_readfirstlane_b32 s40, v105
    s_cmp_lg_u32 s40, 255
    s_cbranch_scc1 P2_noreld
    s_mov_b64 exec, 1
    buffer_store_dword v105, v104, s[24:27], 0 offen offset:136 sc1
    s_mov_b64 exec, -1
P2_noreld:
    s_cmp_lt_u32 s3, 4
    s_cbranch_scc1 P1_ns1
    buffer_store_dwordx4 v[124:127], v103, s[20:23], 0 offen sc1
    v_subrev_u32 v103, 1024, v103
P1_ns1:
    v_mad_u32_u16 v0, v54, 6, s45
    v_and_b32 v1, 2, v0
    v_sub_u32 v0, v0, v1
    v_sub_u32 v1, v0, v1
    ds_write_b32 v0, v6 offset:11344
    ds_write_b16 v1, v79 offset:11352
    v_mad_u32_u16 v2, v54, 6, s45 op_sel:[1,0,0,0]
    v_and_b32 v3, 2, v2
    v_sub_u32 v2, v2, v3
    v_sub_u32 v3, v2, v3
    ds_write_b32 v2, v7 offset:11344
    ds_write_b16_d16_hi v3, v79 offset:11352
    v_mad_u32_u16 v0, v55, 6, s45
    v_and_b32 v1, 2, v0
    v_sub_u32 v0, v0, v1
    v_sub_u32 v1, v0, v1
    ds_write_b32 v0, v8 offset:11344
    ds_write_b16 v1, v80 offset:11352
    v_mad_u32_u16 v2, v55, 6, s45 op_sel:[1,0,0,0]
    v_and_b32 v3, 2, v2
    v_sub_u32 v2, v2, v3
    v_sub_u32 v3, v2, v3
    ds_write_b32 v2, v9 offset:11344
    ds_write_b16_d16_hi v3, v80 offset:11352
    v_mad_u32_u16 v0, v56, 6, s45
    v_and_b32 v1, 2, v0
    v_sub_u32 v0, v0, v1
    v_sub_u32 v1, v0, v1
    ds_write_b32 v0, v10 offset:11344
    ds_write_b16 v1, v81 offset:11352
    v_mad_u32_u16 v2, v56, 6, s45 op_sel:[1,0,0,0]
    v_and_b32 v3, 2, v2
    v_sub_u32 v2, v2, v3
    v_sub_u32 v3, v2, v3
    ds_write_b32 v2, v11 offset:11344
    ds_write_b16_d16_hi v3, v81 offset:11352
    v_mad_u32_u16 v0, v57, 6, s45
    v_and_b32 v1, 2, v0
    v_sub_u32 v0, v0, v1
    v_sub_u32 v1, v0, v1
    ds_write_b32 v0, v12 offset:11344
    ds_write_b16 v1, v82 offset:11352
    v_mad_u32_u16 v2, v57, 6, s45 op_sel:[1,0,0,0]
    v_and_b32 v3, 2, v2
    v_sub_u32 v2, v2, v3
    v_sub_u32 v3, v2, v3
    ds_write_b32 v2, v13 offset:11344
    ds_write_b16_d16_hi v3, v82 offset:11352
    s_cmp_lt_u32 s3, 4
    s_cbranch_scc1 P1_ns5
    buffer_store_dwordx4 v[104:107], v103, s[20:23], 0 offen sc1
    v_subrev_u32 v103, 1024, v103
P1_ns5:
    v_mad_u32_u16 v0, v58, 6, s45
    v_and_b32 v1, 2, v0
    v_sub_u32 v0, v0, v1
    v_sub_u32 v1, v0, v1
    ds_write_b32 v0, v14 offset:11344
    ds_write_b16 v1, v83 offset:11352
    v_mad_u32_u16 v2, v58, 6, s45 op_sel:[1,0,0,0]
    v_and_b32 v3, 2, v2
    v_sub_u32 v2, v2, v3
    v_sub_u32 v3, v2, v3
    ds_write_b32 v2, v15 offset:11344
    ds_write_b16_d16_hi v3, v83 offset:11352
    v_mad_u32_u16 v0, v59, 6, s45
    v_and_b32 v1, 2, v0
    v_sub_u32 v0, v0, v1
    v_sub_u32 v1, v0, v1
    ds_write_b32 v0, v16 offset:11344
    ds_write_b16 v1, v84 offset:11352
    v_mad_u32_u16 v2, v59, 6, s45 op_sel:[1,0,0,0]
    v_and_b32 v3, 2, v2
    v_sub_u32 v2, v2, v3
    v_sub_u32 v3, v2, v3
    ds_write_b32 v2, v17 offset:11344
    ds_write_b16_d16_hi v3, v84 offset:11352
    v_mad_u32_u16 v0, v60, 6, s45
    v_and_b32 v1, 2, v0
    v_sub_u32 v0, v0, v1
    v_sub_u32 v1, v0, v1
    ds_write_b32 v0, v18 offset:11344
    ds_write_b16 v1, v85 offset:11352
    v_mad_u32_u16 v2, v60, 6, s45 op_sel:[1,0,0,0]
    v_and_b32 v3, 2, v2
    v_sub_u32 v2, v2, v3
    v_sub_u32 v3, v2, v3
    ds_write_b32 v2, v19 offset:11344
    ds_write_b16_d16_hi v3, v85 offset:11352
    v_mad_u32_u16 v0, v61, 6, s45
    v_and_b32 v1, 2, v0
    v_sub_u32 v0, v0, v1
    v_sub_u32 v1, v0, v1
    ds_write_b32 v0, v20 offset:11344
    ds_write_b16 v1, v86 offset:11352
    v_mad_u32_u16 v2, v61, 6, s45 op_sel:[1,0,0,0]
    v_and_b32 v3, 2, v2
    v_sub_u32 v2, v2, v3
    v_sub_u32 v3, v2, v3
    ds_write_b32 v2, v21 offset:11344
    ds_write_b16_d16_hi v3, v86 offset:11352
    s_cmp_lt_u32 s3, 4
    s_cbranch_scc1 P1_pr9
    s_setprio 1
P1_pr9:
    s_cmp_lt_u32 s3, 4
    s_cbranch_scc1 P1_ns9
    buffer_store_dwordx4 v[108:111], v103, s[20:23], 0 offen sc1
    v_subrev_u32 v103, 1024, v103
P1_ns9:
    v_mad_u32_u16 v0, v62, 6, s45
    v_and_b32 v1, 2, v0
    v_sub_u32 v0, v0, v1
    v_sub_u32 v1, v0, v1
    ds_write_b32 v0, v22 offset:11344
    ds_write_b16 v1, v87 offset:11352
    v_mad_u32_u16 v2, v62, 6, s45 op_sel:[1,0,0,0]
    v_and_b32 v3, 2, v2
    v_sub_u32 v2, v2, v3
    v_sub_u32 v3, v2, v3
    ds_write_b32 v2, v23 offset:11344
    ds_write_b16_d16_hi v3, v87 offset:11352
    v_mad_u32_u16 v0, v63, 6, s45
    v_and_b32 v1, 2, v0
    v_sub_u32 v0, v0, v1
    v_sub_u32 v1, v0, v1
    ds_write_b32 v0, v24 offset:11344
    ds_write_b16 v1, v88 offset:11352
    v_mad_u32_u16 v2, v63, 6, s45 op_sel:[1,0,0,0]
    v_and_b32 v3, 2, v2
    v_sub_u32 v2, v2, v3
    v_sub_u32 v3, v2, v3
    ds_write_b32 v2, v25 offset:11344
    ds_write_b16_d16_hi v3, v88 offset:11352
    v_mad_u32_u16 v0, v64, 6, s45
    v_and_b32 v1, 2, v0
    v_sub_u32 v0, v0, v1
    v_sub_u32 v1, v0, v1
    ds_write_b32 v0, v26 offset:11344
    ds_write_b16 v1, v89 offset:11352
    v_mad_u32_u16 v2, v64, 6, s45 op_sel:[1,0,0,0]
    v_and_b32 v3, 2, v2
    v_sub_u32 v2, v2, v3
    v_sub_u32 v3, v2, v3
    ds_write_b32 v2, v27 offset:11344
    ds_write_b16_d16_hi v3, v89 offset:11352
    v_mad_u32_u16 v0, v65, 6, s45
    v_and_b32 v1, 2, v0
    v_sub_u32 v0, v0, v1
    v_sub_u32 v1, v0, v1
    ds_write_b32 v0, v28 offset:11344
    ds_write_b16 v1, v90 offset:11352
    v_mad_u32_u16 v2, v65, 6, s45 op_sel:[1,0,0,0]
    v_and_b32 v3, 2, v2
    v_sub_u32 v2, v2, v3
    v_sub_u32 v3, v2, v3
    ds_write_b32 v2, v29 offset:11344
    ds_write_b16_d16_hi v3, v90 offset:11352
    s_cmp_lt_u32 s3, 4
    s_cbranch_scc1 P1_ns13
    buffer_store_dwordx4 v[112:115], v103, s[20:23], 0 offen sc1
    v_subrev_u32 v103, 1024, v103
P1_ns13:
    v_mad_u32_u16 v0, v66, 6, s45
    v_and_b32 v1, 2, v0
    v_sub_u32 v0, v0, v1
    v_sub_u32 v1, v0, v1
    ds_write_b32 v0, v30 offset:11344
    ds_write_b16 v1, v91 offset:11352
    v_mad_u32_u16 v2, v66, 6, s45 op_sel:[1,0,0,0]
    v_and_b32 v3, 2, v2
    v_sub_u32 v2, v2, v3
    v_sub_u32 v3, v2, v3
    ds_write_b32 v2, v31 offset:11344
    ds_write_b16_d16_hi v3, v91 offset:11352
    v_mad_u32_u16 v0, v67, 6, s45
    v_and_b32 v1, 2, v0
    v_sub_u32 v0, v0, v1
    v_sub_u32 v1, v0, v1
    ds_write_b32 v0, v32 offset:11344
    ds_write_b16 v1, v92 offset:11352
    v_mad_u32_u16 v2, v67, 6, s45 op_sel:[1,0,0,0]
    v_and_b32 v3, 2, v2
    v_sub_u32 v2, v2, v3
    v_sub_u32 v3, v2, v3
    ds_write_b32 v2, v33 offset:11344
    ds_write_b16_d16_hi v3, v92 offset:11352
    v_mad_u32_u16 v0, v68, 6, s45
    v_and_b32 v1, 2, v0
    v_sub_u32 v0, v0, v1
    v_sub_u32 v1, v0, v1
    ds_write_b32 v0, v34 offset:11344
    ds_write_b16 v1, v93 offset:11352
    v_mad_u32_u16 v2, v68, 6, s45 op_sel:[1,0,0,0]
    v_and_b32 v3, 2, v2
    v_sub_u32 v2, v2, v3
    v_sub_u32 v3, v2, v3
    ds_write_b32 v2, v35 offset:11344
    ds_write_b16_d16_hi v3, v93 offset:11352
    v_mad_u32_u16 v0, v69, 6, s45
    v_and_b32 v1, 2, v0
    v_sub_u32 v0, v0, v1
    v_sub_u32 v1, v0, v1
    ds_write_b32 v0, v36 offset:11344
    ds_write_b16 v1, v94 offset:11352
    v_mad_u32_u16 v2, v69, 6, s45 op_sel:[1,0,0,0]
    v_and_b32 v3, 2, v2
    v_sub_u32 v2, v2, v3
    v_sub_u32 v3, v2, v3
    ds_write_b32 v2, v37 offset:11344
    ds_write_b16_d16_hi v3, v94 offset:11352
    s_cmp_lt_u32 s3, 4
    s_cbranch_scc1 P1_pr17
    s_setprio 0
P1_pr17:
    s_cmp_lt_u32 s3, 4
    s_cbranch_scc1 P1_ns17
    buffer_store_dwordx4 v[116:119], v103, s[20:23], 0 offen sc1
    v_subrev_u32 v103, 1024, v103
P1_ns17:
    v_mad_u32_u16 v0, v70, 6, s45
    v_and_b32 v1, 2, v0
    v_sub_u32 v0, v0, v1
    v_sub_u32 v1, v0, v1
    ds_write_b32 v0, v38 offset:11344
    ds_write_b16 v1, v95 offset:11352
    v_mad_u32_u16 v2, v70, 6, s45 op_sel:[1,0,0,0]
    v_and_b32 v3, 2, v2
    v_sub_u32 v2, v2, v3
    v_sub_u32 v3, v2, v3
    ds_write_b32 v2, v39 offset:11344
    ds_write_b16_d16_hi v3, v95 offset:11352
    v_mad_u32_u16 v0, v71, 6, s45
    v_and_b32 v1, 2, v0
    v_sub_u32 v0, v0, v1
    v_sub_u32 v1, v0, v1
    ds_write_b32 v0, v40 offset:11344
    ds_write_b16 v1, v96 offset:11352
    v_mad_u32_u16 v2, v71, 6, s45 op_sel:[1,0,0,0]
    v_and_b32 v3, 2, v2
    v_sub_u32 v2, v2, v3
    v_sub_u32 v3, v2, v3
    ds_write_b32 v2, v41 offset:11344
    ds_write_b16_d16_hi v3, v96 offset:11352
    v_mad_u32_u16 v0, v72, 6, s45
    v_and_b32 v1, 2, v0
    v_sub_u32 v0, v0, v1
    v_sub_u32 v1, v0, v1
    ds_write_b32 v0, v42 offset:11344
    ds_write_b16 v1, v97 offset:11352
    v_mad_u32_u16 v2, v72, 6, s45 op_sel:[1,0,0,0]
    v_and_b32 v3, 2, v2
    v_sub_u32 v2, v2, v3
    v_sub_u32 v3, v2, v3
    ds_write_b32 v2, v43 offset:11344
    ds_write_b16_d16_hi v3, v97 offset:11352
    v_mad_u32_u16 v0, v73, 6, s45
    v_and_b32 v1, 2, v0
    v_sub_u32 v0, v0, v1
    v_sub_u32 v1, v0, v1
    ds_write_b32 v0, v44 offset:11344
    ds_write_b16 v1, v98 offset:11352
    v_mad_u32_u16 v2, v73, 6, s45 op_sel:[1,0,0,0]
    v_and_b32 v3, 2, v2
    v_sub_u32 v2, v2, v3
    v_sub_u32 v3, v2, v3
    ds_write_b32 v2, v45 offset:11344
    ds_write_b16_d16_hi v3, v98 offset:11352
    v_mad_u32_u16 v0, v74, 6, s45
    v_and_b32 v1, 2, v0
    v_sub_u32 v0, v0, v1
    v_sub_u32 v1, v0, v1
    ds_write_b32 v0, v46 offset:11344
    ds_write_b16 v1, v99 offset:11352
    v_mad_u32_u16 v2, v74, 6, s45 op_sel:[1,0,0,0]
    v_and_b32 v3, 2, v2
    v_sub_u32 v2, v2, v3
    v_sub_u32 v3, v2, v3
    ds_write_b32 v2, v47 offset:11344
    ds_write_b16_d16_hi v3, v99 offset:11352
    v_mad_u32_u16 v0, v75, 6, s45
    v_and_b32 v1, 2, v0
    v_sub_u32 v0, v0, v1
    v_sub_u32 v1, v0, v1
    ds_write_b32 v0, v48 offset:11344
    ds_write_b16 v1, v100 offset:11352
    v_mad_u32_u16 v2, v75, 6, s45 op_sel:[1,0,0,0]
    v_and_b32 v3, 2, v2
    v_sub_u32 v2, v2, v3
    v_sub_u32 v3, v2, v3
    ds_write_b32 v2, v49 offset:11344
    ds_write_b16_d16_hi v3, v100 offset:11352
    v_mad_u32_u16 v0, v76, 6, s45
    v_and_b32 v1, 2, v0
    v_sub_u32 v0, v0, v1
    v_sub_u32 v1, v0, v1
    ds_write_b32 v0, v50 offset:11344
    ds_write_b16 v1, v101 offset:11352
    v_mad_u32_u16 v2, v76, 6, s45 op_sel:[1,0,0,0]
    v_and_b32 v3, 2, v2
    v_sub_u32 v2, v2, v3
    v_sub_u32 v3, v2, v3
    ds_write_b32 v2, v51 offset:11344
    ds_write_b16_d16_hi v3, v101 offset:11352
    v_mad_u32_u16 v0, v77, 6, s45
    v_and_b32 v1, 2, v0
    v_sub_u32 v0, v0, v1
    v_sub_u32 v1, v0, v1
    ds_write_b32 v0, v52 offset:11344
    ds_write_b16 v1, v102 offset:11352
    v_mov_b32 v4, 161876
    v_mov_b32 v5, 1
    s_mov_b64 exec, 1
    s_waitcnt lgkmcnt(0)
    ds_add_u32 v4, v5
    s_mov_b64 exec, -1
    s_mul_i32 s40, s2, 300032
    s_add_u32 s40, s40, 150528
    s_add_u32 s20, s32, s40
    s_addc_u32 s21, s33, 0
    s_mov_b32 s22, 149472
    s_mov_b32 s23, 0x20000
    s_and_b32 s46, s2, 7
    s_lshl_b32 s46, s46, 2
    s_lshr_b32 s46, 925242628, s46
    s_and_b32 s46, s46, 7
    s_lshl_b32 s46, s46, 5
    s_lshr_b32 s47, s2, 3
    s_add_u32 s46, s46, s47
    v_mbcnt_lo_u32_b32 v12, -1, 0
    v_mbcnt_hi_u32_b32 v12, -1, v12
    s_lshl_b32 s40, s3, 6
    v_add_u32 v0, s40, v12
    s_mov_b32 s8, s48
    s_mov_b32 s9, s49
    s_mov_b32 s10, 25600000
    s_mov_b32 s11, 0x20000
    s_mov_b32 s12, s32
    s_mov_b32 s13, s33
    s_mov_b32 s14, 76808192
    s_mov_b32 s15, 0x20000
    s_add_u32 s16, s32, 83886080
    s_addc_u32 s17, s33, 0
    s_mov_b32 s18, 2883584
    s_mov_b32 s19, 0x20000
    s_mov_b64 s[6:7], s[86:87]
    s_mov_b32 s48, 0
    s_cmp_ge_u32 s3, 4
    s_cbranch_scc1 P2_consumer
    s_setprio 3
    s_waitcnt vmcnt(0)
    v_mov_b32 v24, 161872
    v_mov_b32 v25, 1
    s_mov_b64 exec, 1
    ds_add_rtn_u32 v25, v24, v25
    s_mov_b64 exec, -1
    s_waitcnt lgkmcnt(0)
    v_readfirstlane_b32 s40, v25
    s_cmp_lg_u32 s40, 15
    s_cbranch_scc1 P2_norelap
    v_mov_b32 v24, 0
    v_mov_b32 v25, 1
    s_mov_b64 exec, 1
    buffer_atomic_add v25, v24, s[24:27], 0 offen offset:0 sc0 sc1
    s_mov_b64 exec, -1
    s_waitcnt vmcnt(0)
    v_readfirstlane_b32 s40, v25
    s_cmp_lg_u32 s40, 255
    s_cbranch_scc1 P2_norelap
    s_mov_b64 exec, 1
    buffer_store_dword v25, v24, s[24:27], 0 offen offset:128 sc1
    s_mov_b64 exec, -1
P2_norelap:
    s_lshl_b32 s47, s3, 6
    v_add_u32 v2, s47, v12
    s_lshl_b32 s50, s3, 2
    s_add_u32 s50, s50, 161920
    v_mov_b32 v26, s50
    v_lshlrev_b32 v15, 8, v2
    v_add_u32 v15, s46, v15
    v_mul_u32_u24 v15, 44, v15
    v_mov_b32 v51, 0
    v_mul_u32_u24 v2, 300032, v2
    v_and_b32 v24, 15, v12
    v_mul_u32_u24 v1, 12, v24
    v_lshl_add_u32 v8, v24, 1, 1
    v_add_u32 v7, 1, v8
    v_mov_b32 v3, 262148
    v_mov_b32 v4, 0x3fc
    v_mov_b32 v9, 0x80000000
    v_mov_b32 v5, 0
    v_mov_b32 v6, 0
    v_mov_b32 v18, 0
    v_mov_b32 v19, 0
    v_mov_b32 v28, 0
    v_mov_b32 v29, 0
    s_mov_b32 s49, 0
    s_mov_b32 s5, 16777215
    s_mov_b32 s82, 0x00010001
    s_mov_b32 s83, 0x00010001
    s_mov_b32 s45, 413859839
    s_mov_b32 s51, 0
P2_polle:
    buffer_load_dword v24, v6, s[24:27], 0 offen offset:140 sc1
    s_add_u32 s51, s51, 1
    s_cmp_gt_u32 s51, 1000000
    s_cbranch_scc1 P2_giveup
    s_waitcnt vmcnt(0)
    v_cmp_eq_u32 vcc, 0, v24
    s_cbranch_vccz P2_pollede
    s_sleep 24
    s_branch P2_polle
P2_pollede:
    buffer_load_dwordx4 v[40:43], v15, s[16:19], 0 offen offset:0 sc1
    buffer_load_dwordx4 v[44:47], v15, s[16:19], 0 offen offset:16 sc1
    buffer_load_dwordx3 v[48:50], v15, s[16:19], 0 offen offset:32 sc1
    s_mov_b32 s51, 0
P2_polld:
    buffer_load_dword v24, v6, s[24:27], 0 offen offset:136 sc1
    s_add_u32 s51, s51, 1
    s_cmp_gt_u32 s51, 1000000
    s_cbranch_scc1 P2_giveup
    s_waitcnt vmcnt(0)
    v_cmp_eq_u32 vcc, 0, v24
    s_cbranch_vccz P2_polledd
    s_sleep 24
    s_branch P2_polld
P2_polledd:
    v_cmp_lt_u32 vcc, s45, v40
    s_cbranch_vccz P2_have1
    s_call_b64 s[42:43], P2_ensure
P2_have1:
    v_bfe_u32 v24, v40, 1, 15
    v_mad_u32_u24 v14, v24, 12, v2
    v_lshrrev_b32 v13, 16, v40
    v_and_b32 v24, 0xfffe, v40
    v_sub_u32 v13, v13, v24
    v_and_b32 v24, 1, v40
    v_cmp_eq_u32 s[84:85], 1, v24
    v_cmp_lt_u32 s[86:87], 32, v13
    v_mov_b32 v40, v41
    v_mov_b32 v41, v42
    v_mov_b32 v42, v43
    v_mov_b32 v43, v44
    v_mov_b32 v44, v45
    v_mov_b32 v45, v46
    v_mov_b32 v46, v47
    v_mov_b32 v47, v48
    v_mov_b32 v48, v49
    v_mov_b32 v49, v50
    v_mov_b32 v50, v51
    v_add_u32_dpp v24, v14, v1 row_newbcast:0 row_mask:0xf bank_mask:0xf
    v_sub_u32_dpp v25, v13, v8 row_newbcast:0 row_mask:0xf bank_mask:0xf
    v_bitop3_b32 v24, v25, v9, v24 bitop3:0xea
    buffer_load_dwordx3 v[64:66], v24, s[12:15], 0 offen sc1
    v_add_u32_dpp v16, v14, v1 row_newbcast:1 row_mask:0xf bank_mask:0xf
    v_sub_u32_dpp v17, v13, v8 row_newbcast:1 row_mask:0xf bank_mask:0xf
    v_bitop3_b32 v16, v17, v9, v16 bitop3:0xea
    buffer_load_dwordx3 v[68:70], v16, s[12:15], 0 offen sc1
    v_add_u32_dpp v24, v14, v1 row_newbcast:2 row_mask:0xf bank_mask:0xf
    v_sub_u32_dpp v25, v13, v8 row_newbcast:2 row_mask:0xf bank_mask:0xf
    v_bitop3_b32 v24, v25, v9, v24 bitop3:0xea
    buffer_load_dwordx3 v[72:74], v24, s[12:15], 0 offen sc1
    v_add_u32_dpp v16, v14, v1 row_newbcast:3 row_mask:0xf bank_mask:0xf
    v_sub_u32_dpp v17, v13, v8 row_newbcast:3 row_mask:0xf bank_mask:0xf
    v_bitop3_b32 v16, v17, v9, v16 bitop3:0xea
    buffer_load_dwordx3 v[76:78], v16, s[12:15], 0 offen sc1
    v_add_u32_dpp v24, v14, v1 row_newbcast:4 row_mask:0xf bank_mask:0xf
    v_sub_u32_dpp v25, v13, v8 row_newbcast:4 row_mask:0xf bank_mask:0xf
    v_bitop3_b32 v24, v25, v9, v24 bitop3:0xea
    buffer_load_dwordx3 v[80:82], v24, s[12:15], 0 offen sc1
    v_add_u32_dpp v16, v14, v1 row_newbcast:5 row_mask:0xf bank_mask:0xf
    v_sub_u32_dpp v17, v13, v8 row_newbcast:5 row_mask:0xf bank_mask:0xf
    v_bitop3_b32 v16, v17, v9, v16 bitop3:0xea
    buffer_load_dwordx3 v[84:86], v16, s[12:15], 0 offen sc1
    v_add_u32_dpp v24, v14, v1 row_newbcast:6 row_mask:0xf bank_mask:0xf
    v_sub_u32_dpp v25, v13, v8 row_newbcast:6 row_mask:0xf bank_mask:0xf
    v_bitop3_b32 v24, v25, v9, v24 bitop3:0xea
    buffer_load_dwordx3 v[88:90], v24, s[12:15], 0 offen sc1
    v_add_u32_dpp v16, v14, v1 row_newbcast:7 row_mask:0xf bank_mask:0xf
    v_sub_u32_dpp v17, v13, v8 row_newbcast:7 row_mask:0xf bank_mask:0xf
    v_bitop3_b32 v16, v17, v9, v16 bitop3:0xea
    buffer_load_dwordx3 v[92:94], v16, s[12:15], 0 offen sc1
    v_add_u32_dpp v24, v14, v1 row_newbcast:8 row_mask:0xf bank_mask:0xf
    v_sub_u32_dpp v25, v13, v8 row_newbcast:8 row_mask:0xf bank_mask:0xf
    v_bitop3_b32 v24, v25, v9, v24 bitop3:0xea
    buffer_load_dwordx3 v[96:98], v24, s[12:15], 0 offen sc1
    v_add_u32_dpp v16, v14, v1 row_newbcast:9 row_mask:0xf bank_mask:0xf
    v_sub_u32_dpp v17, v13, v8 row_newbcast:9 row_mask:0xf bank_mask:0xf
    v_bitop3_b32 v16, v17, v9, v16 bitop3:0xea
    buffer_load_dwordx3 v[100:102], v16, s[12:15], 0 offen sc1
    v_add_u32_dpp v24, v14, v1 row_newbcast:10 row_mask:0xf bank_mask:0xf
    v_sub_u32_dpp v25, v13, v8 row_newbcast:10 row_mask:0xf bank_mask:0xf
    v_bitop3_b32 v24, v25, v9, v24 bitop3:0xea
    buffer_load_dwordx3 v[104:106], v24, s[12:15], 0 offen sc1
    v_add_u32_dpp v16, v14, v1 row_newbcast:11 row_mask:0xf bank_mask:0xf
    v_sub_u32_dpp v17, v13, v8 row_newbcast:11 row_mask:0xf bank_mask:0xf
    v_bitop3_b32 v16, v17, v9, v16 bitop3:0xea
    buffer_load_dwordx3 v[108:110], v16, s[12:15], 0 offen sc1
    v_add_u32_dpp v24, v14, v1 row_newbcast:12 row_mask:0xf bank_mask:0xf
    v_sub_u32_dpp v25, v13, v8 row_newbcast:12 row_mask:0xf bank_mask:0xf
    v_bitop3_b32 v24, v25, v9, v24 bitop3:0xea
    buffer_load_dwordx3 v[112:114], v24, s[12:15], 0 offen sc1
    v_add_u32_dpp v16, v14, v1 row_newbcast:13 row_mask:0xf bank_mask:0xf
    v_sub_u32_dpp v17, v13, v8 row_newbcast:13 row_mask:0xf bank_mask:0xf
    v_bitop3_b32 v16, v17, v9, v16 bitop3:0xea
    buffer_load_dwordx3 v[116:118], v16, s[12:15], 0 offen sc1
    v_add_u32_dpp v24, v14, v1 row_newbcast:14 row_mask:0xf bank_mask:0xf
    v_sub_u32_dpp v25, v13, v8 row_newbcast:14 row_mask:0xf bank_mask:0xf
    v_bitop3_b32 v24, v25, v9, v24 bitop3:0xea
    buffer_load_dwordx3 v[120:122], v24, s[12:15], 0 offen sc1
    v_add_u32_dpp v16, v14, v1 row_newbcast:15 row_mask:0xf bank_mask:0xf
    v_sub_u32_dpp v17, v13, v8 row_newbcast:15 row_mask:0xf bank_mask:0xf
    v_bitop3_b32 v16, v17, v9, v16 bitop3:0xea
    buffer_load_dwordx3 v[124:126], v16, s[12:15], 0 offen sc1
    v_mov_b32 v59, 4278452223
    v_mov_b32 v60, 524288
P2_pslice:
    v_mov_b32 v10, v13
    v_mov_b32 v11, v14
    s_mov_b64 s[52:53], s[84:85]
    s_mov_b64 s[54:55], s[86:87]
    v_mov_b32 v61, 0
    v_sub_co_u32_dpp v24, vcc, v10, v8 row_newbcast:0 row_mask:0xf bank_mask:0xf
    s_and_b64 s[92:93], s[52:53], s[82:83]
    s_or_b64 s[88:89], vcc, s[92:93]
    v_sub_co_u32_dpp v25, vcc, v10, v7 row_newbcast:0 row_mask:0xf bank_mask:0xf
    s_lshr_b64 s[52:53], s[52:53], 1
    s_waitcnt vmcnt(15)
    v_lshrrev_b32 v16, 18, v64
    v_lshrrev_b32 v17, 18, v65
    v_bitop3_b32 v16, v16, v4, v5 bitop3:0xea
    v_bitop3_b32 v17, v17, v4, v5 bitop3:0xea
    v_cndmask_b32 v67, v16, v60, s[88:89]
    v_cndmask_b32 v30, v17, v60, vcc
    v_sub_co_u32_dpp v24, vcc, v10, v8 row_newbcast:1 row_mask:0xf bank_mask:0xf
    s_and_b64 s[92:93], s[52:53], s[82:83]
    s_or_b64 s[88:89], vcc, s[92:93]
    v_sub_co_u32_dpp v25, vcc, v10, v7 row_newbcast:1 row_mask:0xf bank_mask:0xf
    s_lshr_b64 s[52:53], s[52:53], 1
    s_waitcnt vmcnt(14)
    v_lshrrev_b32 v16, 18, v68
    v_lshrrev_b32 v17, 18, v69
    v_bitop3_b32 v16, v16, v4, v5 bitop3:0xea
    v_bitop3_b32 v17, v17, v4, v5 bitop3:0xea
    v_cndmask_b32 v71, v16, v60, s[88:89]
    v_cndmask_b32 v31, v17, v60, vcc
    v_sub_co_u32_dpp v24, vcc, v10, v8 row_newbcast:2 row_mask:0xf bank_mask:0xf
    s_and_b64 s[92:93], s[52:53], s[82:83]
    s_or_b64 s[88:89], vcc, s[92:93]
    v_sub_co_u32_dpp v25, vcc, v10, v7 row_newbcast:2 row_mask:0xf bank_mask:0xf
    s_lshr_b64 s[52:53], s[52:53], 1
    s_waitcnt vmcnt(13)
    v_lshrrev_b32 v16, 18, v72
    v_lshrrev_b32 v17, 18, v73
    v_bitop3_b32 v16, v16, v4, v5 bitop3:0xea
    v_bitop3_b32 v17, v17, v4, v5 bitop3:0xea
    v_cndmask_b32 v75, v16, v60, s[88:89]
    v_cndmask_b32 v32, v17, v60, vcc
    v_sub_co_u32_dpp v24, vcc, v10, v8 row_newbcast:3 row_mask:0xf bank_mask:0xf
    s_and_b64 s[92:93], s[52:53], s[82:83]
    s_or_b64 s[88:89], vcc, s[92:93]
    v_sub_co_u32_dpp v25, vcc, v10, v7 row_newbcast:3 row_mask:0xf bank_mask:0xf
    s_lshr_b64 s[52:53], s[52:53], 1
    s_waitcnt vmcnt(12)
    v_lshrrev_b32 v16, 18, v76
    v_lshrrev_b32 v17, 18, v77
    v_bitop3_b32 v16, v16, v4, v5 bitop3:0xea
    v_bitop3_b32 v17, v17, v4, v5 bitop3:0xea
    v_cndmask_b32 v79, v16, v60, s[88:89]
    v_cndmask_b32 v33, v17, v60, vcc
    v_sub_co_u32_dpp v24, vcc, v10, v8 row_newbcast:4 row_mask:0xf bank_mask:0xf
    s_and_b64 s[92:93], s[52:53], s[82:83]
    s_or_b64 s[88:89], vcc, s[92:93]
    v_sub_co_u32_dpp v25, vcc, v10, v7 row_newbcast:4 row_mask:0xf bank_mask:0xf
    s_lshr_b64 s[52:53], s[52:53], 1
    s_waitcnt vmcnt(11)
    v_lshrrev_b32 v16, 18, v80
    v_lshrrev_b32 v17, 18, v81
    v_bitop3_b32 v16, v16, v4, v5 bitop3:0xea
    v_bitop3_b32 v17, v17, v4, v5 bitop3:0xea
    v_cndmask_b32 v83, v16, v60, s[88:89]
    v_cndmask_b32 v34, v17, v60, vcc
    v_sub_co_u32_dpp v24, vcc, v10, v8 row_newbcast:5 row_mask:0xf bank_mask:0xf
    s_and_b64 s[92:93], s[52:53], s[82:83]
    s_or_b64 s[88:89], vcc, s[92:93]
    v_sub_co_u32_dpp v25, vcc, v10, v7 row_newbcast:5 row_mask:0xf bank_mask:0xf
    s_lshr_b64 s[52:53], s[52:53], 1
    s_waitcnt vmcnt(10)
    v_lshrrev_b32 v16, 18, v84
    v_lshrrev_b32 v17, 18, v85
    v_bitop3_b32 v16, v16, v4, v5 bitop3:0xea
    v_bitop3_b32 v17, v17, v4, v5 bitop3:0xea
    v_cndmask_b32 v87, v16, v60, s[88:89]
    v_cndmask_b32 v35, v17, v60, vcc
    v_sub_co_u32_dpp v24, vcc, v10, v8 row_newbcast:6 row_mask:0xf bank_mask:0xf
    s_and_b64 s[92:93], s[52:53], s[82:83]
    s_or_b64 s[88:89], vcc, s[92:93]
    v_sub_co_u32_dpp v25, vcc, v10, v7 row_newbcast:6 row_mask:0xf bank_mask:0xf
    s_lshr_b64 s[52:53], s[52:53], 1
    s_waitcnt vmcnt(9)
    v_lshrrev_b32 v16, 18, v88
    v_lshrrev_b32 v17, 18, v89
    v_bitop3_b32 v16, v16, v4, v5 bitop3:0xea
    v_bitop3_b32 v17, v17, v4, v5 bitop3:0xea
    v_cndmask_b32 v91, v16, v60, s[88:89]
    v_cndmask_b32 v36, v17, v60, vcc
    v_sub_co_u32_dpp v24, vcc, v10, v8 row_newbcast:7 row_mask:0xf bank_mask:0xf
    s_and_b64 s[92:93], s[52:53], s[82:83]
    s_or_b64 s[88:89], vcc, s[92:93]
    v_sub_co_u32_dpp v25, vcc, v10, v7 row_newbcast:7 row_mask:0xf bank_mask:0xf
    s_lshr_b64 s[52:53], s[52:53], 1
    s_waitcnt vmcnt(8)
    v_lshrrev_b32 v16, 18, v92
    v_lshrrev_b32 v17, 18, v93
    v_bitop3_b32 v16, v16, v4, v5 bitop3:0xea
    v_bitop3_b32 v17, v17, v4, v5 bitop3:0xea
    v_cndmask_b32 v95, v16, v60, s[88:89]
    v_cndmask_b32 v37, v17, v60, vcc
    v_sub_co_u32_dpp v24, vcc, v10, v8 row_newbcast:8 row_mask:0xf bank_mask:0xf
    s_and_b64 s[92:93], s[52:53], s[82:83]
    s_or_b64 s[88:89], vcc, s[92:93]
    v_sub_co_u32_dpp v25, vcc, v10, v7 row_newbcast:8 row_mask:0xf bank_mask:0xf
    s_lshr_b64 s[52:53], s[52:53], 1
    s_waitcnt vmcnt(7)
    v_lshrrev_b32 v16, 18, v96
    v_lshrrev_b32 v17, 18, v97
    v_bitop3_b32 v16, v16, v4, v5 bitop3:0xea
    v_bitop3_b32 v17, v17, v4, v5 bitop3:0xea
    v_cndmask_b32 v99, v16, v60, s[88:89]
    v_cndmask_b32 v38, v17, v60, vcc
    v_sub_co_u32_dpp v24, vcc, v10, v8 row_newbcast:9 row_mask:0xf bank_mask:0xf
    s_and_b64 s[92:93], s[52:53], s[82:83]
    s_or_b64 s[88:89], vcc, s[92:93]
    v_sub_co_u32_dpp v25, vcc, v10, v7 row_newbcast:9 row_mask:0xf bank_mask:0xf
    s_lshr_b64 s[52:53], s[52:53], 1
    s_waitcnt vmcnt(6)
    v_lshrrev_b32 v16, 18, v100
    v_lshrrev_b32 v17, 18, v101
    v_bitop3_b32 v16, v16, v4, v5 bitop3:0xea
    v_bitop3_b32 v17, v17, v4, v5 bitop3:0xea
    v_cndmask_b32 v103, v16, v60, s[88:89]
    v_cndmask_b32 v39, v17, v60, vcc
    v_sub_co_u32_dpp v24, vcc, v10, v8 row_newbcast:10 row_mask:0xf bank_mask:0xf
    s_and_b64 s[92:93], s[52:53], s[82:83]
    s_or_b64 s[88:89], vcc, s[92:93]
    v_sub_co_u32_dpp v25, vcc, v10, v7 row_newbcast:10 row_mask:0xf bank_mask:0xf
    s_lshr_b64 s[52:53], s[52:53], 1
    s_waitcnt vmcnt(5)
    v_lshrrev_b32 v16, 18, v104
    v_lshrrev_b32 v17, 18, v105
    v_bitop3_b32 v16, v16, v4, v5 bitop3:0xea
    v_bitop3_b32 v17, v17, v4, v5 bitop3:0xea
    v_cndmask_b32 v107, v16, v60, s[88:89]
    v_cndmask_b32 v53, v17, v60, vcc
    v_sub_co_u32_dpp v24, vcc, v10, v8 row_newbcast:11 row_mask:0xf bank_mask:0xf
    s_and_b64 s[92:93], s[52:53], s[82:83]
    s_or_b64 s[88:89], vcc, s[92:93]
    v_sub_co_u32_dpp v25, vcc, v10, v7 row_newbcast:11 row_mask:0xf bank_mask:0xf
    s_lshr_b64 s[52:53], s[52:53], 1
    s_waitcnt vmcnt(4)
    v_lshrrev_b32 v16, 18, v108
    v_lshrrev_b32 v17, 18, v109
    v_bitop3_b32 v16, v16, v4, v5 bitop3:0xea
    v_bitop3_b32 v17, v17, v4, v5 bitop3:0xea
    v_cndmask_b32 v111, v16, v60, s[88:89]
    v_cndmask_b32 v54, v17, v60, vcc
    v_sub_co_u32_dpp v24, vcc, v10, v8 row_newbcast:12 row_mask:0xf bank_mask:0xf
    s_and_b64 s[92:93], s[52:53], s[82:83]
    s_or_b64 s[88:89], vcc, s[92:93]
    v_sub_co_u32_dpp v25, vcc, v10, v7 row_newbcast:12 row_mask:0xf bank_mask:0xf
    s_lshr_b64 s[52:53], s[52:53], 1
    s_waitcnt vmcnt(3)
    v_lshrrev_b32 v16, 18, v112
    v_lshrrev_b32 v17, 18, v113
    v_bitop3_b32 v16, v16, v4, v5 bitop3:0xea
    v_bitop3_b32 v17, v17, v4, v5 bitop3:0xea
    v_cndmask_b32 v115, v16, v60, s[88:89]
    v_cndmask_b32 v55, v17, v60, vcc
    v_sub_co_u32_dpp v24, vcc, v10, v8 row_newbcast:13 row_mask:0xf bank_mask:0xf
    s_and_b64 s[92:93], s[52:53], s[82:83]
    s_or_b64 s[88:89], vcc, s[92:93]
    v_sub_co_u32_dpp v25, vcc, v10, v7 row_newbcast:13 row_mask:0xf bank_mask:0xf
    s_lshr_b64 s[52:53], s[52:53], 1
    s_waitcnt vmcnt(2)
    v_lshrrev_b32 v16, 18, v116
    v_lshrrev_b32 v17, 18, v117
    v_bitop3_b32 v16, v16, v4, v5 bitop3:0xea
    v_bitop3_b32 v17, v17, v4, v5 bitop3:0xea
    v_cndmask_b32 v119, v16, v60, s[88:89]
    v_cndmask_b32 v56, v17, v60, vcc
    v_sub_co_u32_dpp v24, vcc, v10, v8 row_newbcast:14 row_mask:0xf bank_mask:0xf
    s_and_b64 s[92:93], s[52:53], s[82:83]
    s_or_b64 s[88:89], vcc, s[92:93]
    v_sub_co_u32_dpp v25, vcc, v10, v7 row_newbcast:14 row_mask:0xf bank_mask:0xf
    s_lshr_b64 s[52:53], s[52:53], 1
    s_waitcnt vmcnt(1)
    v_lshrrev_b32 v16, 18, v120
    v_lshrrev_b32 v17, 18, v121
    v_bitop3_b32 v16, v16, v4, v5 bitop3:0xea
    v_bitop3_b32 v17, v17, v4, v5 bitop3:0xea
    v_cndmask_b32 v123, v16, v60, s[88:89]
    v_cndmask_b32 v57, v17, v60, vcc
    v_sub_co_u32_dpp v24, vcc, v10, v8 row_newbcast:15 row_mask:0xf bank_mask:0xf
    s_and_b64 s[92:93], s[52:53], s[82:83]
    s_or_b64 s[88:89], vcc, s[92:93]
    v_sub_co_u32_dpp v25, vcc, v10, v7 row_newbcast:15 row_mask:0xf bank_mask:0xf
    s_lshr_b64 s[52:53], s[52:53], 1
    s_waitcnt vmcnt(0)
    v_lshrrev_b32 v16, 18, v124
    v_lshrrev_b32 v17, 18, v125
    v_bitop3_b32 v16, v16, v4, v5 bitop3:0xea
    v_bitop3_b32 v17, v17, v4, v5 bitop3:0xea
    v_cndmask_b32 v127, v16, v60, s[88:89]
    v_cndmask_b32 v58, v17, v60, vcc
    s_cmp_lg_u32 s49, 0
    s_cbranch_scc1 P2_nfi
    v_mov_b32 v24, 161884
P2_lwi:
    ds_read_b32 v25, v24
    s_waitcnt lgkmcnt(0)
    v_readfirstlane_b32 s40, v25
    s_cmp_ge_u32 s40, 12
    s_cbranch_scc1 P2_lgi
    s_sleep 1
    s_branch P2_lwi
P2_lgi:
P2_nfi:
    s_call_b64 s[42:43], P2_wait
    ds_add_rtn_u32 v16, v67, v3
    ds_add_rtn_u32 v17, v30, v3
    v_and_b32 v24, 0xf00fffff, v64
    v_and_b32 v25, 0xf00fffff, v65
    s_waitcnt lgkmcnt(0)
    v_bitop3_b32 v67, v59, v16, v67 bitop3:0xca
    v_bitop3_b32 v30, v59, v17, v30 bitop3:0xca
    v_lshrrev_b32 v27, 1, v67
    v_lshrrev_b32 v15, 1, v30
    ds_write_b32 v67, v24 offset:50144
    ds_write_b16 v27, v66 offset:2560
    ds_write_b32 v30, v25 offset:50144
    ds_write_b16_d16_hi v15, v66 offset:2560
    v_bitop3_b32 v61, v61, v67, v30 bitop3:0xfe
    s_waitcnt lgkmcnt(0)
    ds_add_rtn_u32 v16, v71, v3
    ds_add_rtn_u32 v17, v31, v3
    v_and_b32 v24, 0xf00fffff, v68
    v_and_b32 v25, 0xf00fffff, v69
    s_waitcnt lgkmcnt(0)
    v_bitop3_b32 v71, v59, v16, v71 bitop3:0xca
    v_bitop3_b32 v31, v59, v17, v31 bitop3:0xca
    v_lshrrev_b32 v27, 1, v71
    v_lshrrev_b32 v15, 1, v31
    ds_write_b32 v71, v24 offset:50144
    ds_write_b16 v27, v70 offset:2560
    ds_write_b32 v31, v25 offset:50144
    ds_write_b16_d16_hi v15, v70 offset:2560
    v_bitop3_b32 v61, v61, v71, v31 bitop3:0xfe
    s_waitcnt lgkmcnt(0)
    ds_add_rtn_u32 v16, v75, v3
    ds_add_rtn_u32 v17, v32, v3
    v_and_b32 v24, 0xf00fffff, v72
    v_and_b32 v25, 0xf00fffff, v73
    s_waitcnt lgkmcnt(0)
    v_bitop3_b32 v75, v59, v16, v75 bitop3:0xca
    v_bitop3_b32 v32, v59, v17, v32 bitop3:0xca
    v_lshrrev_b32 v27, 1, v75
    v_lshrrev_b32 v15, 1, v32
    ds_write_b32 v75, v24 offset:50144
    ds_write_b16 v27, v74 offset:2560
    ds_write_b32 v32, v25 offset:50144
    ds_write_b16_d16_hi v15, v74 offset:2560
    v_bitop3_b32 v61, v61, v75, v32 bitop3:0xfe
    s_waitcnt lgkmcnt(0)
    ds_add_rtn_u32 v16, v79, v3
    ds_add_rtn_u32 v17, v33, v3
    v_and_b32 v24, 0xf00fffff, v76
    v_and_b32 v25, 0xf00fffff, v77
    s_waitcnt lgkmcnt(0)
    v_bitop3_b32 v79, v59, v16, v79 bitop3:0xca
    v_bitop3_b32 v33, v59, v17, v33 bitop3:0xca
    v_lshrrev_b32 v27, 1, v79
    v_lshrrev_b32 v15, 1, v33
    ds_write_b32 v79, v24 offset:50144
    ds_write_b16 v27, v78 offset:2560
    ds_write_b32 v33, v25 offset:50144
    ds_write_b16_d16_hi v15, v78 offset:2560
    v_bitop3_b32 v61, v61, v79, v33 bitop3:0xfe
    s_waitcnt lgkmcnt(0)
    ds_add_rtn_u32 v16, v83, v3
    ds_add_rtn_u32 v17, v34, v3
    v_and_b32 v24, 0xf00fffff, v80
    v_and_b32 v25, 0xf00fffff, v81
    s_waitcnt lgkmcnt(0)
    v_bitop3_b32 v83, v59, v16, v83 bitop3:0xca
    v_bitop3_b32 v34, v59, v17, v34 bitop3:0xca
    v_lshrrev_b32 v27, 1, v83
    v_lshrrev_b32 v15, 1, v34
    ds_write_b32 v83, v24 offset:50144
    ds_write_b16 v27, v82 offset:2560
    ds_write_b32 v34, v25 offset:50144
    ds_write_b16_d16_hi v15, v82 offset:2560
    v_bitop3_b32 v61, v61, v83, v34 bitop3:0xfe
    s_waitcnt lgkmcnt(0)
    ds_add_rtn_u32 v16, v87, v3
    ds_add_rtn_u32 v17, v35, v3
    v_and_b32 v24, 0xf00fffff, v84
    v_and_b32 v25, 0xf00fffff, v85
    s_waitcnt lgkmcnt(0)
    v_bitop3_b32 v87, v59, v16, v87 bitop3:0xca
    v_bitop3_b32 v35, v59, v17, v35 bitop3:0xca
    v_lshrrev_b32 v27, 1, v87
    v_lshrrev_b32 v15, 1, v35
    ds_write_b32 v87, v24 offset:50144
    ds_write_b16 v27, v86 offset:2560
    ds_write_b32 v35, v25 offset:50144
    ds_write_b16_d16_hi v15, v86 offset:2560
    v_bitop3_b32 v61, v61, v87, v35 bitop3:0xfe
    s_waitcnt lgkmcnt(0)
    ds_add_rtn_u32 v16, v91, v3
    ds_add_rtn_u32 v17, v36, v3
    v_and_b32 v24, 0xf00fffff, v88
    v_and_b32 v25, 0xf00fffff, v89
    s_waitcnt lgkmcnt(0)
    v_bitop3_b32 v91, v59, v16, v91 bitop3:0xca
    v_bitop3_b32 v36, v59, v17, v36 bitop3:0xca
    v_lshrrev_b32 v27, 1, v91
    v_lshrrev_b32 v15, 1, v36
    ds_write_b32 v91, v24 offset:50144
    ds_write_b16 v27, v90 offset:2560
    ds_write_b32 v36, v25 offset:50144
    ds_write_b16_d16_hi v15, v90 offset:2560
    v_bitop3_b32 v61, v61, v91, v36 bitop3:0xfe
    s_waitcnt lgkmcnt(0)
    ds_add_rtn_u32 v16, v95, v3
    ds_add_rtn_u32 v17, v37, v3
    v_and_b32 v24, 0xf00fffff, v92
    v_and_b32 v25, 0xf00fffff, v93
    s_waitcnt lgkmcnt(0)
    v_bitop3_b32 v95, v59, v16, v95 bitop3:0xca
    v_bitop3_b32 v37, v59, v17, v37 bitop3:0xca
    v_lshrrev_b32 v27, 1, v95
    v_lshrrev_b32 v15, 1, v37
    ds_write_b32 v95, v24 offset:50144
    ds_write_b16 v27, v94 offset:2560
    ds_write_b32 v37, v25 offset:50144
    ds_write_b16_d16_hi v15, v94 offset:2560
    v_bitop3_b32 v61, v61, v95, v37 bitop3:0xfe
    s_waitcnt lgkmcnt(0)
    ds_add_rtn_u32 v16, v99, v3
    ds_add_rtn_u32 v17, v38, v3
    v_and_b32 v24, 0xf00fffff, v96
    v_and_b32 v25, 0xf00fffff, v97
    s_waitcnt lgkmcnt(0)
    v_bitop3_b32 v99, v59, v16, v99 bitop3:0xca
    v_bitop3_b32 v38, v59, v17, v38 bitop3:0xca
    v_lshrrev_b32 v27, 1, v99
    v_lshrrev_b32 v15, 1, v38
    ds_write_b32 v99, v24 offset:50144
    ds_write_b16 v27, v98 offset:2560
    ds_write_b32 v38, v25 offset:50144
    ds_write_b16_d16_hi v15, v98 offset:2560
    v_bitop3_b32 v61, v61, v99, v38 bitop3:0xfe
    s_waitcnt lgkmcnt(0)
    ds_add_rtn_u32 v16, v103, v3
    ds_add_rtn_u32 v17, v39, v3
    v_and_b32 v24, 0xf00fffff, v100
    v_and_b32 v25, 0xf00fffff, v101
    s_waitcnt lgkmcnt(0)
    v_bitop3_b32 v103, v59, v16, v103 bitop3:0xca
    v_bitop3_b32 v39, v59, v17, v39 bitop3:0xca
    v_lshrrev_b32 v27, 1, v103
    v_lshrrev_b32 v15, 1, v39
    ds_write_b32 v103, v24 offset:50144
    ds_write_b16 v27, v102 offset:2560
    ds_write_b32 v39, v25 offset:50144
    ds_write_b16_d16_hi v15, v102 offset:2560
    v_bitop3_b32 v61, v61, v103, v39 bitop3:0xfe
    s_waitcnt lgkmcnt(0)
    ds_add_rtn_u32 v16, v107, v3
    ds_add_rtn_u32 v17, v53, v3
    v_and_b32 v24, 0xf00fffff, v104
    v_and_b32 v25, 0xf00fffff, v105
    s_waitcnt lgkmcnt(0)
    v_bitop3_b32 v107, v59, v16, v107 bitop3:0xca
    v_bitop3_b32 v53, v59, v17, v53 bitop3:0xca
    v_lshrrev_b32 v27, 1, v107
    v_lshrrev_b32 v15, 1, v53
    ds_write_b32 v107, v24 offset:50144
    ds_write_b16 v27, v106 offset:2560
    ds_write_b32 v53, v25 offset:50144
    ds_write_b16_d16_hi v15, v106 offset:2560
    v_bitop3_b32 v61, v61, v107, v53 bitop3:0xfe
    s_waitcnt lgkmcnt(0)
    ds_add_rtn_u32 v16, v111, v3
    ds_add_rtn_u32 v17, v54, v3
    v_and_b32 v24, 0xf00fffff, v108
    v_and_b32 v25, 0xf00fffff, v109
    s_waitcnt lgkmcnt(0)
    v_bitop3_b32 v111, v59, v16, v111 bitop3:0xca
    v_bitop3_b32 v54, v59, v17, v54 bitop3:0xca
    v_lshrrev_b32 v27, 1, v111
    v_lshrrev_b32 v15, 1, v54
    ds_write_b32 v111, v24 offset:50144
    ds_write_b16 v27, v110 offset:2560
    ds_write_b32 v54, v25 offset:50144
    ds_write_b16_d16_hi v15, v110 offset:2560
    v_bitop3_b32 v61, v61, v111, v54 bitop3:0xfe
    s_waitcnt lgkmcnt(0)
    ds_add_rtn_u32 v16, v115, v3
    ds_add_rtn_u32 v17, v55, v3
    v_and_b32 v24, 0xf00fffff, v112
    v_and_b32 v25, 0xf00fffff, v113
    s_waitcnt lgkmcnt(0)
    v_bitop3_b32 v115, v59, v16, v115 bitop3:0xca
    v_bitop3_b32 v55, v59, v17, v55 bitop3:0xca
    v_lshrrev_b32 v27, 1, v115
    v_lshrrev_b32 v15, 1, v55
    ds_write_b32 v115, v24 offset:50144
    ds_write_b16 v27, v114 offset:2560
    ds_write_b32 v55, v25 offset:50144
    ds_write_b16_d16_hi v15, v114 offset:2560
    v_bitop3_b32 v61, v61, v115, v55 bitop3:0xfe
    s_waitcnt lgkmcnt(0)
    ds_add_rtn_u32 v16, v119, v3
    ds_add_rtn_u32 v17, v56, v3
    v_and_b32 v24, 0xf00fffff, v116
    v_and_b32 v25, 0xf00fffff, v117
    s_waitcnt lgkmcnt(0)
    v_bitop3_b32 v119, v59, v16, v119 bitop3:0xca
    v_bitop3_b32 v56, v59, v17, v56 bitop3:0xca
    v_lshrrev_b32 v27, 1, v119
    v_lshrrev_b32 v15, 1, v56
    ds_write_b32 v119, v24 offset:50144
    ds_write_b16 v27, v118 offset:2560
    ds_write_b32 v56, v25 offset:50144
    ds_write_b16_d16_hi v15, v118 offset:2560
    v_bitop3_b32 v61, v61, v119, v56 bitop3:0xfe
    s_waitcnt lgkmcnt(0)
    ds_add_rtn_u32 v16, v123, v3
    ds_add_rtn_u32 v17, v57, v3
    v_and_b32 v24, 0xf00fffff, v120
    v_and_b32 v25, 0xf00fffff, v121
    s_waitcnt lgkmcnt(0)
    v_bitop3_b32 v123, v59, v16, v123 bitop3:0xca
    v_bitop3_b32 v57, v59, v17, v57 bitop3:0xca
    v_lshrrev_b32 v27, 1, v123
    v_lshrrev_b32 v15, 1, v57
    ds_write_b32 v123, v24 offset:50144
    ds_write_b16 v27, v122 offset:2560
    ds_write_b32 v57, v25 offset:50144
    ds_write_b16_d16_hi v15, v122 offset:2560
    v_bitop3_b32 v61, v61, v123, v57 bitop3:0xfe
    s_waitcnt lgkmcnt(0)
    ds_add_rtn_u32 v16, v127, v3
    ds_add_rtn_u32 v17, v58, v3
    v_and_b32 v24, 0xf00fffff, v124
    v_and_b32 v25, 0xf00fffff, v125
    s_waitcnt lgkmcnt(0)
    v_bitop3_b32 v127, v59, v16, v127 bitop3:0xca
    v_bitop3_b32 v58, v59, v17, v58 bitop3:0xca
    v_lshrrev_b32 v27, 1, v127
    v_lshrrev_b32 v15, 1, v58
    ds_write_b32 v127, v24 offset:50144
    ds_write_b16 v27, v126 offset:2560
    ds_write_b32 v58, v25 offset:50144
    ds_write_b16_d16_hi v15, v126 offset:2560
    v_bitop3_b32 v61, v61, v127, v58 bitop3:0xfe
    s_waitcnt lgkmcnt(0)
    v_cmp_lt_u32 vcc, s5, v61
    v_mov_b32 v18, 0
    v_mov_b32 v19, 0
    s_or_b32 s47, s54, s55
    s_lshr_b32 s40, s47, 16
    s_or_b32 s47, s47, s40
    s_cmp_lg_u64 vcc, 0
    s_cselect_b32 s47, -1, s47
    s_and_b32 s47, s47, 0xffff
    s_cbranch_scc1 P2_sweep
P2_swept:
    s_add_u32 s49, s49, 1
    s_cmp_ge_u32 s49, 11
    s_cbranch_scc1 P2_pdone
    s_cmp_ge_u32 s48, 1
    s_cbranch_scc1 P2_ff0
    s_call_b64 s[42:43], P2_next
P2_ff0:
    v_cmp_lt_u32 vcc, s45, v40
    s_cbranch_vccz P2_have2
    s_call_b64 s[42:43], P2_ensure
P2_have2:
    v_bfe_u32 v24, v40, 1, 15
    v_mad_u32_u24 v14, v24, 12, v2
    v_lshrrev_b32 v13, 16, v40
    v_and_b32 v24, 0xfffe, v40
    v_sub_u32 v13, v13, v24
    v_and_b32 v24, 1, v40
    v_cmp_eq_u32 s[84:85], 1, v24
    v_cmp_lt_u32 s[86:87], 32, v13
    v_mov_b32 v40, v41
    v_mov_b32 v41, v42
    v_mov_b32 v42, v43
    v_mov_b32 v43, v44
    v_mov_b32 v44, v45
    v_mov_b32 v45, v46
    v_mov_b32 v46, v47
    v_mov_b32 v47, v48
    v_mov_b32 v48, v49
    v_mov_b32 v49, v50
    v_mov_b32 v50, v51
    v_add_u32_dpp v24, v14, v1 row_newbcast:0 row_mask:0xf bank_mask:0xf
    v_sub_u32_dpp v25, v13, v8 row_newbcast:0 row_mask:0xf bank_mask:0xf
    v_bitop3_b32 v24, v25, v9, v24 bitop3:0xea
    buffer_load_dwordx3 v[64:66], v24, s[12:15], 0 offen sc1
    v_add_u32_dpp v16, v14, v1 row_newbcast:1 row_mask:0xf bank_mask:0xf
    v_sub_u32_dpp v17, v13, v8 row_newbcast:1 row_mask:0xf bank_mask:0xf
    v_bitop3_b32 v16, v17, v9, v16 bitop3:0xea
    buffer_load_dwordx3 v[68:70], v16, s[12:15], 0 offen sc1
    v_add_u32_dpp v24, v14, v1 row_newbcast:2 row_mask:0xf bank_mask:0xf
    v_sub_u32_dpp v25, v13, v8 row_newbcast:2 row_mask:0xf bank_mask:0xf
    v_bitop3_b32 v24, v25, v9, v24 bitop3:0xea
    buffer_load_dwordx3 v[72:74], v24, s[12:15], 0 offen sc1
    v_add_u32_dpp v16, v14, v1 row_newbcast:3 row_mask:0xf bank_mask:0xf
    v_sub_u32_dpp v17, v13, v8 row_newbcast:3 row_mask:0xf bank_mask:0xf
    v_bitop3_b32 v16, v17, v9, v16 bitop3:0xea
    buffer_load_dwordx3 v[76:78], v16, s[12:15], 0 offen sc1
    v_add_u32_dpp v24, v14, v1 row_newbcast:4 row_mask:0xf bank_mask:0xf
    v_sub_u32_dpp v25, v13, v8 row_newbcast:4 row_mask:0xf bank_mask:0xf
    v_bitop3_b32 v24, v25, v9, v24 bitop3:0xea
    buffer_load_dwordx3 v[80:82], v24, s[12:15], 0 offen sc1
    v_add_u32_dpp v16, v14, v1 row_newbcast:5 row_mask:0xf bank_mask:0xf
    v_sub_u32_dpp v17, v13, v8 row_newbcast:5 row_mask:0xf bank_mask:0xf
    v_bitop3_b32 v16, v17, v9, v16 bitop3:0xea
    buffer_load_dwordx3 v[84:86], v16, s[12:15], 0 offen sc1
    v_add_u32_dpp v24, v14, v1 row_newbcast:6 row_mask:0xf bank_mask:0xf
    v_sub_u32_dpp v25, v13, v8 row_newbcast:6 row_mask:0xf bank_mask:0xf
    v_bitop3_b32 v24, v25, v9, v24 bitop3:0xea
    buffer_load_dwordx3 v[88:90], v24, s[12:15], 0 offen sc1
    v_add_u32_dpp v16, v14, v1 row_newbcast:7 row_mask:0xf bank_mask:0xf
    v_sub_u32_dpp v17, v13, v8 row_newbcast:7 row_mask:0xf bank_mask:0xf
    v_bitop3_b32 v16, v17, v9, v16 bitop3:0xea
    buffer_load_dwordx3 v[92:94], v16, s[12:15], 0 offen sc1
    v_add_u32_dpp v24, v14, v1 row_newbcast:8 row_mask:0xf bank_mask:0xf
    v_sub_u32_dpp v25, v13, v8 row_newbcast:8 row_mask:0xf bank_mask:0xf
    v_bitop3_b32 v24, v25, v9, v24 bitop3:0xea
    buffer_load_dwordx3 v[96:98], v24, s[12:15], 0 offen sc1
    v_add_u32_dpp v16, v14, v1 row_newbcast:9 row_mask:0xf bank_mask:0xf
    v_sub_u32_dpp v17, v13, v8 row_newbcast:9 row_mask:0xf bank_mask:0xf
    v_bitop3_b32 v16, v17, v9, v16 bitop3:0xea
    buffer_load_dwordx3 v[100:102], v16, s[12:15], 0 offen sc1
    v_add_u32_dpp v24, v14, v1 row_newbcast:10 row_mask:0xf bank_mask:0xf
    v_sub_u32_dpp v25, v13, v8 row_newbcast:10 row_mask:0xf bank_mask:0xf
    v_bitop3_b32 v24, v25, v9, v24 bitop3:0xea
    buffer_load_dwordx3 v[104:106], v24, s[12:15], 0 offen sc1
    v_add_u32_dpp v16, v14, v1 row_newbcast:11 row_mask:0xf bank_mask:0xf
    v_sub_u32_dpp v17, v13, v8 row_newbcast:11 row_mask:0xf bank_mask:0xf
    v_bitop3_b32 v16, v17, v9, v16 bitop3:0xea
    buffer_load_dwordx3 v[108:110], v16, s[12:15], 0 offen sc1
    v_add_u32_dpp v24, v14, v1 row_newbcast:12 row_mask:0xf bank_mask:0xf
    v_sub_u32_dpp v25, v13, v8 row_newbcast:12 row_mask:0xf bank_mask:0xf
    v_bitop3_b32 v24, v25, v9, v24 bitop3:0xea
    buffer_load_dwordx3 v[112:114], v24, s[12:15], 0 offen sc1
    v_add_u32_dpp v16, v14, v1 row_newbcast:13 row_mask:0xf bank_mask:0xf
    v_sub_u32_dpp v17, v13, v8 row_newbcast:13 row_mask:0xf bank_mask:0xf
    v_bitop3_b32 v16, v17, v9, v16 bitop3:0xea
    buffer_load_dwordx3 v[116:118], v16, s[12:15], 0 offen sc1
    v_add_u32_dpp v24, v14, v1 row_newbcast:14 row_mask:0xf bank_mask:0xf
    v_sub_u32_dpp v25, v13, v8 row_newbcast:14 row_mask:0xf bank_mask:0xf
    v_bitop3_b32 v24, v25, v9, v24 bitop3:0xea
    buffer_load_dwordx3 v[120:122], v24, s[12:15], 0 offen sc1
    v_add_u32_dpp v16, v14, v1 row_newbcast:15 row_mask:0xf bank_mask:0xf
    v_sub_u32_dpp v17, v13, v8 row_newbcast:15 row_mask:0xf bank_mask:0xf
    v_bitop3_b32 v16, v17, v9, v16 bitop3:0xea
    buffer_load_dwordx3 v[124:126], v16, s[12:15], 0 offen sc1
    s_cmp_ge_u32 s48, s49
    s_cbranch_scc1 P2_ff1
    s_call_b64 s[42:43], P2_next
P2_ff1:
    s_cmp_lg_u32 s49, 3
    s_cbranch_scc1 P2_nwd
    s_load_dwordx2 s[36:37], s[0:1], 24
    s_lshl_b32 s40, s2, 2
    s_add_u32 s40, s40, s3
    s_mulk_i32 s40, 13
    s_min_u32 s40, s40, 12487
    s_lshl_b32 s40, s40, 7
    s_waitcnt lgkmcnt(0)
    s_add_u32 s36, s36, s40
    s_addc_u32 s37, s37, 0
    s_load_dwordx2 s[38:39], s[36:37], 60
    s_load_dwordx2 s[38:39], s[36:37], 188
    s_load_dwordx2 s[38:39], s[36:37], 316
    s_load_dwordx2 s[38:39], s[36:37], 444
    s_load_dwordx2 s[38:39], s[36:37], 572
    s_load_dwordx2 s[38:39], s[36:37], 700
    s_load_dwordx2 s[38:39], s[36:37], 828
    s_load_dwordx2 s[38:39], s[36:37], 956
    s_load_dwordx2 s[38:39], s[36:37], 1084
    s_load_dwordx2 s[38:39], s[36:37], 1212
    s_load_dwordx2 s[38:39], s[36:37], 1340
    s_load_dwordx2 s[38:39], s[36:37], 1468
    s_load_dwordx2 s[38:39], s[36:37], 1596
P2_nwd:
    s_sub_u32 s4, s49, 0
    s_cmp_lt_u32 s4, 5
    s_cbranch_scc1 P2_nowarm
    s_cmp_ge_u32 s4, 11
    s_cbranch_scc1 P2_nowarm
    s_mul_i32 s40, s4, 18196
    s_lshr_b32 s41, s2, 1
    s_lshl_b32 s41, s41, 2
    s_add_u32 s41, s41, s3
    s_mul_i32 s41, s41, 36
    s_add_u32 s40, s40, s41
    s_add_u32 s40, s40, 11250
    s_bitcmp1_b32 s2, 0
    s_cselect_b32 s41, 18, 0
    s_add_u32 s40, s40, s41
    s_cmp_ge_u32 s40, 200000
    s_cbranch_scc1 P2_we3
    s_min_u32 s40, s40, 199982
    s_lshl_b32 s40, s40, 7
    s_add_u32 s36, s8, s40
    s_addc_u32 s37, s9, 0
    s_load_dwordx2 s[38:39], s[36:37], 60
    s_load_dwordx2 s[38:39], s[36:37], 188
    s_load_dwordx2 s[38:39], s[36:37], 316
    s_load_dwordx2 s[38:39], s[36:37], 444
    s_load_dwordx2 s[38:39], s[36:37], 572
    s_load_dwordx2 s[38:39], s[36:37], 700
    s_load_dwordx2 s[38:39], s[36:37], 828
    s_load_dwordx2 s[38:39], s[36:37], 956
    s_load_dwordx2 s[38:39], s[36:37], 1084
    s_load_dwordx2 s[38:39], s[36:37], 1212
    s_load_dwordx2 s[38:39], s[36:37], 1340
    s_load_dwordx2 s[38:39], s[36:37], 1468
    s_load_dwordx2 s[38:39], s[36:37], 1596
    s_load_dwordx2 s[38:39], s[36:37], 1724
    s_load_dwordx2 s[38:39], s[36:37], 1852
    s_load_dwordx2 s[38:39], s[36:37], 1980
    s_load_dwordx2 s[38:39], s[36:37], 2108
    s_load_dwordx2 s[38:39], s[36:37], 2236
P2_we3:
P2_nowarm:
    v_cmp_lt_u32 vcc, s45, v40
    s_cbranch_vccz P2_have4
    s_call_b64 s[42:43], P2_ensure
P2_have4:
    s_cmp_lg_u32 s48, 3
    s_cbranch_scc1 P2_next1
    s_call_b64 s[96:97], P2_pubb
P2_next1:
    s_branch P2_pslice
P2_next:
    s_add_u32 s48, s48, 1
    v_mov_b32 v24, s48
    s_waitcnt lgkmcnt(0)
    ds_write_b32 v26, v24
    v_xor_b32 v5, 1024, v5
    s_setpc_b64 s[42:43]
P2_wait:
    s_add_u32 s50, s48, 1
    s_lshr_b32 s50, s50, 1
    s_mul_i32 s50, s50, 12
    s_and_b32 s51, s48, 1
    s_lshl_b32 s51, s51, 2
    s_add_u32 s51, s51, 161904
    v_mov_b32 v25, s51
P2_pwn:
    ds_read_b32 v24, v25
    s_waitcnt lgkmcnt(0)
    v_readfirstlane_b32 s51, v24
    s_cmp_ge_u32 s51, s50
    s_cbranch_scc1 P2_pgn
    s_sleep 2
    s_branch P2_pwn
P2_pgn:
    s_cmp_lg_u32 s48, 3
    s_cbranch_scc1 P2_next2
    s_call_b64 s[96:97], P2_pubb
P2_next2:
    s_setpc_b64 s[42:43]
P2_pubb:
    v_mov_b32 v28, 161896
    v_mov_b32 v29, 1
    s_mov_b64 exec, 1
    ds_add_rtn_u32 v29, v28, v29
    s_mov_b64 exec, -1
    s_waitcnt lgkmcnt(0)
    v_readfirstlane_b32 s40, v29
    s_cmp_lg_u32 s40, 0
    s_cbranch_scc1 P2_norelb
    v_mov_b32 v28, 161888
P2_lwb:
    ds_read_b32 v29, v28
    s_waitcnt lgkmcnt(0)
    v_readfirstlane_b32 s40, v29
    s_cmp_ge_u32 s40, 12
    s_cbranch_scc1 P2_lgb
    s_sleep 1
    s_branch P2_lwb
P2_lgb:
    v_mov_b32 v28, 0
    v_mov_b32 v29, 1
    s_mov_b64 exec, 1
    buffer_atomic_add v29, v28, s[24:27], 0 offen offset:32 sc0 sc1
    s_mov_b64 exec, -1
    s_waitcnt vmcnt(0)
    v_readfirstlane_b32 s40, v29
    s_cmp_lg_u32 s40, 255
    s_cbranch_scc1 P2_norelb
    s_mov_b64 exec, 1
    buffer_store_dword v29, v28, s[24:27], 0 offen offset:132 sc1
    s_mov_b64 exec, -1
P2_norelb:
    s_setpc_b64 s[96:97]
P2_ensure:
    s_mov_b32 s51, 0
P2_polla:
    buffer_load_dword v24, v6, s[24:27], 0 offen offset:128 sc1
    s_add_u32 s51, s51, 1
    s_cmp_gt_u32 s51, 1000000
    s_cbranch_scc1 P2_giveup
    s_waitcnt vmcnt(0)
    v_cmp_eq_u32 vcc, 0, v24
    s_cbranch_vccz P2_polleda
    s_sleep 24
    s_branch P2_polla
P2_polleda:
    s_mov_b32 s45, 1644232703
    v_cmp_lt_u32 vcc, s45, v40
    s_cbranch_vccz P2_ens1
    s_lshl_b32 s40, 1, s3
    v_mov_b32 v24, 161900
    v_mov_b32 v25, s40
    s_mov_b64 exec, 1
    ds_or_b32 v24, v25
    s_mov_b64 exec, -1
    s_call_b64 s[96:97], P2_pubb
    s_mov_b32 s51, 0
P2_pollb:
    buffer_load_dword v24, v6, s[24:27], 0 offen offset:132 sc1
    s_add_u32 s51, s51, 1
    s_cmp_gt_u32 s51, 1000000
    s_cbranch_scc1 P2_giveup
    s_waitcnt vmcnt(0)
    v_cmp_eq_u32 vcc, 0, v24
    s_cbranch_vccz P2_polledb
    s_sleep 24
    s_branch P2_pollb
P2_polledb:
    s_mov_b32 s45, -1
P2_ens1:
    s_setpc_b64 s[42:43]
P2_stallf0:
    v_cmp_lt_u32 s[88:89], s5, v18
    v_cmp_lt_u32 s[90:91], s5, v19
    s_call_b64 s[42:43], P2_next
    s_call_b64 s[42:43], P2_wait
    s_branch P2_retryf0
P2_moref0:
    s_lshl_b64 exec, s[82:83], 0
    v_max_u32 v10, 32, v10
    v_subrev_u32 v10, 32, v10
    v_add_u32 v11, 192, v11
    s_mov_b64 exec, -1
    v_sub_u32_dpp v25, v10, v8 row_newbcast:0 row_mask:0xf bank_mask:0xf
    v_add_u32_dpp v24, v11, v1 row_newbcast:0 row_mask:0xf bank_mask:0xf
    v_bitop3_b32 v24, v25, v9, v24 bitop3:0xea
    buffer_load_dwordx3 v[64:66], v24, s[12:15], 0 offen sc1
    v_cmp_lt_u32 vcc, 32, v10
    s_lshr_b64 s[92:93], vcc, 0
    s_and_b64 s[92:93], s[92:93], s[82:83]
    s_andn2_b64 s[54:55], s[54:55], s[82:83]
    s_or_b64 s[54:55], s[54:55], s[92:93]
    v_sub_co_u32_dpp v25, vcc, v10, v7 row_newbcast:0 row_mask:0xf bank_mask:0xf
    s_not_b64 s[90:91], vcc
    s_nop 0
    v_sub_co_u32_dpp v25, vcc, v10, v8 row_newbcast:0 row_mask:0xf bank_mask:0xf
    s_not_b64 s[88:89], vcc
    s_waitcnt vmcnt(0)
    s_branch P2_retryf0
P2_stallf1:
    v_cmp_lt_u32 s[88:89], s5, v18
    v_cmp_lt_u32 s[90:91], s5, v19
    s_call_b64 s[42:43], P2_next
    s_call_b64 s[42:43], P2_wait
    s_branch P2_retryf1
P2_moref1:
    s_lshl_b64 exec, s[82:83], 1
    v_max_u32 v10, 32, v10
    v_subrev_u32 v10, 32, v10
    v_add_u32 v11, 192, v11
    s_mov_b64 exec, -1
    v_sub_u32_dpp v25, v10, v8 row_newbcast:1 row_mask:0xf bank_mask:0xf
    v_add_u32_dpp v24, v11, v1 row_newbcast:1 row_mask:0xf bank_mask:0xf
    v_bitop3_b32 v24, v25, v9, v24 bitop3:0xea
    buffer_load_dwordx3 v[68:70], v24, s[12:15], 0 offen sc1
    v_cmp_lt_u32 vcc, 32, v10
    s_lshr_b64 s[92:93], vcc, 1
    s_and_b64 s[92:93], s[92:93], s[82:83]
    s_andn2_b64 s[54:55], s[54:55], s[82:83]
    s_or_b64 s[54:55], s[54:55], s[92:93]
    v_sub_co_u32_dpp v25, vcc, v10, v7 row_newbcast:1 row_mask:0xf bank_mask:0xf
    s_not_b64 s[90:91], vcc
    s_nop 0
    v_sub_co_u32_dpp v25, vcc, v10, v8 row_newbcast:1 row_mask:0xf bank_mask:0xf
    s_not_b64 s[88:89], vcc
    s_waitcnt vmcnt(0)
    s_branch P2_retryf1
P2_stallf2:
    v_cmp_lt_u32 s[88:89], s5, v18
    v_cmp_lt_u32 s[90:91], s5, v19
    s_call_b64 s[42:43], P2_next
    s_call_b64 s[42:43], P2_wait
    s_branch P2_retryf2
P2_moref2:
    s_lshl_b64 exec, s[82:83], 2
    v_max_u32 v10, 32, v10
    v_subrev_u32 v10, 32, v10
    v_add_u32 v11, 192, v11
    s_mov_b64 exec, -1
    v_sub_u32_dpp v25, v10, v8 row_newbcast:2 row_mask:0xf bank_mask:0xf
    v_add_u32_dpp v24, v11, v1 row_newbcast:2 row_mask:0xf bank_mask:0xf
    v_bitop3_b32 v24, v25, v9, v24 bitop3:0xea
    buffer_load_dwordx3 v[72:74], v24, s[12:15], 0 offen sc1
    v_cmp_lt_u32 vcc, 32, v10
    s_lshr_b64 s[92:93], vcc, 2
    s_and_b64 s[92:93], s[92:93], s[82:83]
    s_andn2_b64 s[54:55], s[54:55], s[82:83]
    s_or_b64 s[54:55], s[54:55], s[92:93]
    v_sub_co_u32_dpp v25, vcc, v10, v7 row_newbcast:2 row_mask:0xf bank_mask:0xf
    s_not_b64 s[90:91], vcc
    s_nop 0
    v_sub_co_u32_dpp v25, vcc, v10, v8 row_newbcast:2 row_mask:0xf bank_mask:0xf
    s_not_b64 s[88:89], vcc
    s_waitcnt vmcnt(0)
    s_branch P2_retryf2
P2_stallf3:
    v_cmp_lt_u32 s[88:89], s5, v18
    v_cmp_lt_u32 s[90:91], s5, v19
    s_call_b64 s[42:43], P2_next
    s_call_b64 s[42:43], P2_wait
    s_branch P2_retryf3
P2_moref3:
    s_lshl_b64 exec, s[82:83], 3
    v_max_u32 v10, 32, v10
    v_subrev_u32 v10, 32, v10
    v_add_u32 v11, 192, v11
    s_mov_b64 exec, -1
    v_sub_u32_dpp v25, v10, v8 row_newbcast:3 row_mask:0xf bank_mask:0xf
    v_add_u32_dpp v24, v11, v1 row_newbcast:3 row_mask:0xf bank_mask:0xf
    v_bitop3_b32 v24, v25, v9, v24 bitop3:0xea
    buffer_load_dwordx3 v[76:78], v24, s[12:15], 0 offen sc1
    v_cmp_lt_u32 vcc, 32, v10
    s_lshr_b64 s[92:93], vcc, 3
    s_and_b64 s[92:93], s[92:93], s[82:83]
    s_andn2_b64 s[54:55], s[54:55], s[82:83]
    s_or_b64 s[54:55], s[54:55], s[92:93]
    v_sub_co_u32_dpp v25, vcc, v10, v7 row_newbcast:3 row_mask:0xf bank_mask:0xf
    s_not_b64 s[90:91], vcc
    s_nop 0
    v_sub_co_u32_dpp v25, vcc, v10, v8 row_newbcast:3 row_mask:0xf bank_mask:0xf
    s_not_b64 s[88:89], vcc
    s_waitcnt vmcnt(0)
    s_branch P2_retryf3
P2_stallf4:
    v_cmp_lt_u32 s[88:89], s5, v18
    v_cmp_lt_u32 s[90:91], s5, v19
    s_call_b64 s[42:43], P2_next
    s_call_b64 s[42:43], P2_wait
    s_branch P2_retryf4
P2_moref4:
    s_lshl_b64 exec, s[82:83], 4
    v_max_u32 v10, 32, v10
    v_subrev_u32 v10, 32, v10
    v_add_u32 v11, 192, v11
    s_mov_b64 exec, -1
    v_sub_u32_dpp v25, v10, v8 row_newbcast:4 row_mask:0xf bank_mask:0xf
    v_add_u32_dpp v24, v11, v1 row_newbcast:4 row_mask:0xf bank_mask:0xf
    v_bitop3_b32 v24, v25, v9, v24 bitop3:0xea
    buffer_load_dwordx3 v[80:82], v24, s[12:15], 0 offen sc1
    v_cmp_lt_u32 vcc, 32, v10
    s_lshr_b64 s[92:93], vcc, 4
    s_and_b64 s[92:93], s[92:93], s[82:83]
    s_andn2_b64 s[54:55], s[54:55], s[82:83]
    s_or_b64 s[54:55], s[54:55], s[92:93]
    v_sub_co_u32_dpp v25, vcc, v10, v7 row_newbcast:4 row_mask:0xf bank_mask:0xf
    s_not_b64 s[90:91], vcc
    s_nop 0
    v_sub_co_u32_dpp v25, vcc, v10, v8 row_newbcast:4 row_mask:0xf bank_mask:0xf
    s_not_b64 s[88:89], vcc
    s_waitcnt vmcnt(0)
    s_branch P2_retryf4
P2_stallf5:
    v_cmp_lt_u32 s[88:89], s5, v18
    v_cmp_lt_u32 s[90:91], s5, v19
    s_call_b64 s[42:43], P2_next
    s_call_b64 s[42:43], P2_wait
    s_branch P2_retryf5
P2_moref5:
    s_lshl_b64 exec, s[82:83], 5
    v_max_u32 v10, 32, v10
    v_subrev_u32 v10, 32, v10
    v_add_u32 v11, 192, v11
    s_mov_b64 exec, -1
    v_sub_u32_dpp v25, v10, v8 row_newbcast:5 row_mask:0xf bank_mask:0xf
    v_add_u32_dpp v24, v11, v1 row_newbcast:5 row_mask:0xf bank_mask:0xf
    v_bitop3_b32 v24, v25, v9, v24 bitop3:0xea
    buffer_load_dwordx3 v[84:86], v24, s[12:15], 0 offen sc1
    v_cmp_lt_u32 vcc, 32, v10
    s_lshr_b64 s[92:93], vcc, 5
    s_and_b64 s[92:93], s[92:93], s[82:83]
    s_andn2_b64 s[54:55], s[54:55], s[82:83]
    s_or_b64 s[54:55], s[54:55], s[92:93]
    v_sub_co_u32_dpp v25, vcc, v10, v7 row_newbcast:5 row_mask:0xf bank_mask:0xf
    s_not_b64 s[90:91], vcc
    s_nop 0
    v_sub_co_u32_dpp v25, vcc, v10, v8 row_newbcast:5 row_mask:0xf bank_mask:0xf
    s_not_b64 s[88:89], vcc
    s_waitcnt vmcnt(0)
    s_branch P2_retryf5
P2_stallf6:
    v_cmp_lt_u32 s[88:89], s5, v18
    v_cmp_lt_u32 s[90:91], s5, v19
    s_call_b64 s[42:43], P2_next
    s_call_b64 s[42:43], P2_wait
    s_branch P2_retryf6
P2_moref6:
    s_lshl_b64 exec, s[82:83], 6
    v_max_u32 v10, 32, v10
    v_subrev_u32 v10, 32, v10
    v_add_u32 v11, 192, v11
    s_mov_b64 exec, -1
    v_sub_u32_dpp v25, v10, v8 row_newbcast:6 row_mask:0xf bank_mask:0xf
    v_add_u32_dpp v24, v11, v1 row_newbcast:6 row_mask:0xf bank_mask:0xf
    v_bitop3_b32 v24, v25, v9, v24 bitop3:0xea
    buffer_load_dwordx3 v[88:90], v24, s[12:15], 0 offen sc1
    v_cmp_lt_u32 vcc, 32, v10
    s_lshr_b64 s[92:93], vcc, 6
    s_and_b64 s[92:93], s[92:93], s[82:83]
    s_andn2_b64 s[54:55], s[54:55], s[82:83]
    s_or_b64 s[54:55], s[54:55], s[92:93]
    v_sub_co_u32_dpp v25, vcc, v10, v7 row_newbcast:6 row_mask:0xf bank_mask:0xf
    s_not_b64 s[90:91], vcc
    s_nop 0
    v_sub_co_u32_dpp v25, vcc, v10, v8 row_newbcast:6 row_mask:0xf bank_mask:0xf
    s_not_b64 s[88:89], vcc
    s_waitcnt vmcnt(0)
    s_branch P2_retryf6
P2_stallf7:
    v_cmp_lt_u32 s[88:89], s5, v18
    v_cmp_lt_u32 s[90:91], s5, v19
    s_call_b64 s[42:43], P2_next
    s_call_b64 s[42:43], P2_wait
    s_branch P2_retryf7
P2_moref7:
    s_lshl_b64 exec, s[82:83], 7
    v_max_u32 v10, 32, v10
    v_subrev_u32 v10, 32, v10
    v_add_u32 v11, 192, v11
    s_mov_b64 exec, -1
    v_sub_u32_dpp v25, v10, v8 row_newbcast:7 row_mask:0xf bank_mask:0xf
    v_add_u32_dpp v24, v11, v1 row_newbcast:7 row_mask:0xf bank_mask:0xf
    v_bitop3_b32 v24, v25, v9, v24 bitop3:0xea
    buffer_load_dwordx3 v[92:94], v24, s[12:15], 0 offen sc1
    v_cmp_lt_u32 vcc, 32, v10
    s_lshr_b64 s[92:93], vcc, 7
    s_and_b64 s[92:93], s[92:93], s[82:83]
    s_andn2_b64 s[54:55], s[54:55], s[82:83]
    s_or_b64 s[54:55], s[54:55], s[92:93]
    v_sub_co_u32_dpp v25, vcc, v10, v7 row_newbcast:7 row_mask:0xf bank_mask:0xf
    s_not_b64 s[90:91], vcc
    s_nop 0
    v_sub_co_u32_dpp v25, vcc, v10, v8 row_newbcast:7 row_mask:0xf bank_mask:0xf
    s_not_b64 s[88:89], vcc
    s_waitcnt vmcnt(0)
    s_branch P2_retryf7
P2_stallf8:
    v_cmp_lt_u32 s[88:89], s5, v18
    v_cmp_lt_u32 s[90:91], s5, v19
    s_call_b64 s[42:43], P2_next
    s_call_b64 s[42:43], P2_wait
    s_branch P2_retryf8
P2_moref8:
    s_lshl_b64 exec, s[82:83], 8
    v_max_u32 v10, 32, v10
    v_subrev_u32 v10, 32, v10
    v_add_u32 v11, 192, v11
    s_mov_b64 exec, -1
    v_sub_u32_dpp v25, v10, v8 row_newbcast:8 row_mask:0xf bank_mask:0xf
    v_add_u32_dpp v24, v11, v1 row_newbcast:8 row_mask:0xf bank_mask:0xf
    v_bitop3_b32 v24, v25, v9, v24 bitop3:0xea
    buffer_load_dwordx3 v[96:98], v24, s[12:15], 0 offen sc1
    v_cmp_lt_u32 vcc, 32, v10
    s_lshr_b64 s[92:93], vcc, 8
    s_and_b64 s[92:93], s[92:93], s[82:83]
    s_andn2_b64 s[54:55], s[54:55], s[82:83]
    s_or_b64 s[54:55], s[54:55], s[92:93]
    v_sub_co_u32_dpp v25, vcc, v10, v7 row_newbcast:8 row_mask:0xf bank_mask:0xf
    s_not_b64 s[90:91], vcc
    s_nop 0
    v_sub_co_u32_dpp v25, vcc, v10, v8 row_newbcast:8 row_mask:0xf bank_mask:0xf
    s_not_b64 s[88:89], vcc
    s_waitcnt vmcnt(0)
    s_branch P2_retryf8
P2_stallf9:
    v_cmp_lt_u32 s[88:89], s5, v18
    v_cmp_lt_u32 s[90:91], s5, v19
    s_call_b64 s[42:43], P2_next
    s_call_b64 s[42:43], P2_wait
    s_branch P2_retryf9
P2_moref9:
    s_lshl_b64 exec, s[82:83], 9
    v_max_u32 v10, 32, v10
    v_subrev_u32 v10, 32, v10
    v_add_u32 v11, 192, v11
    s_mov_b64 exec, -1
    v_sub_u32_dpp v25, v10, v8 row_newbcast:9 row_mask:0xf bank_mask:0xf
    v_add_u32_dpp v24, v11, v1 row_newbcast:9 row_mask:0xf bank_mask:0xf
    v_bitop3_b32 v24, v25, v9, v24 bitop3:0xea
    buffer_load_dwordx3 v[100:102], v24, s[12:15], 0 offen sc1
    v_cmp_lt_u32 vcc, 32, v10
    s_lshr_b64 s[92:93], vcc, 9
    s_and_b64 s[92:93], s[92:93], s[82:83]
    s_andn2_b64 s[54:55], s[54:55], s[82:83]
    s_or_b64 s[54:55], s[54:55], s[92:93]
    v_sub_co_u32_dpp v25, vcc, v10, v7 row_newbcast:9 row_mask:0xf bank_mask:0xf
    s_not_b64 s[90:91], vcc
    s_nop 0
    v_sub_co_u32_dpp v25, vcc, v10, v8 row_newbcast:9 row_mask:0xf bank_mask:0xf
    s_not_b64 s[88:89], vcc
    s_waitcnt vmcnt(0)
    s_branch P2_retryf9
P2_stallf10:
    v_cmp_lt_u32 s[88:89], s5, v18
    v_cmp_lt_u32 s[90:91], s5, v19
    s_call_b64 s[42:43], P2_next
    s_call_b64 s[42:43], P2_wait
    s_branch P2_retryf10
P2_moref10:
    s_lshl_b64 exec, s[82:83], 10
    v_max_u32 v10, 32, v10
    v_subrev_u32 v10, 32, v10
    v_add_u32 v11, 192, v11
    s_mov_b64 exec, -1
    v_sub_u32_dpp v25, v10, v8 row_newbcast:10 row_mask:0xf bank_mask:0xf
    v_add_u32_dpp v24, v11, v1 row_newbcast:10 row_mask:0xf bank_mask:0xf
    v_bitop3_b32 v24, v25, v9, v24 bitop3:0xea
    buffer_load_dwordx3 v[104:106], v24, s[12:15], 0 offen sc1
    v_cmp_lt_u32 vcc, 32, v10
    s_lshr_b64 s[92:93], vcc, 10
    s_and_b64 s[92:93], s[92:93], s[82:83]
    s_andn2_b64 s[54:55], s[54:55], s[82:83]
    s_or_b64 s[54:55], s[54:55], s[92:93]
    v_sub_co_u32_dpp v25, vcc, v10, v7 row_newbcast:10 row_mask:0xf bank_mask:0xf
    s_not_b64 s[90:91], vcc
    s_nop 0
    v_sub_co_u32_dpp v25, vcc, v10, v8 row_newbcast:10 row_mask:0xf bank_mask:0xf
    s_not_b64 s[88:89], vcc
    s_waitcnt vmcnt(0)
    s_branch P2_retryf10
P2_stallf11:
    v_cmp_lt_u32 s[88:89], s5, v18
    v_cmp_lt_u32 s[90:91], s5, v19
    s_call_b64 s[42:43], P2_next
    s_call_b64 s[42:43], P2_wait
    s_branch P2_retryf11
P2_moref11:
    s_lshl_b64 exec, s[82:83], 11
    v_max_u32 v10, 32, v10
    v_subrev_u32 v10, 32, v10
    v_add_u32 v11, 192, v11
    s_mov_b64 exec, -1
    v_sub_u32_dpp v25, v10, v8 row_newbcast:11 row_mask:0xf bank_mask:0xf
    v_add_u32_dpp v24, v11, v1 row_newbcast:11 row_mask:0xf bank_mask:0xf
    v_bitop3_b32 v24, v25, v9, v24 bitop3:0xea
    buffer_load_dwordx3 v[108:110], v24, s[12:15], 0 offen sc1
    v_cmp_lt_u32 vcc, 32, v10
    s_lshr_b64 s[92:93], vcc, 11
    s_and_b64 s[92:93], s[92:93], s[82:83]
    s_andn2_b64 s[54:55], s[54:55], s[82:83]
    s_or_b64 s[54:55], s[54:55], s[92:93]
    v_sub_co_u32_dpp v25, vcc, v10, v7 row_newbcast:11 row_mask:0xf bank_mask:0xf
    s_not_b64 s[90:91], vcc
    s_nop 0
    v_sub_co_u32_dpp v25, vcc, v10, v8 row_newbcast:11 row_mask:0xf bank_mask:0xf
    s_not_b64 s[88:89], vcc
    s_waitcnt vmcnt(0)
    s_branch P2_retryf11
P2_stallf12:
    v_cmp_lt_u32 s[88:89], s5, v18
    v_cmp_lt_u32 s[90:91], s5, v19
    s_call_b64 s[42:43], P2_next
    s_call_b64 s[42:43], P2_wait
    s_branch P2_retryf12
P2_moref12:
    s_lshl_b64 exec, s[82:83], 12
    v_max_u32 v10, 32, v10
    v_subrev_u32 v10, 32, v10
    v_add_u32 v11, 192, v11
    s_mov_b64 exec, -1
    v_sub_u32_dpp v25, v10, v8 row_newbcast:12 row_mask:0xf bank_mask:0xf
    v_add_u32_dpp v24, v11, v1 row_newbcast:12 row_mask:0xf bank_mask:0xf
    v_bitop3_b32 v24, v25, v9, v24 bitop3:0xea
    buffer_load_dwordx3 v[112:114], v24, s[12:15], 0 offen sc1
    v_cmp_lt_u32 vcc, 32, v10
    s_lshr_b64 s[92:93], vcc, 12
    s_and_b64 s[92:93], s[92:93], s[82:83]
    s_andn2_b64 s[54:55], s[54:55], s[82:83]
    s_or_b64 s[54:55], s[54:55], s[92:93]
    v_sub_co_u32_dpp v25, vcc, v10, v7 row_newbcast:12 row_mask:0xf bank_mask:0xf
    s_not_b64 s[90:91], vcc
    s_nop 0
    v_sub_co_u32_dpp v25, vcc, v10, v8 row_newbcast:12 row_mask:0xf bank_mask:0xf
    s_not_b64 s[88:89], vcc
    s_waitcnt vmcnt(0)
    s_branch P2_retryf12
P2_stallf13:
    v_cmp_lt_u32 s[88:89], s5, v18
    v_cmp_lt_u32 s[90:91], s5, v19
    s_call_b64 s[42:43], P2_next
    s_call_b64 s[42:43], P2_wait
    s_branch P2_retryf13
P2_moref13:
    s_lshl_b64 exec, s[82:83], 13
    v_max_u32 v10, 32, v10
    v_subrev_u32 v10, 32, v10
    v_add_u32 v11, 192, v11
    s_mov_b64 exec, -1
    v_sub_u32_dpp v25, v10, v8 row_newbcast:13 row_mask:0xf bank_mask:0xf
    v_add_u32_dpp v24, v11, v1 row_newbcast:13 row_mask:0xf bank_mask:0xf
    v_bitop3_b32 v24, v25, v9, v24 bitop3:0xea
    buffer_load_dwordx3 v[116:118], v24, s[12:15], 0 offen sc1
    v_cmp_lt_u32 vcc, 32, v10
    s_lshr_b64 s[92:93], vcc, 13
    s_and_b64 s[92:93], s[92:93], s[82:83]
    s_andn2_b64 s[54:55], s[54:55], s[82:83]
    s_or_b64 s[54:55], s[54:55], s[92:93]
    v_sub_co_u32_dpp v25, vcc, v10, v7 row_newbcast:13 row_mask:0xf bank_mask:0xf
    s_not_b64 s[90:91], vcc
    s_nop 0
    v_sub_co_u32_dpp v25, vcc, v10, v8 row_newbcast:13 row_mask:0xf bank_mask:0xf
    s_not_b64 s[88:89], vcc
    s_waitcnt vmcnt(0)
    s_branch P2_retryf13
P2_stallf14:
    v_cmp_lt_u32 s[88:89], s5, v18
    v_cmp_lt_u32 s[90:91], s5, v19
    s_call_b64 s[42:43], P2_next
    s_call_b64 s[42:43], P2_wait
    s_branch P2_retryf14
P2_moref14:
    s_lshl_b64 exec, s[82:83], 14
    v_max_u32 v10, 32, v10
    v_subrev_u32 v10, 32, v10
    v_add_u32 v11, 192, v11
    s_mov_b64 exec, -1
    v_sub_u32_dpp v25, v10, v8 row_newbcast:14 row_mask:0xf bank_mask:0xf
    v_add_u32_dpp v24, v11, v1 row_newbcast:14 row_mask:0xf bank_mask:0xf
    v_bitop3_b32 v24, v25, v9, v24 bitop3:0xea
    buffer_load_dwordx3 v[120:122], v24, s[12:15], 0 offen sc1
    v_cmp_lt_u32 vcc, 32, v10
    s_lshr_b64 s[92:93], vcc, 14
    s_and_b64 s[92:93], s[92:93], s[82:83]
    s_andn2_b64 s[54:55], s[54:55], s[82:83]
    s_or_b64 s[54:55], s[54:55], s[92:93]
    v_sub_co_u32_dpp v25, vcc, v10, v7 row_newbcast:14 row_mask:0xf bank_mask:0xf
    s_not_b64 s[90:91], vcc
    s_nop 0
    v_sub_co_u32_dpp v25, vcc, v10, v8 row_newbcast:14 row_mask:0xf bank_mask:0xf
    s_not_b64 s[88:89], vcc
    s_waitcnt vmcnt(0)
    s_branch P2_retryf14
P2_stallf15:
    v_cmp_lt_u32 s[88:89], s5, v18
    v_cmp_lt_u32 s[90:91], s5, v19
    s_call_b64 s[42:43], P2_next
    s_call_b64 s[42:43], P2_wait
    s_branch P2_retryf15
P2_moref15:
    s_lshl_b64 exec, s[82:83], 15
    v_max_u32 v10, 32, v10
    v_subrev_u32 v10, 32, v10
    v_add_u32 v11, 192, v11
    s_mov_b64 exec, -1
    v_sub_u32_dpp v25, v10, v8 row_newbcast:15 row_mask:0xf bank_mask:0xf
    v_add_u32_dpp v24, v11, v1 row_newbcast:15 row_mask:0xf bank_mask:0xf
    v_bitop3_b32 v24, v25, v9, v24 bitop3:0xea
    buffer_load_dwordx3 v[124:126], v24, s[12:15], 0 offen sc1
    v_cmp_lt_u32 vcc, 32, v10
    s_lshr_b64 s[92:93], vcc, 15
    s_and_b64 s[92:93], s[92:93], s[82:83]
    s_andn2_b64 s[54:55], s[54:55], s[82:83]
    s_or_b64 s[54:55], s[54:55], s[92:93]
    v_sub_co_u32_dpp v25, vcc, v10, v7 row_newbcast:15 row_mask:0xf bank_mask:0xf
    s_not_b64 s[90:91], vcc
    s_nop 0
    v_sub_co_u32_dpp v25, vcc, v10, v8 row_newbcast:15 row_mask:0xf bank_mask:0xf
    s_not_b64 s[88:89], vcc
    s_waitcnt vmcnt(0)
    s_branch P2_retryf15
P2_fix0:
    s_bitset0_b32 s47, 0
    v_cmp_lt_u32 vcc, 32, v10
    v_cmp_lt_u32 s[88:89], s5, v67
    v_cmp_lt_u32 s[90:91], s5, v30
    s_lshr_b64 s[54:55], vcc, 0
P2_retryf0:
    v_lshrrev_b32 v16, 18, v64
    v_lshrrev_b32 v17, 18, v65
    v_bitop3_b32 v16, v16, v4, v5 bitop3:0xea
    v_bitop3_b32 v17, v17, v4, v5 bitop3:0xea
    s_mov_b64 exec, s[88:89]
    ds_add_rtn_u32 v18, v16, v3
    s_mov_b64 exec, s[90:91]
    ds_add_rtn_u32 v19, v17, v3
    s_mov_b64 exec, -1
    v_and_b32 v20, 0xf00fffff, v64
    v_and_b32 v21, 0xf00fffff, v65
    s_waitcnt lgkmcnt(0)
    v_and_b32 v18, 4278452223, v18
    v_and_b32 v19, 4278452223, v19
    v_lshrrev_b32 v22, 1, v18
    v_lshrrev_b32 v23, 1, v19
    v_or_b32 v24, v18, v19
    v_cmp_lt_u32 vcc, 16777215, v24
    s_mov_b64 exec, s[88:89]
    ds_write_b32 v18, v20 offset:50144
    ds_write_b16 v22, v66 offset:2560
    s_mov_b64 exec, s[90:91]
    ds_write_b32 v19, v21 offset:50144
    ds_write_b16_d16_hi v23, v66 offset:2560
    s_mov_b64 exec, -1
    s_cbranch_vccnz P2_stallf0
    s_and_b64 s[92:93], s[54:55], s[82:83]
    s_cbranch_scc1 P2_moref0
    s_branch P2_sweep
P2_fix1:
    s_bitset0_b32 s47, 1
    v_cmp_lt_u32 vcc, 32, v10
    v_cmp_lt_u32 s[88:89], s5, v71
    v_cmp_lt_u32 s[90:91], s5, v31
    s_lshr_b64 s[54:55], vcc, 1
P2_retryf1:
    v_lshrrev_b32 v16, 18, v68
    v_lshrrev_b32 v17, 18, v69
    v_bitop3_b32 v16, v16, v4, v5 bitop3:0xea
    v_bitop3_b32 v17, v17, v4, v5 bitop3:0xea
    s_mov_b64 exec, s[88:89]
    ds_add_rtn_u32 v18, v16, v3
    s_mov_b64 exec, s[90:91]
    ds_add_rtn_u32 v19, v17, v3
    s_mov_b64 exec, -1
    v_and_b32 v20, 0xf00fffff, v68
    v_and_b32 v21, 0xf00fffff, v69
    s_waitcnt lgkmcnt(0)
    v_and_b32 v18, 4278452223, v18
    v_and_b32 v19, 4278452223, v19
    v_lshrrev_b32 v22, 1, v18
    v_lshrrev_b32 v23, 1, v19
    v_or_b32 v24, v18, v19
    v_cmp_lt_u32 vcc, 16777215, v24
    s_mov_b64 exec, s[88:89]
    ds_write_b32 v18, v20 offset:50144
    ds_write_b16 v22, v70 offset:2560
    s_mov_b64 exec, s[90:91]
    ds_write_b32 v19, v21 offset:50144
    ds_write_b16_d16_hi v23, v70 offset:2560
    s_mov_b64 exec, -1
    s_cbranch_vccnz P2_stallf1
    s_and_b64 s[92:93], s[54:55], s[82:83]
    s_cbranch_scc1 P2_moref1
    s_branch P2_sweep
P2_fix2:
    s_bitset0_b32 s47, 2
    v_cmp_lt_u32 vcc, 32, v10
    v_cmp_lt_u32 s[88:89], s5, v75
    v_cmp_lt_u32 s[90:91], s5, v32
    s_lshr_b64 s[54:55], vcc, 2
P2_retryf2:
    v_lshrrev_b32 v16, 18, v72
    v_lshrrev_b32 v17, 18, v73
    v_bitop3_b32 v16, v16, v4, v5 bitop3:0xea
    v_bitop3_b32 v17, v17, v4, v5 bitop3:0xea
    s_mov_b64 exec, s[88:89]
    ds_add_rtn_u32 v18, v16, v3
    s_mov_b64 exec, s[90:91]
    ds_add_rtn_u32 v19, v17, v3
    s_mov_b64 exec, -1
    v_and_b32 v20, 0xf00fffff, v72
    v_and_b32 v21, 0xf00fffff, v73
    s_waitcnt lgkmcnt(0)
    v_and_b32 v18, 4278452223, v18
    v_and_b32 v19, 4278452223, v19
    v_lshrrev_b32 v22, 1, v18
    v_lshrrev_b32 v23, 1, v19
    v_or_b32 v24, v18, v19
    v_cmp_lt_u32 vcc, 16777215, v24
    s_mov_b64 exec, s[88:89]
    ds_write_b32 v18, v20 offset:50144
    ds_write_b16 v22, v74 offset:2560
    s_mov_b64 exec, s[90:91]
    ds_write_b32 v19, v21 offset:50144
    ds_write_b16_d16_hi v23, v74 offset:2560
    s_mov_b64 exec, -1
    s_cbranch_vccnz P2_stallf2
    s_and_b64 s[92:93], s[54:55], s[82:83]
    s_cbranch_scc1 P2_moref2
    s_branch P2_sweep
P2_fix3:
    s_bitset0_b32 s47, 3
    v_cmp_lt_u32 vcc, 32, v10
    v_cmp_lt_u32 s[88:89], s5, v79
    v_cmp_lt_u32 s[90:91], s5, v33
    s_lshr_b64 s[54:55], vcc, 3
P2_retryf3:
    v_lshrrev_b32 v16, 18, v76
    v_lshrrev_b32 v17, 18, v77
    v_bitop3_b32 v16, v16, v4, v5 bitop3:0xea
    v_bitop3_b32 v17, v17, v4, v5 bitop3:0xea
    s_mov_b64 exec, s[88:89]
    ds_add_rtn_u32 v18, v16, v3
    s_mov_b64 exec, s[90:91]
    ds_add_rtn_u32 v19, v17, v3
    s_mov_b64 exec, -1
    v_and_b32 v20, 0xf00fffff, v76
    v_and_b32 v21, 0xf00fffff, v77
    s_waitcnt lgkmcnt(0)
    v_and_b32 v18, 4278452223, v18
    v_and_b32 v19, 4278452223, v19
    v_lshrrev_b32 v22, 1, v18
    v_lshrrev_b32 v23, 1, v19
    v_or_b32 v24, v18, v19
    v_cmp_lt_u32 vcc, 16777215, v24
    s_mov_b64 exec, s[88:89]
    ds_write_b32 v18, v20 offset:50144
    ds_write_b16 v22, v78 offset:2560
    s_mov_b64 exec, s[90:91]
    ds_write_b32 v19, v21 offset:50144
    ds_write_b16_d16_hi v23, v78 offset:2560
    s_mov_b64 exec, -1
    s_cbranch_vccnz P2_stallf3
    s_and_b64 s[92:93], s[54:55], s[82:83]
    s_cbranch_scc1 P2_moref3
    s_branch P2_sweep
P2_fix4:
    s_bitset0_b32 s47, 4
    v_cmp_lt_u32 vcc, 32, v10
    v_cmp_lt_u32 s[88:89], s5, v83
    v_cmp_lt_u32 s[90:91], s5, v34
    s_lshr_b64 s[54:55], vcc, 4
P2_retryf4:
    v_lshrrev_b32 v16, 18, v80
    v_lshrrev_b32 v17, 18, v81
    v_bitop3_b32 v16, v16, v4, v5 bitop3:0xea
    v_bitop3_b32 v17, v17, v4, v5 bitop3:0xea
    s_mov_b64 exec, s[88:89]
    ds_add_rtn_u32 v18, v16, v3
    s_mov_b64 exec, s[90:91]
    ds_add_rtn_u32 v19, v17, v3
    s_mov_b64 exec, -1
    v_and_b32 v20, 0xf00fffff, v80
    v_and_b32 v21, 0xf00fffff, v81
    s_waitcnt lgkmcnt(0)
    v_and_b32 v18, 4278452223, v18
    v_and_b32 v19, 4278452223, v19
    v_lshrrev_b32 v22, 1, v18
    v_lshrrev_b32 v23, 1, v19
    v_or_b32 v24, v18, v19
    v_cmp_lt_u32 vcc, 16777215, v24
    s_mov_b64 exec, s[88:89]
    ds_write_b32 v18, v20 offset:50144
    ds_write_b16 v22, v82 offset:2560
    s_mov_b64 exec, s[90:91]
    ds_write_b32 v19, v21 offset:50144
    ds_write_b16_d16_hi v23, v82 offset:2560
    s_mov_b64 exec, -1
    s_cbranch_vccnz P2_stallf4
    s_and_b64 s[92:93], s[54:55], s[82:83]
    s_cbranch_scc1 P2_moref4
    s_branch P2_sweep
P2_fix5:
    s_bitset0_b32 s47, 5
    v_cmp_lt_u32 vcc, 32, v10
    v_cmp_lt_u32 s[88:89], s5, v87
    v_cmp_lt_u32 s[90:91], s5, v35
    s_lshr_b64 s[54:55], vcc, 5
P2_retryf5:
    v_lshrrev_b32 v16, 18, v84
    v_lshrrev_b32 v17, 18, v85
    v_bitop3_b32 v16, v16, v4, v5 bitop3:0xea
    v_bitop3_b32 v17, v17, v4, v5 bitop3:0xea
    s_mov_b64 exec, s[88:89]
    ds_add_rtn_u32 v18, v16, v3
    s_mov_b64 exec, s[90:91]
    ds_add_rtn_u32 v19, v17, v3
    s_mov_b64 exec, -1
    v_and_b32 v20, 0xf00fffff, v84
    v_and_b32 v21, 0xf00fffff, v85
    s_waitcnt lgkmcnt(0)
    v_and_b32 v18, 4278452223, v18
    v_and_b32 v19, 4278452223, v19
    v_lshrrev_b32 v22, 1, v18
    v_lshrrev_b32 v23, 1, v19
    v_or_b32 v24, v18, v19
    v_cmp_lt_u32 vcc, 16777215, v24
    s_mov_b64 exec, s[88:89]
    ds_write_b32 v18, v20 offset:50144
    ds_write_b16 v22, v86 offset:2560
    s_mov_b64 exec, s[90:91]
    ds_write_b32 v19, v21 offset:50144
    ds_write_b16_d16_hi v23, v86 offset:2560
    s_mov_b64 exec, -1
    s_cbranch_vccnz P2_stallf5
    s_and_b64 s[92:93], s[54:55], s[82:83]
    s_cbranch_scc1 P2_moref5
    s_branch P2_sweep
P2_fix6:
    s_bitset0_b32 s47, 6
    v_cmp_lt_u32 vcc, 32, v10
    v_cmp_lt_u32 s[88:89], s5, v91
    v_cmp_lt_u32 s[90:91], s5, v36
    s_lshr_b64 s[54:55], vcc, 6
P2_retryf6:
    v_lshrrev_b32 v16, 18, v88
    v_lshrrev_b32 v17, 18, v89
    v_bitop3_b32 v16, v16, v4, v5 bitop3:0xea
    v_bitop3_b32 v17, v17, v4, v5 bitop3:0xea
    s_mov_b64 exec, s[88:89]
    ds_add_rtn_u32 v18, v16, v3
    s_mov_b64 exec, s[90:91]
    ds_add_rtn_u32 v19, v17, v3
    s_mov_b64 exec, -1
    v_and_b32 v20, 0xf00fffff, v88
    v_and_b32 v21, 0xf00fffff, v89
    s_waitcnt lgkmcnt(0)
    v_and_b32 v18, 4278452223, v18
    v_and_b32 v19, 4278452223, v19
    v_lshrrev_b32 v22, 1, v18
    v_lshrrev_b32 v23, 1, v19
    v_or_b32 v24, v18, v19
    v_cmp_lt_u32 vcc, 16777215, v24
    s_mov_b64 exec, s[88:89]
    ds_write_b32 v18, v20 offset:50144
    ds_write_b16 v22, v90 offset:2560
    s_mov_b64 exec, s[90:91]
    ds_write_b32 v19, v21 offset:50144
    ds_write_b16_d16_hi v23, v90 offset:2560
    s_mov_b64 exec, -1
    s_cbranch_vccnz P2_stallf6
    s_and_b64 s[92:93], s[54:55], s[82:83]
    s_cbranch_scc1 P2_moref6
    s_branch P2_sweep
P2_fix7:
    s_bitset0_b32 s47, 7
    v_cmp_lt_u32 vcc, 32, v10
    v_cmp_lt_u32 s[88:89], s5, v95
    v_cmp_lt_u32 s[90:91], s5, v37
    s_lshr_b64 s[54:55], vcc, 7
P2_retryf7:
    v_lshrrev_b32 v16, 18, v92
    v_lshrrev_b32 v17, 18, v93
    v_bitop3_b32 v16, v16, v4, v5 bitop3:0xea
    v_bitop3_b32 v17, v17, v4, v5 bitop3:0xea
    s_mov_b64 exec, s[88:89]
    ds_add_rtn_u32 v18, v16, v3
    s_mov_b64 exec, s[90:91]
    ds_add_rtn_u32 v19, v17, v3
    s_mov_b64 exec, -1
    v_and_b32 v20, 0xf00fffff, v92
    v_and_b32 v21, 0xf00fffff, v93
    s_waitcnt lgkmcnt(0)
    v_and_b32 v18, 4278452223, v18
    v_and_b32 v19, 4278452223, v19
    v_lshrrev_b32 v22, 1, v18
    v_lshrrev_b32 v23, 1, v19
    v_or_b32 v24, v18, v19
    v_cmp_lt_u32 vcc, 16777215, v24
    s_mov_b64 exec, s[88:89]
    ds_write_b32 v18, v20 offset:50144
    ds_write_b16 v22, v94 offset:2560
    s_mov_b64 exec, s[90:91]
    ds_write_b32 v19, v21 offset:50144
    ds_write_b16_d16_hi v23, v94 offset:2560
    s_mov_b64 exec, -1
    s_cbranch_vccnz P2_stallf7
    s_and_b64 s[92:93], s[54:55], s[82:83]
    s_cbranch_scc1 P2_moref7
    s_branch P2_sweep
P2_fix8:
    s_bitset0_b32 s47, 8
    v_cmp_lt_u32 vcc, 32, v10
    v_cmp_lt_u32 s[88:89], s5, v99
    v_cmp_lt_u32 s[90:91], s5, v38
    s_lshr_b64 s[54:55], vcc, 8
P2_retryf8:
    v_lshrrev_b32 v16, 18, v96
    v_lshrrev_b32 v17, 18, v97
    v_bitop3_b32 v16, v16, v4, v5 bitop3:0xea
    v_bitop3_b32 v17, v17, v4, v5 bitop3:0xea
    s_mov_b64 exec, s[88:89]
    ds_add_rtn_u32 v18, v16, v3
    s_mov_b64 exec, s[90:91]
    ds_add_rtn_u32 v19, v17, v3
    s_mov_b64 exec, -1
    v_and_b32 v20, 0xf00fffff, v96
    v_and_b32 v21, 0xf00fffff, v97
    s_waitcnt lgkmcnt(0)
    v_and_b32 v18, 4278452223, v18
    v_and_b32 v19, 4278452223, v19
    v_lshrrev_b32 v22, 1, v18
    v_lshrrev_b32 v23, 1, v19
    v_or_b32 v24, v18, v19
    v_cmp_lt_u32 vcc, 16777215, v24
    s_mov_b64 exec, s[88:89]
    ds_write_b32 v18, v20 offset:50144
    ds_write_b16 v22, v98 offset:2560
    s_mov_b64 exec, s[90:91]
    ds_write_b32 v19, v21 offset:50144
    ds_write_b16_d16_hi v23, v98 offset:2560
    s_mov_b64 exec, -1
    s_cbranch_vccnz P2_stallf8
    s_and_b64 s[92:93], s[54:55], s[82:83]
    s_cbranch_scc1 P2_moref8
    s_branch P2_sweep
P2_fix9:
    s_bitset0_b32 s47, 9
    v_cmp_lt_u32 vcc, 32, v10
    v_cmp_lt_u32 s[88:89], s5, v103
    v_cmp_lt_u32 s[90:91], s5, v39
    s_lshr_b64 s[54:55], vcc, 9
P2_retryf9:
    v_lshrrev_b32 v16, 18, v100
    v_lshrrev_b32 v17, 18, v101
    v_bitop3_b32 v16, v16, v4, v5 bitop3:0xea
    v_bitop3_b32 v17, v17, v4, v5 bitop3:0xea
    s_mov_b64 exec, s[88:89]
    ds_add_rtn_u32 v18, v16, v3
    s_mov_b64 exec, s[90:91]
    ds_add_rtn_u32 v19, v17, v3
    s_mov_b64 exec, -1
    v_and_b32 v20, 0xf00fffff, v100
    v_and_b32 v21, 0xf00fffff, v101
    s_waitcnt lgkmcnt(0)
    v_and_b32 v18, 4278452223, v18
    v_and_b32 v19, 4278452223, v19
    v_lshrrev_b32 v22, 1, v18
    v_lshrrev_b32 v23, 1, v19
    v_or_b32 v24, v18, v19
    v_cmp_lt_u32 vcc, 16777215, v24
    s_mov_b64 exec, s[88:89]
    ds_write_b32 v18, v20 offset:50144
    ds_write_b16 v22, v102 offset:2560
    s_mov_b64 exec, s[90:91]
    ds_write_b32 v19, v21 offset:50144
    ds_write_b16_d16_hi v23, v102 offset:2560
    s_mov_b64 exec, -1
    s_cbranch_vccnz P2_stallf9
    s_and_b64 s[92:93], s[54:55], s[82:83]
    s_cbranch_scc1 P2_moref9
    s_branch P2_sweep
P2_fix10:
    s_bitset0_b32 s47, 10
    v_cmp_lt_u32 vcc, 32, v10
    v_cmp_lt_u32 s[88:89], s5, v107
    v_cmp_lt_u32 s[90:91], s5, v53
    s_lshr_b64 s[54:55], vcc, 10
P2_retryf10:
    v_lshrrev_b32 v16, 18, v104
    v_lshrrev_b32 v17, 18, v105
    v_bitop3_b32 v16, v16, v4, v5 bitop3:0xea
    v_bitop3_b32 v17, v17, v4, v5 bitop3:0xea
    s_mov_b64 exec, s[88:89]
    ds_add_rtn_u32 v18, v16, v3
    s_mov_b64 exec, s[90:91]
    ds_add_rtn_u32 v19, v17, v3
    s_mov_b64 exec, -1
    v_and_b32 v20, 0xf00fffff, v104
    v_and_b32 v21, 0xf00fffff, v105
    s_waitcnt lgkmcnt(0)
    v_and_b32 v18, 4278452223, v18
    v_and_b32 v19, 4278452223, v19
    v_lshrrev_b32 v22, 1, v18
    v_lshrrev_b32 v23, 1, v19
    v_or_b32 v24, v18, v19
    v_cmp_lt_u32 vcc, 16777215, v24
    s_mov_b64 exec, s[88:89]
    ds_write_b32 v18, v20 offset:50144
    ds_write_b16 v22, v106 offset:2560
    s_mov_b64 exec, s[90:91]
    ds_write_b32 v19, v21 offset:50144
    ds_write_b16_d16_hi v23, v106 offset:2560
    s_mov_b64 exec, -1
    s_cbranch_vccnz P2_stallf10
    s_and_b64 s[92:93], s[54:55], s[82:83]
    s_cbranch_scc1 P2_moref10
    s_branch P2_sweep
P2_fix11:
    s_bitset0_b32 s47, 11
    v_cmp_lt_u32 vcc, 32, v10
    v_cmp_lt_u32 s[88:89], s5, v111
    v_cmp_lt_u32 s[90:91], s5, v54
    s_lshr_b64 s[54:55], vcc, 11
P2_retryf11:
    v_lshrrev_b32 v16, 18, v108
    v_lshrrev_b32 v17, 18, v109
    v_bitop3_b32 v16, v16, v4, v5 bitop3:0xea
    v_bitop3_b32 v17, v17, v4, v5 bitop3:0xea
    s_mov_b64 exec, s[88:89]
    ds_add_rtn_u32 v18, v16, v3
    s_mov_b64 exec, s[90:91]
    ds_add_rtn_u32 v19, v17, v3
    s_mov_b64 exec, -1
    v_and_b32 v20, 0xf00fffff, v108
    v_and_b32 v21, 0xf00fffff, v109
    s_waitcnt lgkmcnt(0)
    v_and_b32 v18, 4278452223, v18
    v_and_b32 v19, 4278452223, v19
    v_lshrrev_b32 v22, 1, v18
    v_lshrrev_b32 v23, 1, v19
    v_or_b32 v24, v18, v19
    v_cmp_lt_u32 vcc, 16777215, v24
    s_mov_b64 exec, s[88:89]
    ds_write_b32 v18, v20 offset:50144
    ds_write_b16 v22, v110 offset:2560
    s_mov_b64 exec, s[90:91]
    ds_write_b32 v19, v21 offset:50144
    ds_write_b16_d16_hi v23, v110 offset:2560
    s_mov_b64 exec, -1
    s_cbranch_vccnz P2_stallf11
    s_and_b64 s[92:93], s[54:55], s[82:83]
    s_cbranch_scc1 P2_moref11
    s_branch P2_sweep
P2_fix12:
    s_bitset0_b32 s47, 12
    v_cmp_lt_u32 vcc, 32, v10
    v_cmp_lt_u32 s[88:89], s5, v115
    v_cmp_lt_u32 s[90:91], s5, v55
    s_lshr_b64 s[54:55], vcc, 12
P2_retryf12:
    v_lshrrev_b32 v16, 18, v112
    v_lshrrev_b32 v17, 18, v113
    v_bitop3_b32 v16, v16, v4, v5 bitop3:0xea
    v_bitop3_b32 v17, v17, v4, v5 bitop3:0xea
    s_mov_b64 exec, s[88:89]
    ds_add_rtn_u32 v18, v16, v3
    s_mov_b64 exec, s[90:91]
    ds_add_rtn_u32 v19, v17, v3
    s_mov_b64 exec, -1
    v_and_b32 v20, 0xf00fffff, v112
    v_and_b32 v21, 0xf00fffff, v113
    s_waitcnt lgkmcnt(0)
    v_and_b32 v18, 4278452223, v18
    v_and_b32 v19, 4278452223, v19
    v_lshrrev_b32 v22, 1, v18
    v_lshrrev_b32 v23, 1, v19
    v_or_b32 v24, v18, v19
    v_cmp_lt_u32 vcc, 16777215, v24
    s_mov_b64 exec, s[88:89]
    ds_write_b32 v18, v20 offset:50144
    ds_write_b16 v22, v114 offset:2560
    s_mov_b64 exec, s[90:91]
    ds_write_b32 v19, v21 offset:50144
    ds_write_b16_d16_hi v23, v114 offset:2560
    s_mov_b64 exec, -1
    s_cbranch_vccnz P2_stallf12
    s_and_b64 s[92:93], s[54:55], s[82:83]
    s_cbranch_scc1 P2_moref12
    s_branch P2_sweep
P2_fix13:
    s_bitset0_b32 s47, 13
    v_cmp_lt_u32 vcc, 32, v10
    v_cmp_lt_u32 s[88:89], s5, v119
    v_cmp_lt_u32 s[90:91], s5, v56
    s_lshr_b64 s[54:55], vcc, 13
P2_retryf13:
    v_lshrrev_b32 v16, 18, v116
    v_lshrrev_b32 v17, 18, v117
    v_bitop3_b32 v16, v16, v4, v5 bitop3:0xea
    v_bitop3_b32 v17, v17, v4, v5 bitop3:0xea
    s_mov_b64 exec, s[88:89]
    ds_add_rtn_u32 v18, v16, v3
    s_mov_b64 exec, s[90:91]
    ds_add_rtn_u32 v19, v17, v3
    s_mov_b64 exec, -1
    v_and_b32 v20, 0xf00fffff, v116
    v_and_b32 v21, 0xf00fffff, v117
    s_waitcnt lgkmcnt(0)
    v_and_b32 v18, 4278452223, v18
    v_and_b32 v19, 4278452223, v19
    v_lshrrev_b32 v22, 1, v18
    v_lshrrev_b32 v23, 1, v19
    v_or_b32 v24, v18, v19
    v_cmp_lt_u32 vcc, 16777215, v24
    s_mov_b64 exec, s[88:89]
    ds_write_b32 v18, v20 offset:50144
    ds_write_b16 v22, v118 offset:2560
    s_mov_b64 exec, s[90:91]
    ds_write_b32 v19, v21 offset:50144
    ds_write_b16_d16_hi v23, v118 offset:2560
    s_mov_b64 exec, -1
    s_cbranch_vccnz P2_stallf13
    s_and_b64 s[92:93], s[54:55], s[82:83]
    s_cbranch_scc1 P2_moref13
    s_branch P2_sweep
P2_fix14:
    s_bitset0_b32 s47, 14
    v_cmp_lt_u32 vcc, 32, v10
    v_cmp_lt_u32 s[88:89], s5, v123
    v_cmp_lt_u32 s[90:91], s5, v57
    s_lshr_b64 s[54:55], vcc, 14
P2_retryf14:
    v_lshrrev_b32 v16, 18, v120
    v_lshrrev_b32 v17, 18, v121
    v_bitop3_b32 v16, v16, v4, v5 bitop3:0xea
    v_bitop3_b32 v17, v17, v4, v5 bitop3:0xea
    s_mov_b64 exec, s[88:89]
    ds_add_rtn_u32 v18, v16, v3
    s_mov_b64 exec, s[90:91]
    ds_add_rtn_u32 v19, v17, v3
    s_mov_b64 exec, -1
    v_and_b32 v20, 0xf00fffff, v120
    v_and_b32 v21, 0xf00fffff, v121
    s_waitcnt lgkmcnt(0)
    v_and_b32 v18, 4278452223, v18
    v_and_b32 v19, 4278452223, v19
    v_lshrrev_b32 v22, 1, v18
    v_lshrrev_b32 v23, 1, v19
    v_or_b32 v24, v18, v19
    v_cmp_lt_u32 vcc, 16777215, v24
    s_mov_b64 exec, s[88:89]
    ds_write_b32 v18, v20 offset:50144
    ds_write_b16 v22, v122 offset:2560
    s_mov_b64 exec, s[90:91]
    ds_write_b32 v19, v21 offset:50144
    ds_write_b16_d16_hi v23, v122 offset:2560
    s_mov_b64 exec, -1
    s_cbranch_vccnz P2_stallf14
    s_and_b64 s[92:93], s[54:55], s[82:83]
    s_cbranch_scc1 P2_moref14
    s_branch P2_sweep
P2_fix15:
    s_bitset0_b32 s47, 15
    v_cmp_lt_u32 vcc, 32, v10
    v_cmp_lt_u32 s[88:89], s5, v127
    v_cmp_lt_u32 s[90:91], s5, v58
    s_lshr_b64 s[54:55], vcc, 15
P2_retryf15:
    v_lshrrev_b32 v16, 18, v124
    v_lshrrev_b32 v17, 18, v125
    v_bitop3_b32 v16, v16, v4, v5 bitop3:0xea
    v_bitop3_b32 v17, v17, v4, v5 bitop3:0xea
    s_mov_b64 exec, s[88:89]
    ds_add_rtn_u32 v18, v16, v3
    s_mov_b64 exec, s[90:91]
    ds_add_rtn_u32 v19, v17, v3
    s_mov_b64 exec, -1
    v_and_b32 v20, 0xf00fffff, v124
    v_and_b32 v21, 0xf00fffff, v125
    s_waitcnt lgkmcnt(0)
    v_and_b32 v18, 4278452223, v18
    v_and_b32 v19, 4278452223, v19
    v_lshrrev_b32 v22, 1, v18
    v_lshrrev_b32 v23, 1, v19
    v_or_b32 v24, v18, v19
    v_cmp_lt_u32 vcc, 16777215, v24
    s_mov_b64 exec, s[88:89]
    ds_write_b32 v18, v20 offset:50144
    ds_write_b16 v22, v126 offset:2560
    s_mov_b64 exec, s[90:91]
    ds_write_b32 v19, v21 offset:50144
    ds_write_b16_d16_hi v23, v126 offset:2560
    s_mov_b64 exec, -1
    s_cbranch_vccnz P2_stallf15
    s_and_b64 s[92:93], s[54:55], s[82:83]
    s_cbranch_scc1 P2_moref15
P2_sweep:
    s_bitcmp1_b32 s47, 0
    s_cbranch_scc1 P2_fix0
    s_bitcmp1_b32 s47, 1
    s_cbranch_scc1 P2_fix1
    s_bitcmp1_b32 s47, 2
    s_cbranch_scc1 P2_fix2
    s_bitcmp1_b32 s47, 3
    s_cbranch_scc1 P2_fix3
    s_bitcmp1_b32 s47, 4
    s_cbranch_scc1 P2_fix4
    s_bitcmp1_b32 s47, 5
    s_cbranch_scc1 P2_fix5
    s_bitcmp1_b32 s47, 6
    s_cbranch_scc1 P2_fix6
    s_bitcmp1_b32 s47, 7
    s_cbranch_scc1 P2_fix7
    s_bitcmp1_b32 s47, 8
    s_cbranch_scc1 P2_fix8
    s_bitcmp1_b32 s47, 9
    s_cbranch_scc1 P2_fix9
    s_bitcmp1_b32 s47, 10
    s_cbranch_scc1 P2_fix10
    s_bitcmp1_b32 s47, 11
    s_cbranch_scc1 P2_fix11
    s_bitcmp1_b32 s47, 12
    s_cbranch_scc1 P2_fix12
    s_bitcmp1_b32 s47, 13
    s_cbranch_scc1 P2_fix13
    s_bitcmp1_b32 s47, 14
    s_cbranch_scc1 P2_fix14
    s_bitcmp1_b32 s47, 15
    s_cbranch_scc1 P2_fix15
    s_branch P2_swept
P2_giveup:
    s_lshl_b32 s40, 1, s3
    v_mov_b32 v24, 161900
    v_mov_b32 v25, s40
    s_mov_b64 exec, 1
    ds_or_b32 v24, v25
    s_mov_b64 exec, -1
P2_pdone:
    s_add_u32 s48, s48, 0x40000001
    v_mov_b32 v24, s48
    s_waitcnt lgkmcnt(0)
    ds_write_b32 v26, v24
    s_setprio 0
    s_load_dwordx2 s[6:7], s[0:1], 24
    s_load_dwordx2 s[34:35], s[0:1], 40
    s_load_dwordx8 s[36:43], s[0:1], 56
    v_and_b32 v13, 15, v12
    v_lshrrev_b32 v14, 4, v12
    v_lshlrev_b32 v1, 7, v14
    v_lshl_add_u32 v1, v13, 1, v1
    v_and_b32 v2, 0xff, v1
    v_and_b32 v3, 1, v14
    v_lshlrev_b32 v3, 3, v3
    v_lshrrev_b32 v4, 1, v14
    v_lshlrev_b32 v4, 10, v4
    v_lshl_add_u32 v4, v13, 1, v4
    s_and_b32 s47, s46, 31
    s_lshl_b32 s47, s47, 5
    v_add_u32 v4, s47, v4
    v_cmp_gt_u32 s[88:89], 32, v12
    s_waitcnt vmcnt(0) lgkmcnt(0)
    s_lshr_b32 s47, s46, 5
    s_mul_i32 s47, s47, 200000
    s_add_u32 s20, s6, s47
    s_addc_u32 s21, s7, 0
    s_mov_b32 s22, 200000
    s_mov_b32 s23, 0x20000
    s_mov_b32 s28, s42
    s_mov_b32 s29, s43
    s_mov_b32 s30, 512
    s_mov_b32 s31, 0x20000
    s_mov_b32 s12, s38
    s_mov_b32 s13, s39
    s_mov_b32 s14, 256
    s_mov_b32 s15, 0x20000
    s_mov_b32 s16, s36
    s_mov_b32 s17, s37
    s_mov_b32 s18, 256
    s_mov_b32 s19, 0x20000
    s_mov_b32 s52, s34
    s_mov_b32 s53, s35
    s_mov_b32 s54, 16
    s_mov_b32 s55, 0x20000
    s_mov_b32 s84, s40
    s_mov_b32 s85, s41
    s_mov_b32 s86, 512
    s_mov_b32 s87, 0x20000
    buffer_load_ushort v56, v3, s[52:55], 0 offen offset:0
    buffer_load_ushort v57, v3, s[52:55], 0 offen offset:2
    buffer_load_ushort v58, v3, s[52:55], 0 offen offset:4
    buffer_load_ushort v59, v3, s[52:55], 0 offen offset:6
    s_mul_i32 s47, s3, 25
    s_mul_i32 s50, s47, 57
    s_lshr_b32 s50, s50, 9
    s_min_u32 s50, s50, 4
    s_lshl_b32 s51, s47, 1
    s_sub_u32 s50, s51, s50
    s_lshl_b32 s50, s50, 10
    v_add_u32 v30, s50, v4
    s_add_u32 s47, s47, 1
    buffer_load_ushort v30, v30, s[20:23], 0 offen
    s_mul_i32 s50, s47, 57
    s_lshr_b32 s50, s50, 9
    s_min_u32 s50, s50, 4
    s_lshl_b32 s51, s47, 1
    s_sub_u32 s50, s51, s50
    s_lshl_b32 s50, s50, 10
    v_add_u32 v31, s50, v4
    s_add_u32 s47, s47, 1
    buffer_load_ushort v31, v31, s[20:23], 0 offen
    s_mul_i32 s50, s47, 57
    s_lshr_b32 s50, s50, 9
    s_min_u32 s50, s50, 4
    s_lshl_b32 s51, s47, 1
    s_sub_u32 s50, s51, s50
    s_lshl_b32 s50, s50, 10
    v_add_u32 v32, s50, v4
    s_add_u32 s47, s47, 1
    buffer_load_ushort v32, v32, s[20:23], 0 offen
    s_mul_i32 s50, s47, 57
    s_lshr_b32 s50, s50, 9
    s_min_u32 s50, s50, 4
    s_lshl_b32 s51, s47, 1
    s_sub_u32 s50, s51, s50
    s_lshl_b32 s50, s50, 10
    v_add_u32 v33, s50, v4
    s_add_u32 s47, s47, 1
    buffer_load_ushort v33, v33, s[20:23], 0 offen
    s_mul_i32 s50, s47, 57
    s_lshr_b32 s50, s50, 9
    s_min_u32 s50, s50, 4
    s_lshl_b32 s51, s47, 1
    s_sub_u32 s50, s51, s50
    s_lshl_b32 s50, s50, 10
    v_add_u32 v34, s50, v4
    s_add_u32 s47, s47, 1
    buffer_load_ushort v34, v34, s[20:23], 0 offen
    s_mul_i32 s50, s47, 57
    s_lshr_b32 s50, s50, 9
    s_min_u32 s50, s50, 4
    s_lshl_b32 s51, s47, 1
    s_sub_u32 s50, s51, s50
    s_lshl_b32 s50, s50, 10
    v_add_u32 v35, s50, v4
    s_add_u32 s47, s47, 1
    buffer_load_ushort v35, v35, s[20:23], 0 offen
    s_mul_i32 s50, s47, 57
    s_lshr_b32 s50, s50, 9
    s_min_u32 s50, s50, 4
    s_lshl_b32 s51, s47, 1
    s_sub_u32 s50, s51, s50
    s_lshl_b32 s50, s50, 10
    v_add_u32 v36, s50, v4
    s_add_u32 s47, s47, 1
    buffer_load_ushort v36, v36, s[20:23], 0 offen
    s_mul_i32 s50, s47, 57
    s_lshr_b32 s50, s50, 9
    s_min_u32 s50, s50, 4
    s_lshl_b32 s51, s47, 1
    s_sub_u32 s50, s51, s50
    s_lshl_b32 s50, s50, 10
    v_add_u32 v37, s50, v4
    s_add_u32 s47, s47, 1
    buffer_load_ushort v37, v37, s[20:23], 0 offen
    s_mul_i32 s50, s47, 57
    s_lshr_b32 s50, s50, 9
    s_min_u32 s50, s50, 4
    s_lshl_b32 s51, s47, 1
    s_sub_u32 s50, s51, s50
    s_lshl_b32 s50, s50, 10
    v_add_u32 v38, s50, v4
    s_add_u32 s47, s47, 1
    buffer_load_ushort v38, v38, s[20:23], 0 offen
    s_mul_i32 s50, s47, 57
    s_lshr_b32 s50, s50, 9
    s_min_u32 s50, s50, 4
    s_lshl_b32 s51, s47, 1
    s_sub_u32 s50, s51, s50
    s_lshl_b32 s50, s50, 10
    v_add_u32 v39, s50, v4
    s_add_u32 s47, s47, 1
    buffer_load_ushort v39, v39, s[20:23], 0 offen
    s_mul_i32 s50, s47, 57
    s_lshr_b32 s50, s50, 9
    s_min_u32 s50, s50, 4
    s_lshl_b32 s51, s47, 1
    s_sub_u32 s50, s51, s50
    s_lshl_b32 s50, s50, 10
    v_add_u32 v40, s50, v4
    s_add_u32 s47, s47, 1
    buffer_load_ushort v40, v40, s[20:23], 0 offen
    s_mul_i32 s50, s47, 57
    s_lshr_b32 s50, s50, 9
    s_min_u32 s50, s50, 4
    s_lshl_b32 s51, s47, 1
    s_sub_u32 s50, s51, s50
    s_lshl_b32 s50, s50, 10
    v_add_u32 v41, s50, v4
    s_add_u32 s47, s47, 1
    buffer_load_ushort v41, v41, s[20:23], 0 offen
    s_mul_i32 s50, s47, 57
    s_lshr_b32 s50, s50, 9
    s_min_u32 s50, s50, 4
    s_lshl_b32 s51, s47, 1
    s_sub_u32 s50, s51, s50
    s_lshl_b32 s50, s50, 10
    v_add_u32 v42, s50, v4
    s_add_u32 s47, s47, 1
    buffer_load_ushort v42, v42, s[20:23], 0 offen
    s_mul_i32 s50, s47, 57
    s_lshr_b32 s50, s50, 9
    s_min_u32 s50, s50, 4
    s_lshl_b32 s51, s47, 1
    s_sub_u32 s50, s51, s50
    s_lshl_b32 s50, s50, 10
    v_add_u32 v43, s50, v4
    s_add_u32 s47, s47, 1
    buffer_load_ushort v43, v43, s[20:23], 0 offen
    s_mul_i32 s50, s47, 57
    s_lshr_b32 s50, s50, 9
    s_min_u32 s50, s50, 4
    s_lshl_b32 s51, s47, 1
    s_sub_u32 s50, s51, s50
    s_lshl_b32 s50, s50, 10
    v_add_u32 v44, s50, v4
    s_add_u32 s47, s47, 1
    buffer_load_ushort v44, v44, s[20:23], 0 offen
    s_mul_i32 s50, s47, 57
    s_lshr_b32 s50, s50, 9
    s_min_u32 s50, s50, 4
    s_lshl_b32 s51, s47, 1
    s_sub_u32 s50, s51, s50
    s_lshl_b32 s50, s50, 10
    v_add_u32 v45, s50, v4
    s_add_u32 s47, s47, 1
    buffer_load_ushort v45, v45, s[20:23], 0 offen
    s_mul_i32 s50, s47, 57
    s_lshr_b32 s50, s50, 9
    s_min_u32 s50, s50, 4
    s_lshl_b32 s51, s47, 1
    s_sub_u32 s50, s51, s50
    s_lshl_b32 s50, s50, 10
    v_add_u32 v46, s50, v4
    s_add_u32 s47, s47, 1
    buffer_load_ushort v46, v46, s[20:23], 0 offen
    s_mul_i32 s50, s47, 57
    s_lshr_b32 s50, s50, 9
    s_min_u32 s50, s50, 4
    s_lshl_b32 s51, s47, 1
    s_sub_u32 s50, s51, s50
    s_lshl_b32 s50, s50, 10
    v_add_u32 v47, s50, v4
    s_add_u32 s47, s47, 1
    buffer_load_ushort v47, v47, s[20:23], 0 offen
    s_mul_i32 s50, s47, 57
    s_lshr_b32 s50, s50, 9
    s_min_u32 s50, s50, 4
    s_lshl_b32 s51, s47, 1
    s_sub_u32 s50, s51, s50
    s_lshl_b32 s50, s50, 10
    v_add_u32 v48, s50, v4
    s_add_u32 s47, s47, 1
    buffer_load_ushort v48, v48, s[20:23], 0 offen
    s_mul_i32 s50, s47, 57
    s_lshr_b32 s50, s50, 9
    s_min_u32 s50, s50, 4
    s_lshl_b32 s51, s47, 1
    s_sub_u32 s50, s51, s50
    s_lshl_b32 s50, s50, 10
    v_add_u32 v49, s50, v4
    s_add_u32 s47, s47, 1
    buffer_load_ushort v49, v49, s[20:23], 0 offen
    s_mul_i32 s50, s47, 57
    s_lshr_b32 s50, s50, 9
    s_min_u32 s50, s50, 4
    s_lshl_b32 s51, s47, 1
    s_sub_u32 s50, s51, s50
    s_lshl_b32 s50, s50, 10
    v_add_u32 v50, s50, v4
    s_add_u32 s47, s47, 1
    buffer_load_ushort v50, v50, s[20:23], 0 offen
    s_mul_i32 s50, s47, 57
    s_lshr_b32 s50, s50, 9
    s_min_u32 s50, s50, 4
    s_lshl_b32 s51, s47, 1
    s_sub_u32 s50, s51, s50
    s_lshl_b32 s50, s50, 10
    v_add_u32 v51, s50, v4
    s_add_u32 s47, s47, 1
    buffer_load_ushort v51, v51, s[20:23], 0 offen
    s_mul_i32 s50, s47, 57
    s_lshr_b32 s50, s50, 9
    s_min_u32 s50, s50, 4
    s_lshl_b32 s51, s47, 1
    s_sub_u32 s50, s51, s50
    s_lshl_b32 s50, s50, 10
    v_add_u32 v52, s50, v4
    s_add_u32 s47, s47, 1
    buffer_load_ushort v52, v52, s[20:23], 0 offen
    s_mul_i32 s50, s47, 57
    s_lshr_b32 s50, s50, 9
    s_min_u32 s50, s50, 4
    s_lshl_b32 s51, s47, 1
    s_sub_u32 s50, s51, s50
    s_lshl_b32 s50, s50, 10
    v_add_u32 v53, s50, v4
    s_add_u32 s47, s47, 1
    buffer_load_ushort v53, v53, s[20:23], 0 offen
    s_mul_i32 s50, s47, 57
    s_lshr_b32 s50, s50, 9
    s_min_u32 s50, s50, 4
    s_lshl_b32 s51, s47, 1
    s_sub_u32 s50, s51, s50
    s_lshl_b32 s50, s50, 10
    v_add_u32 v54, s50, v4
    s_add_u32 s47, s47, 1
    buffer_load_ushort v54, v54, s[20:23], 0 offen
    buffer_load_ushort v116, v1, s[28:31], 0 offen offset:0
    buffer_load_ushort v117, v1, s[28:31], 0 offen offset:32
    buffer_load_ushort v118, v1, s[28:31], 0 offen offset:64
    buffer_load_ushort v119, v1, s[28:31], 0 offen offset:96
    buffer_load_ushort v120, v2, s[12:15], 0 offen offset:0
    buffer_load_ushort v121, v2, s[12:15], 0 offen offset:32
    buffer_load_ushort v122, v2, s[12:15], 0 offen offset:64
    buffer_load_ushort v123, v2, s[12:15], 0 offen offset:96
    buffer_load_ushort v124, v2, s[16:19], 0 offen offset:0
    buffer_load_ushort v125, v2, s[16:19], 0 offen offset:32
    buffer_load_ushort v126, v2, s[16:19], 0 offen offset:64
    buffer_load_ushort v127, v2, s[16:19], 0 offen offset:96
    buffer_load_ushort v16, v1, s[84:87], 0 offen offset:0
    buffer_load_ushort v17, v1, s[84:87], 0 offen offset:32
    buffer_load_ushort v18, v1, s[84:87], 0 offen offset:64
    buffer_load_ushort v19, v1, s[84:87], 0 offen offset:96
    s_waitcnt vmcnt(40)
    v_lshlrev_b32 v56, 16, v56
    v_lshlrev_b32 v57, 16, v57
    v_lshlrev_b32 v58, 16, v58
    v_lshlrev_b32 v59, 16, v59
    s_waitcnt vmcnt(40)
    v_lshlrev_b32 v30, 16, v30
    v_sub_f32 v60, v30, v56
    v_sub_f32 v61, v30, v57
    v_sub_f32 v62, v30, v58
    v_sub_f32 v63, v30, v59
    v_cvt_pk_bf16_f32 v61, v60, v61
    v_cvt_pk_bf16_f32 v63, v62, v63
    v_lshlrev_b32 v60, 16, v61
    v_and_b32 v61, 0xffff0000, v61
    v_lshlrev_b32 v62, 16, v63
    v_and_b32 v63, 0xffff0000, v63
    v_mul_f32 v60, v60, v60
    v_mul_f32 v61, v61, v61
    v_mul_f32 v62, v62, v62
    v_mul_f32 v63, v63, v63
    v_cvt_pk_bf16_f32 v61, v60, v61
    v_cvt_pk_bf16_f32 v63, v62, v63
    v_lshlrev_b32 v60, 16, v61
    v_and_b32 v61, 0xffff0000, v61
    v_lshlrev_b32 v62, 16, v63
    v_and_b32 v63, 0xffff0000, v63
    v_mul_f32 v60, 0xc1200000, v60
    v_mul_f32 v61, 0xc1200000, v61
    v_mul_f32 v62, 0xc1200000, v62
    v_mul_f32 v63, 0xc1200000, v63
    v_cvt_pk_bf16_f32 v61, v60, v61
    v_cvt_pk_bf16_f32 v63, v62, v63
    v_lshlrev_b32 v60, 16, v61
    v_and_b32 v61, 0xffff0000, v61
    v_lshlrev_b32 v62, 16, v63
    v_and_b32 v63, 0xffff0000, v63
    v_mul_f32 v60, 0x3fb8aa3b, v60
    v_mul_f32 v61, 0x3fb8aa3b, v61
    v_mul_f32 v62, 0x3fb8aa3b, v62
    v_mul_f32 v63, 0x3fb8aa3b, v63
    v_exp_f32 v60, v60
    v_exp_f32 v61, v61
    v_exp_f32 v62, v62
    v_exp_f32 v63, v63
    v_cvt_pk_bf16_f32 v64, v60, v61
    v_cvt_pk_bf16_f32 v65, v62, v63
    s_waitcnt vmcnt(39)
    v_lshlrev_b32 v31, 16, v31
    v_sub_f32 v60, v31, v56
    v_sub_f32 v61, v31, v57
    v_sub_f32 v62, v31, v58
    v_sub_f32 v63, v31, v59
    v_cvt_pk_bf16_f32 v61, v60, v61
    v_cvt_pk_bf16_f32 v63, v62, v63
    v_lshlrev_b32 v60, 16, v61
    v_and_b32 v61, 0xffff0000, v61
    v_lshlrev_b32 v62, 16, v63
    v_and_b32 v63, 0xffff0000, v63
    v_mul_f32 v60, v60, v60
    v_mul_f32 v61, v61, v61
    v_mul_f32 v62, v62, v62
    v_mul_f32 v63, v63, v63
    v_cvt_pk_bf16_f32 v61, v60, v61
    v_cvt_pk_bf16_f32 v63, v62, v63
    v_lshlrev_b32 v60, 16, v61
    v_and_b32 v61, 0xffff0000, v61
    v_lshlrev_b32 v62, 16, v63
    v_and_b32 v63, 0xffff0000, v63
    v_mul_f32 v60, 0xc1200000, v60
    v_mul_f32 v61, 0xc1200000, v61
    v_mul_f32 v62, 0xc1200000, v62
    v_mul_f32 v63, 0xc1200000, v63
    v_cvt_pk_bf16_f32 v61, v60, v61
    v_cvt_pk_bf16_f32 v63, v62, v63
    v_lshlrev_b32 v60, 16, v61
    v_and_b32 v61, 0xffff0000, v61
    v_lshlrev_b32 v62, 16, v63
    v_and_b32 v63, 0xffff0000, v63
    v_mul_f32 v60, 0x3fb8aa3b, v60
    v_mul_f32 v61, 0x3fb8aa3b, v61
    v_mul_f32 v62, 0x3fb8aa3b, v62
    v_mul_f32 v63, 0x3fb8aa3b, v63
    v_exp_f32 v60, v60
    v_exp_f32 v61, v61
    v_exp_f32 v62, v62
    v_exp_f32 v63, v63
    v_cvt_pk_bf16_f32 v66, v60, v61
    v_cvt_pk_bf16_f32 v67, v62, v63
    s_waitcnt vmcnt(38)
    v_lshlrev_b32 v32, 16, v32
    v_sub_f32 v60, v32, v56
    v_sub_f32 v61, v32, v57
    v_sub_f32 v62, v32, v58
    v_sub_f32 v63, v32, v59
    v_cvt_pk_bf16_f32 v61, v60, v61
    v_cvt_pk_bf16_f32 v63, v62, v63
    v_lshlrev_b32 v60, 16, v61
    v_and_b32 v61, 0xffff0000, v61
    v_lshlrev_b32 v62, 16, v63
    v_and_b32 v63, 0xffff0000, v63
    v_mul_f32 v60, v60, v60
    v_mul_f32 v61, v61, v61
    v_mul_f32 v62, v62, v62
    v_mul_f32 v63, v63, v63
    v_cvt_pk_bf16_f32 v61, v60, v61
    v_cvt_pk_bf16_f32 v63, v62, v63
    v_lshlrev_b32 v60, 16, v61
    v_and_b32 v61, 0xffff0000, v61
    v_lshlrev_b32 v62, 16, v63
    v_and_b32 v63, 0xffff0000, v63
    v_mul_f32 v60, 0xc1200000, v60
    v_mul_f32 v61, 0xc1200000, v61
    v_mul_f32 v62, 0xc1200000, v62
    v_mul_f32 v63, 0xc1200000, v63
    v_cvt_pk_bf16_f32 v61, v60, v61
    v_cvt_pk_bf16_f32 v63, v62, v63
    v_lshlrev_b32 v60, 16, v61
    v_and_b32 v61, 0xffff0000, v61
    v_lshlrev_b32 v62, 16, v63
    v_and_b32 v63, 0xffff0000, v63
    v_mul_f32 v60, 0x3fb8aa3b, v60
    v_mul_f32 v61, 0x3fb8aa3b, v61
    v_mul_f32 v62, 0x3fb8aa3b, v62
    v_mul_f32 v63, 0x3fb8aa3b, v63
    v_exp_f32 v60, v60
    v_exp_f32 v61, v61
    v_exp_f32 v62, v62
    v_exp_f32 v63, v63
    v_cvt_pk_bf16_f32 v68, v60, v61
    v_cvt_pk_bf16_f32 v69, v62, v63
    s_waitcnt vmcnt(37)
    v_lshlrev_b32 v33, 16, v33
    v_sub_f32 v60, v33, v56
    v_sub_f32 v61, v33, v57
    v_sub_f32 v62, v33, v58
    v_sub_f32 v63, v33, v59
    v_cvt_pk_bf16_f32 v61, v60, v61
    v_cvt_pk_bf16_f32 v63, v62, v63
    v_lshlrev_b32 v60, 16, v61
    v_and_b32 v61, 0xffff0000, v61
    v_lshlrev_b32 v62, 16, v63
    v_and_b32 v63, 0xffff0000, v63
    v_mul_f32 v60, v60, v60
    v_mul_f32 v61, v61, v61
    v_mul_f32 v62, v62, v62
    v_mul_f32 v63, v63, v63
    v_cvt_pk_bf16_f32 v61, v60, v61
    v_cvt_pk_bf16_f32 v63, v62, v63
    v_lshlrev_b32 v60, 16, v61
    v_and_b32 v61, 0xffff0000, v61
    v_lshlrev_b32 v62, 16, v63
    v_and_b32 v63, 0xffff0000, v63
    v_mul_f32 v60, 0xc1200000, v60
    v_mul_f32 v61, 0xc1200000, v61
    v_mul_f32 v62, 0xc1200000, v62
    v_mul_f32 v63, 0xc1200000, v63
    v_cvt_pk_bf16_f32 v61, v60, v61
    v_cvt_pk_bf16_f32 v63, v62, v63
    v_lshlrev_b32 v60, 16, v61
    v_and_b32 v61, 0xffff0000, v61
    v_lshlrev_b32 v62, 16, v63
    v_and_b32 v63, 0xffff0000, v63
    v_mul_f32 v60, 0x3fb8aa3b, v60
    v_mul_f32 v61, 0x3fb8aa3b, v61
    v_mul_f32 v62, 0x3fb8aa3b, v62
    v_mul_f32 v63, 0x3fb8aa3b, v63
    v_exp_f32 v60, v60
    v_exp_f32 v61, v61
    v_exp_f32 v62, v62
    v_exp_f32 v63, v63
    v_cvt_pk_bf16_f32 v70, v60, v61
    v_cvt_pk_bf16_f32 v71, v62, v63
    s_waitcnt vmcnt(36)
    v_lshlrev_b32 v34, 16, v34
    v_sub_f32 v60, v34, v56
    v_sub_f32 v61, v34, v57
    v_sub_f32 v62, v34, v58
    v_sub_f32 v63, v34, v59
    v_cvt_pk_bf16_f32 v61, v60, v61
    v_cvt_pk_bf16_f32 v63, v62, v63
    v_lshlrev_b32 v60, 16, v61
    v_and_b32 v61, 0xffff0000, v61
    v_lshlrev_b32 v62, 16, v63
    v_and_b32 v63, 0xffff0000, v63
    v_mul_f32 v60, v60, v60
    v_mul_f32 v61, v61, v61
    v_mul_f32 v62, v62, v62
    v_mul_f32 v63, v63, v63
    v_cvt_pk_bf16_f32 v61, v60, v61
    v_cvt_pk_bf16_f32 v63, v62, v63
    v_lshlrev_b32 v60, 16, v61
    v_and_b32 v61, 0xffff0000, v61
    v_lshlrev_b32 v62, 16, v63
    v_and_b32 v63, 0xffff0000, v63
    v_mul_f32 v60, 0xc1200000, v60
    v_mul_f32 v61, 0xc1200000, v61
    v_mul_f32 v62, 0xc1200000, v62
    v_mul_f32 v63, 0xc1200000, v63
    v_cvt_pk_bf16_f32 v61, v60, v61
    v_cvt_pk_bf16_f32 v63, v62, v63
    v_lshlrev_b32 v60, 16, v61
    v_and_b32 v61, 0xffff0000, v61
    v_lshlrev_b32 v62, 16, v63
    v_and_b32 v63, 0xffff0000, v63
    v_mul_f32 v60, 0x3fb8aa3b, v60
    v_mul_f32 v61, 0x3fb8aa3b, v61
    v_mul_f32 v62, 0x3fb8aa3b, v62
    v_mul_f32 v63, 0x3fb8aa3b, v63
    v_exp_f32 v60, v60
    v_exp_f32 v61, v61
    v_exp_f32 v62, v62
    v_exp_f32 v63, v63
    v_cvt_pk_bf16_f32 v72, v60, v61
    v_cvt_pk_bf16_f32 v73, v62, v63
    s_waitcnt vmcnt(35)
    v_lshlrev_b32 v35, 16, v35
    v_sub_f32 v60, v35, v56
    v_sub_f32 v61, v35, v57
    v_sub_f32 v62, v35, v58
    v_sub_f32 v63, v35, v59
    v_cvt_pk_bf16_f32 v61, v60, v61
    v_cvt_pk_bf16_f32 v63, v62, v63
    v_lshlrev_b32 v60, 16, v61
    v_and_b32 v61, 0xffff0000, v61
    v_lshlrev_b32 v62, 16, v63
    v_and_b32 v63, 0xffff0000, v63
    v_mul_f32 v60, v60, v60
    v_mul_f32 v61, v61, v61
    v_mul_f32 v62, v62, v62
    v_mul_f32 v63, v63, v63
    v_cvt_pk_bf16_f32 v61, v60, v61
    v_cvt_pk_bf16_f32 v63, v62, v63
    v_lshlrev_b32 v60, 16, v61
    v_and_b32 v61, 0xffff0000, v61
    v_lshlrev_b32 v62, 16, v63
    v_and_b32 v63, 0xffff0000, v63
    v_mul_f32 v60, 0xc1200000, v60
    v_mul_f32 v61, 0xc1200000, v61
    v_mul_f32 v62, 0xc1200000, v62
    v_mul_f32 v63, 0xc1200000, v63
    v_cvt_pk_bf16_f32 v61, v60, v61
    v_cvt_pk_bf16_f32 v63, v62, v63
    v_lshlrev_b32 v60, 16, v61
    v_and_b32 v61, 0xffff0000, v61
    v_lshlrev_b32 v62, 16, v63
    v_and_b32 v63, 0xffff0000, v63
    v_mul_f32 v60, 0x3fb8aa3b, v60
    v_mul_f32 v61, 0x3fb8aa3b, v61
    v_mul_f32 v62, 0x3fb8aa3b, v62
    v_mul_f32 v63, 0x3fb8aa3b, v63
    v_exp_f32 v60, v60
    v_exp_f32 v61, v61
    v_exp_f32 v62, v62
    v_exp_f32 v63, v63
    v_cvt_pk_bf16_f32 v74, v60, v61
    v_cvt_pk_bf16_f32 v75, v62, v63
    s_waitcnt vmcnt(34)
    v_lshlrev_b32 v36, 16, v36
    v_sub_f32 v60, v36, v56
    v_sub_f32 v61, v36, v57
    v_sub_f32 v62, v36, v58
    v_sub_f32 v63, v36, v59
    v_cvt_pk_bf16_f32 v61, v60, v61
    v_cvt_pk_bf16_f32 v63, v62, v63
    v_lshlrev_b32 v60, 16, v61
    v_and_b32 v61, 0xffff0000, v61
    v_lshlrev_b32 v62, 16, v63
    v_and_b32 v63, 0xffff0000, v63
    v_mul_f32 v60, v60, v60
    v_mul_f32 v61, v61, v61
    v_mul_f32 v62, v62, v62
    v_mul_f32 v63, v63, v63
    v_cvt_pk_bf16_f32 v61, v60, v61
    v_cvt_pk_bf16_f32 v63, v62, v63
    v_lshlrev_b32 v60, 16, v61
    v_and_b32 v61, 0xffff0000, v61
    v_lshlrev_b32 v62, 16, v63
    v_and_b32 v63, 0xffff0000, v63
    v_mul_f32 v60, 0xc1200000, v60
    v_mul_f32 v61, 0xc1200000, v61
    v_mul_f32 v62, 0xc1200000, v62
    v_mul_f32 v63, 0xc1200000, v63
    v_cvt_pk_bf16_f32 v61, v60, v61
    v_cvt_pk_bf16_f32 v63, v62, v63
    v_lshlrev_b32 v60, 16, v61
    v_and_b32 v61, 0xffff0000, v61
    v_lshlrev_b32 v62, 16, v63
    v_and_b32 v63, 0xffff0000, v63
    v_mul_f32 v60, 0x3fb8aa3b, v60
    v_mul_f32 v61, 0x3fb8aa3b, v61
    v_mul_f32 v62, 0x3fb8aa3b, v62
    v_mul_f32 v63, 0x3fb8aa3b, v63
    v_exp_f32 v60, v60
    v_exp_f32 v61, v61
    v_exp_f32 v62, v62
    v_exp_f32 v63, v63
    v_cvt_pk_bf16_f32 v76, v60, v61
    v_cvt_pk_bf16_f32 v77, v62, v63
    s_waitcnt vmcnt(33)
    v_lshlrev_b32 v37, 16, v37
    v_sub_f32 v60, v37, v56
    v_sub_f32 v61, v37, v57
    v_sub_f32 v62, v37, v58
    v_sub_f32 v63, v37, v59
    v_cvt_pk_bf16_f32 v61, v60, v61
    v_cvt_pk_bf16_f32 v63, v62, v63
    v_lshlrev_b32 v60, 16, v61
    v_and_b32 v61, 0xffff0000, v61
    v_lshlrev_b32 v62, 16, v63
    v_and_b32 v63, 0xffff0000, v63
    v_mul_f32 v60, v60, v60
    v_mul_f32 v61, v61, v61
    v_mul_f32 v62, v62, v62
    v_mul_f32 v63, v63, v63
    v_cvt_pk_bf16_f32 v61, v60, v61
    v_cvt_pk_bf16_f32 v63, v62, v63
    v_lshlrev_b32 v60, 16, v61
    v_and_b32 v61, 0xffff0000, v61
    v_lshlrev_b32 v62, 16, v63
    v_and_b32 v63, 0xffff0000, v63
    v_mul_f32 v60, 0xc1200000, v60
    v_mul_f32 v61, 0xc1200000, v61
    v_mul_f32 v62, 0xc1200000, v62
    v_mul_f32 v63, 0xc1200000, v63
    v_cvt_pk_bf16_f32 v61, v60, v61
    v_cvt_pk_bf16_f32 v63, v62, v63
    v_lshlrev_b32 v60, 16, v61
    v_and_b32 v61, 0xffff0000, v61
    v_lshlrev_b32 v62, 16, v63
    v_and_b32 v63, 0xffff0000, v63
    v_mul_f32 v60, 0x3fb8aa3b, v60
    v_mul_f32 v61, 0x3fb8aa3b, v61
    v_mul_f32 v62, 0x3fb8aa3b, v62
    v_mul_f32 v63, 0x3fb8aa3b, v63
    v_exp_f32 v60, v60
    v_exp_f32 v61, v61
    v_exp_f32 v62, v62
    v_exp_f32 v63, v63
    v_cvt_pk_bf16_f32 v78, v60, v61
    v_cvt_pk_bf16_f32 v79, v62, v63
    s_waitcnt vmcnt(32)
    v_lshlrev_b32 v38, 16, v38
    v_sub_f32 v60, v38, v56
    v_sub_f32 v61, v38, v57
    v_sub_f32 v62, v38, v58
    v_sub_f32 v63, v38, v59
    v_cvt_pk_bf16_f32 v61, v60, v61
    v_cvt_pk_bf16_f32 v63, v62, v63
    v_lshlrev_b32 v60, 16, v61
    v_and_b32 v61, 0xffff0000, v61
    v_lshlrev_b32 v62, 16, v63
    v_and_b32 v63, 0xffff0000, v63
    v_mul_f32 v60, v60, v60
    v_mul_f32 v61, v61, v61
    v_mul_f32 v62, v62, v62
    v_mul_f32 v63, v63, v63
    v_cvt_pk_bf16_f32 v61, v60, v61
    v_cvt_pk_bf16_f32 v63, v62, v63
    v_lshlrev_b32 v60, 16, v61
    v_and_b32 v61, 0xffff0000, v61
    v_lshlrev_b32 v62, 16, v63
    v_and_b32 v63, 0xffff0000, v63
    v_mul_f32 v60, 0xc1200000, v60
    v_mul_f32 v61, 0xc1200000, v61
    v_mul_f32 v62, 0xc1200000, v62
    v_mul_f32 v63, 0xc1200000, v63
    v_cvt_pk_bf16_f32 v61, v60, v61
    v_cvt_pk_bf16_f32 v63, v62, v63
    v_lshlrev_b32 v60, 16, v61
    v_and_b32 v61, 0xffff0000, v61
    v_lshlrev_b32 v62, 16, v63
    v_and_b32 v63, 0xffff0000, v63
    v_mul_f32 v60, 0x3fb8aa3b, v60
    v_mul_f32 v61, 0x3fb8aa3b, v61
    v_mul_f32 v62, 0x3fb8aa3b, v62
    v_mul_f32 v63, 0x3fb8aa3b, v63
    v_exp_f32 v60, v60
    v_exp_f32 v61, v61
    v_exp_f32 v62, v62
    v_exp_f32 v63, v63
    v_cvt_pk_bf16_f32 v80, v60, v61
    v_cvt_pk_bf16_f32 v81, v62, v63
    s_waitcnt vmcnt(31)
    v_lshlrev_b32 v39, 16, v39
    v_sub_f32 v60, v39, v56
    v_sub_f32 v61, v39, v57
    v_sub_f32 v62, v39, v58
    v_sub_f32 v63, v39, v59
    v_cvt_pk_bf16_f32 v61, v60, v61
    v_cvt_pk_bf16_f32 v63, v62, v63
    v_lshlrev_b32 v60, 16, v61
    v_and_b32 v61, 0xffff0000, v61
    v_lshlrev_b32 v62, 16, v63
    v_and_b32 v63, 0xffff0000, v63
    v_mul_f32 v60, v60, v60
    v_mul_f32 v61, v61, v61
    v_mul_f32 v62, v62, v62
    v_mul_f32 v63, v63, v63
    v_cvt_pk_bf16_f32 v61, v60, v61
    v_cvt_pk_bf16_f32 v63, v62, v63
    v_lshlrev_b32 v60, 16, v61
    v_and_b32 v61, 0xffff0000, v61
    v_lshlrev_b32 v62, 16, v63
    v_and_b32 v63, 0xffff0000, v63
    v_mul_f32 v60, 0xc1200000, v60
    v_mul_f32 v61, 0xc1200000, v61
    v_mul_f32 v62, 0xc1200000, v62
    v_mul_f32 v63, 0xc1200000, v63
    v_cvt_pk_bf16_f32 v61, v60, v61
    v_cvt_pk_bf16_f32 v63, v62, v63
    v_lshlrev_b32 v60, 16, v61
    v_and_b32 v61, 0xffff0000, v61
    v_lshlrev_b32 v62, 16, v63
    v_and_b32 v63, 0xffff0000, v63
    v_mul_f32 v60, 0x3fb8aa3b, v60
    v_mul_f32 v61, 0x3fb8aa3b, v61
    v_mul_f32 v62, 0x3fb8aa3b, v62
    v_mul_f32 v63, 0x3fb8aa3b, v63
    v_exp_f32 v60, v60
    v_exp_f32 v61, v61
    v_exp_f32 v62, v62
    v_exp_f32 v63, v63
    v_cvt_pk_bf16_f32 v82, v60, v61
    v_cvt_pk_bf16_f32 v83, v62, v63
    s_waitcnt vmcnt(30)
    v_lshlrev_b32 v40, 16, v40
    v_sub_f32 v60, v40, v56
    v_sub_f32 v61, v40, v57
    v_sub_f32 v62, v40, v58
    v_sub_f32 v63, v40, v59
    v_cvt_pk_bf16_f32 v61, v60, v61
    v_cvt_pk_bf16_f32 v63, v62, v63
    v_lshlrev_b32 v60, 16, v61
    v_and_b32 v61, 0xffff0000, v61
    v_lshlrev_b32 v62, 16, v63
    v_and_b32 v63, 0xffff0000, v63
    v_mul_f32 v60, v60, v60
    v_mul_f32 v61, v61, v61
    v_mul_f32 v62, v62, v62
    v_mul_f32 v63, v63, v63
    v_cvt_pk_bf16_f32 v61, v60, v61
    v_cvt_pk_bf16_f32 v63, v62, v63
    v_lshlrev_b32 v60, 16, v61
    v_and_b32 v61, 0xffff0000, v61
    v_lshlrev_b32 v62, 16, v63
    v_and_b32 v63, 0xffff0000, v63
    v_mul_f32 v60, 0xc1200000, v60
    v_mul_f32 v61, 0xc1200000, v61
    v_mul_f32 v62, 0xc1200000, v62
    v_mul_f32 v63, 0xc1200000, v63
    v_cvt_pk_bf16_f32 v61, v60, v61
    v_cvt_pk_bf16_f32 v63, v62, v63
    v_lshlrev_b32 v60, 16, v61
    v_and_b32 v61, 0xffff0000, v61
    v_lshlrev_b32 v62, 16, v63
    v_and_b32 v63, 0xffff0000, v63
    v_mul_f32 v60, 0x3fb8aa3b, v60
    v_mul_f32 v61, 0x3fb8aa3b, v61
    v_mul_f32 v62, 0x3fb8aa3b, v62
    v_mul_f32 v63, 0x3fb8aa3b, v63
    v_exp_f32 v60, v60
    v_exp_f32 v61, v61
    v_exp_f32 v62, v62
    v_exp_f32 v63, v63
    v_cvt_pk_bf16_f32 v84, v60, v61
    v_cvt_pk_bf16_f32 v85, v62, v63
    s_waitcnt vmcnt(29)
    v_lshlrev_b32 v41, 16, v41
    v_sub_f32 v60, v41, v56
    v_sub_f32 v61, v41, v57
    v_sub_f32 v62, v41, v58
    v_sub_f32 v63, v41, v59
    v_cvt_pk_bf16_f32 v61, v60, v61
    v_cvt_pk_bf16_f32 v63, v62, v63
    v_lshlrev_b32 v60, 16, v61
    v_and_b32 v61, 0xffff0000, v61
    v_lshlrev_b32 v62, 16, v63
    v_and_b32 v63, 0xffff0000, v63
    v_mul_f32 v60, v60, v60
    v_mul_f32 v61, v61, v61
    v_mul_f32 v62, v62, v62
    v_mul_f32 v63, v63, v63
    v_cvt_pk_bf16_f32 v61, v60, v61
    v_cvt_pk_bf16_f32 v63, v62, v63
    v_lshlrev_b32 v60, 16, v61
    v_and_b32 v61, 0xffff0000, v61
    v_lshlrev_b32 v62, 16, v63
    v_and_b32 v63, 0xffff0000, v63
    v_mul_f32 v60, 0xc1200000, v60
    v_mul_f32 v61, 0xc1200000, v61
    v_mul_f32 v62, 0xc1200000, v62
    v_mul_f32 v63, 0xc1200000, v63
    v_cvt_pk_bf16_f32 v61, v60, v61
    v_cvt_pk_bf16_f32 v63, v62, v63
    v_lshlrev_b32 v60, 16, v61
    v_and_b32 v61, 0xffff0000, v61
    v_lshlrev_b32 v62, 16, v63
    v_and_b32 v63, 0xffff0000, v63
    v_mul_f32 v60, 0x3fb8aa3b, v60
    v_mul_f32 v61, 0x3fb8aa3b, v61
    v_mul_f32 v62, 0x3fb8aa3b, v62
    v_mul_f32 v63, 0x3fb8aa3b, v63
    v_exp_f32 v60, v60
    v_exp_f32 v61, v61
    v_exp_f32 v62, v62
    v_exp_f32 v63, v63
    v_cvt_pk_bf16_f32 v86, v60, v61
    v_cvt_pk_bf16_f32 v87, v62, v63
    s_waitcnt vmcnt(28)
    v_lshlrev_b32 v42, 16, v42
    v_sub_f32 v60, v42, v56
    v_sub_f32 v61, v42, v57
    v_sub_f32 v62, v42, v58
    v_sub_f32 v63, v42, v59
    v_cvt_pk_bf16_f32 v61, v60, v61
    v_cvt_pk_bf16_f32 v63, v62, v63
    v_lshlrev_b32 v60, 16, v61
    v_and_b32 v61, 0xffff0000, v61
    v_lshlrev_b32 v62, 16, v63
    v_and_b32 v63, 0xffff0000, v63
    v_mul_f32 v60, v60, v60
    v_mul_f32 v61, v61, v61
    v_mul_f32 v62, v62, v62
    v_mul_f32 v63, v63, v63
    v_cvt_pk_bf16_f32 v61, v60, v61
    v_cvt_pk_bf16_f32 v63, v62, v63
    v_lshlrev_b32 v60, 16, v61
    v_and_b32 v61, 0xffff0000, v61
    v_lshlrev_b32 v62, 16, v63
    v_and_b32 v63, 0xffff0000, v63
    v_mul_f32 v60, 0xc1200000, v60
    v_mul_f32 v61, 0xc1200000, v61
    v_mul_f32 v62, 0xc1200000, v62
    v_mul_f32 v63, 0xc1200000, v63
    v_cvt_pk_bf16_f32 v61, v60, v61
    v_cvt_pk_bf16_f32 v63, v62, v63
    v_lshlrev_b32 v60, 16, v61
    v_and_b32 v61, 0xffff0000, v61
    v_lshlrev_b32 v62, 16, v63
    v_and_b32 v63, 0xffff0000, v63
    v_mul_f32 v60, 0x3fb8aa3b, v60
    v_mul_f32 v61, 0x3fb8aa3b, v61
    v_mul_f32 v62, 0x3fb8aa3b, v62
    v_mul_f32 v63, 0x3fb8aa3b, v63
    v_exp_f32 v60, v60
    v_exp_f32 v61, v61
    v_exp_f32 v62, v62
    v_exp_f32 v63, v63
    v_cvt_pk_bf16_f32 v88, v60, v61
    v_cvt_pk_bf16_f32 v89, v62, v63
    s_waitcnt vmcnt(27)
    v_lshlrev_b32 v43, 16, v43
    v_sub_f32 v60, v43, v56
    v_sub_f32 v61, v43, v57
    v_sub_f32 v62, v43, v58
    v_sub_f32 v63, v43, v59
    v_cvt_pk_bf16_f32 v61, v60, v61
    v_cvt_pk_bf16_f32 v63, v62, v63
    v_lshlrev_b32 v60, 16, v61
    v_and_b32 v61, 0xffff0000, v61
    v_lshlrev_b32 v62, 16, v63
    v_and_b32 v63, 0xffff0000, v63
    v_mul_f32 v60, v60, v60
    v_mul_f32 v61, v61, v61
    v_mul_f32 v62, v62, v62
    v_mul_f32 v63, v63, v63
    v_cvt_pk_bf16_f32 v61, v60, v61
    v_cvt_pk_bf16_f32 v63, v62, v63
    v_lshlrev_b32 v60, 16, v61
    v_and_b32 v61, 0xffff0000, v61
    v_lshlrev_b32 v62, 16, v63
    v_and_b32 v63, 0xffff0000, v63
    v_mul_f32 v60, 0xc1200000, v60
    v_mul_f32 v61, 0xc1200000, v61
    v_mul_f32 v62, 0xc1200000, v62
    v_mul_f32 v63, 0xc1200000, v63
    v_cvt_pk_bf16_f32 v61, v60, v61
    v_cvt_pk_bf16_f32 v63, v62, v63
    v_lshlrev_b32 v60, 16, v61
    v_and_b32 v61, 0xffff0000, v61
    v_lshlrev_b32 v62, 16, v63
    v_and_b32 v63, 0xffff0000, v63
    v_mul_f32 v60, 0x3fb8aa3b, v60
    v_mul_f32 v61, 0x3fb8aa3b, v61
    v_mul_f32 v62, 0x3fb8aa3b, v62
    v_mul_f32 v63, 0x3fb8aa3b, v63
    v_exp_f32 v60, v60
    v_exp_f32 v61, v61
    v_exp_f32 v62, v62
    v_exp_f32 v63, v63
    v_cvt_pk_bf16_f32 v90, v60, v61
    v_cvt_pk_bf16_f32 v91, v62, v63
    s_waitcnt vmcnt(26)
    v_lshlrev_b32 v44, 16, v44
    v_sub_f32 v60, v44, v56
    v_sub_f32 v61, v44, v57
    v_sub_f32 v62, v44, v58
    v_sub_f32 v63, v44, v59
    v_cvt_pk_bf16_f32 v61, v60, v61
    v_cvt_pk_bf16_f32 v63, v62, v63
    v_lshlrev_b32 v60, 16, v61
    v_and_b32 v61, 0xffff0000, v61
    v_lshlrev_b32 v62, 16, v63
    v_and_b32 v63, 0xffff0000, v63
    v_mul_f32 v60, v60, v60
    v_mul_f32 v61, v61, v61
    v_mul_f32 v62, v62, v62
    v_mul_f32 v63, v63, v63
    v_cvt_pk_bf16_f32 v61, v60, v61
    v_cvt_pk_bf16_f32 v63, v62, v63
    v_lshlrev_b32 v60, 16, v61
    v_and_b32 v61, 0xffff0000, v61
    v_lshlrev_b32 v62, 16, v63
    v_and_b32 v63, 0xffff0000, v63
    v_mul_f32 v60, 0xc1200000, v60
    v_mul_f32 v61, 0xc1200000, v61
    v_mul_f32 v62, 0xc1200000, v62
    v_mul_f32 v63, 0xc1200000, v63
    v_cvt_pk_bf16_f32 v61, v60, v61
    v_cvt_pk_bf16_f32 v63, v62, v63
    v_lshlrev_b32 v60, 16, v61
    v_and_b32 v61, 0xffff0000, v61
    v_lshlrev_b32 v62, 16, v63
    v_and_b32 v63, 0xffff0000, v63
    v_mul_f32 v60, 0x3fb8aa3b, v60
    v_mul_f32 v61, 0x3fb8aa3b, v61
    v_mul_f32 v62, 0x3fb8aa3b, v62
    v_mul_f32 v63, 0x3fb8aa3b, v63
    v_exp_f32 v60, v60
    v_exp_f32 v61, v61
    v_exp_f32 v62, v62
    v_exp_f32 v63, v63
    v_cvt_pk_bf16_f32 v92, v60, v61
    v_cvt_pk_bf16_f32 v93, v62, v63
    s_waitcnt vmcnt(25)
    v_lshlrev_b32 v45, 16, v45
    v_sub_f32 v60, v45, v56
    v_sub_f32 v61, v45, v57
    v_sub_f32 v62, v45, v58
    v_sub_f32 v63, v45, v59
    v_cvt_pk_bf16_f32 v61, v60, v61
    v_cvt_pk_bf16_f32 v63, v62, v63
    v_lshlrev_b32 v60, 16, v61
    v_and_b32 v61, 0xffff0000, v61
    v_lshlrev_b32 v62, 16, v63
    v_and_b32 v63, 0xffff0000, v63
    v_mul_f32 v60, v60, v60
    v_mul_f32 v61, v61, v61
    v_mul_f32 v62, v62, v62
    v_mul_f32 v63, v63, v63
    v_cvt_pk_bf16_f32 v61, v60, v61
    v_cvt_pk_bf16_f32 v63, v62, v63
    v_lshlrev_b32 v60, 16, v61
    v_and_b32 v61, 0xffff0000, v61
    v_lshlrev_b32 v62, 16, v63
    v_and_b32 v63, 0xffff0000, v63
    v_mul_f32 v60, 0xc1200000, v60
    v_mul_f32 v61, 0xc1200000, v61
    v_mul_f32 v62, 0xc1200000, v62
    v_mul_f32 v63, 0xc1200000, v63
    v_cvt_pk_bf16_f32 v61, v60, v61
    v_cvt_pk_bf16_f32 v63, v62, v63
    v_lshlrev_b32 v60, 16, v61
    v_and_b32 v61, 0xffff0000, v61
    v_lshlrev_b32 v62, 16, v63
    v_and_b32 v63, 0xffff0000, v63
    v_mul_f32 v60, 0x3fb8aa3b, v60
    v_mul_f32 v61, 0x3fb8aa3b, v61
    v_mul_f32 v62, 0x3fb8aa3b, v62
    v_mul_f32 v63, 0x3fb8aa3b, v63
    v_exp_f32 v60, v60
    v_exp_f32 v61, v61
    v_exp_f32 v62, v62
    v_exp_f32 v63, v63
    v_cvt_pk_bf16_f32 v94, v60, v61
    v_cvt_pk_bf16_f32 v95, v62, v63
    s_waitcnt vmcnt(24)
    v_lshlrev_b32 v46, 16, v46
    v_sub_f32 v60, v46, v56
    v_sub_f32 v61, v46, v57
    v_sub_f32 v62, v46, v58
    v_sub_f32 v63, v46, v59
    v_cvt_pk_bf16_f32 v61, v60, v61
    v_cvt_pk_bf16_f32 v63, v62, v63
    v_lshlrev_b32 v60, 16, v61
    v_and_b32 v61, 0xffff0000, v61
    v_lshlrev_b32 v62, 16, v63
    v_and_b32 v63, 0xffff0000, v63
    v_mul_f32 v60, v60, v60
    v_mul_f32 v61, v61, v61
    v_mul_f32 v62, v62, v62
    v_mul_f32 v63, v63, v63
    v_cvt_pk_bf16_f32 v61, v60, v61
    v_cvt_pk_bf16_f32 v63, v62, v63
    v_lshlrev_b32 v60, 16, v61
    v_and_b32 v61, 0xffff0000, v61
    v_lshlrev_b32 v62, 16, v63
    v_and_b32 v63, 0xffff0000, v63
    v_mul_f32 v60, 0xc1200000, v60
    v_mul_f32 v61, 0xc1200000, v61
    v_mul_f32 v62, 0xc1200000, v62
    v_mul_f32 v63, 0xc1200000, v63
    v_cvt_pk_bf16_f32 v61, v60, v61
    v_cvt_pk_bf16_f32 v63, v62, v63
    v_lshlrev_b32 v60, 16, v61
    v_and_b32 v61, 0xffff0000, v61
    v_lshlrev_b32 v62, 16, v63
    v_and_b32 v63, 0xffff0000, v63
    v_mul_f32 v60, 0x3fb8aa3b, v60
    v_mul_f32 v61, 0x3fb8aa3b, v61
    v_mul_f32 v62, 0x3fb8aa3b, v62
    v_mul_f32 v63, 0x3fb8aa3b, v63
    v_exp_f32 v60, v60
    v_exp_f32 v61, v61
    v_exp_f32 v62, v62
    v_exp_f32 v63, v63
    v_cvt_pk_bf16_f32 v96, v60, v61
    v_cvt_pk_bf16_f32 v97, v62, v63
    s_waitcnt vmcnt(23)
    v_lshlrev_b32 v47, 16, v47
    v_sub_f32 v60, v47, v56
    v_sub_f32 v61, v47, v57
    v_sub_f32 v62, v47, v58
    v_sub_f32 v63, v47, v59
    v_cvt_pk_bf16_f32 v61, v60, v61
    v_cvt_pk_bf16_f32 v63, v62, v63
    v_lshlrev_b32 v60, 16, v61
    v_and_b32 v61, 0xffff0000, v61
    v_lshlrev_b32 v62, 16, v63
    v_and_b32 v63, 0xffff0000, v63
    v_mul_f32 v60, v60, v60
    v_mul_f32 v61, v61, v61
    v_mul_f32 v62, v62, v62
    v_mul_f32 v63, v63, v63
    v_cvt_pk_bf16_f32 v61, v60, v61
    v_cvt_pk_bf16_f32 v63, v62, v63
    v_lshlrev_b32 v60, 16, v61
    v_and_b32 v61, 0xffff0000, v61
    v_lshlrev_b32 v62, 16, v63
    v_and_b32 v63, 0xffff0000, v63
    v_mul_f32 v60, 0xc1200000, v60
    v_mul_f32 v61, 0xc1200000, v61
    v_mul_f32 v62, 0xc1200000, v62
    v_mul_f32 v63, 0xc1200000, v63
    v_cvt_pk_bf16_f32 v61, v60, v61
    v_cvt_pk_bf16_f32 v63, v62, v63
    v_lshlrev_b32 v60, 16, v61
    v_and_b32 v61, 0xffff0000, v61
    v_lshlrev_b32 v62, 16, v63
    v_and_b32 v63, 0xffff0000, v63
    v_mul_f32 v60, 0x3fb8aa3b, v60
    v_mul_f32 v61, 0x3fb8aa3b, v61
    v_mul_f32 v62, 0x3fb8aa3b, v62
    v_mul_f32 v63, 0x3fb8aa3b, v63
    v_exp_f32 v60, v60
    v_exp_f32 v61, v61
    v_exp_f32 v62, v62
    v_exp_f32 v63, v63
    v_cvt_pk_bf16_f32 v98, v60, v61
    v_cvt_pk_bf16_f32 v99, v62, v63
    s_waitcnt vmcnt(22)
    v_lshlrev_b32 v48, 16, v48
    v_sub_f32 v60, v48, v56
    v_sub_f32 v61, v48, v57
    v_sub_f32 v62, v48, v58
    v_sub_f32 v63, v48, v59
    v_cvt_pk_bf16_f32 v61, v60, v61
    v_cvt_pk_bf16_f32 v63, v62, v63
    v_lshlrev_b32 v60, 16, v61
    v_and_b32 v61, 0xffff0000, v61
    v_lshlrev_b32 v62, 16, v63
    v_and_b32 v63, 0xffff0000, v63
    v_mul_f32 v60, v60, v60
    v_mul_f32 v61, v61, v61
    v_mul_f32 v62, v62, v62
    v_mul_f32 v63, v63, v63
    v_cvt_pk_bf16_f32 v61, v60, v61
    v_cvt_pk_bf16_f32 v63, v62, v63
    v_lshlrev_b32 v60, 16, v61
    v_and_b32 v61, 0xffff0000, v61
    v_lshlrev_b32 v62, 16, v63
    v_and_b32 v63, 0xffff0000, v63
    v_mul_f32 v60, 0xc1200000, v60
    v_mul_f32 v61, 0xc1200000, v61
    v_mul_f32 v62, 0xc1200000, v62
    v_mul_f32 v63, 0xc1200000, v63
    v_cvt_pk_bf16_f32 v61, v60, v61
    v_cvt_pk_bf16_f32 v63, v62, v63
    v_lshlrev_b32 v60, 16, v61
    v_and_b32 v61, 0xffff0000, v61
    v_lshlrev_b32 v62, 16, v63
    v_and_b32 v63, 0xffff0000, v63
    v_mul_f32 v60, 0x3fb8aa3b, v60
    v_mul_f32 v61, 0x3fb8aa3b, v61
    v_mul_f32 v62, 0x3fb8aa3b, v62
    v_mul_f32 v63, 0x3fb8aa3b, v63
    v_exp_f32 v60, v60
    v_exp_f32 v61, v61
    v_exp_f32 v62, v62
    v_exp_f32 v63, v63
    v_cvt_pk_bf16_f32 v100, v60, v61
    v_cvt_pk_bf16_f32 v101, v62, v63
    s_waitcnt vmcnt(21)
    v_lshlrev_b32 v49, 16, v49
    v_sub_f32 v60, v49, v56
    v_sub_f32 v61, v49, v57
    v_sub_f32 v62, v49, v58
    v_sub_f32 v63, v49, v59
    v_cvt_pk_bf16_f32 v61, v60, v61
    v_cvt_pk_bf16_f32 v63, v62, v63
    v_lshlrev_b32 v60, 16, v61
    v_and_b32 v61, 0xffff0000, v61
    v_lshlrev_b32 v62, 16, v63
    v_and_b32 v63, 0xffff0000, v63
    v_mul_f32 v60, v60, v60
    v_mul_f32 v61, v61, v61
    v_mul_f32 v62, v62, v62
    v_mul_f32 v63, v63, v63
    v_cvt_pk_bf16_f32 v61, v60, v61
    v_cvt_pk_bf16_f32 v63, v62, v63
    v_lshlrev_b32 v60, 16, v61
    v_and_b32 v61, 0xffff0000, v61
    v_lshlrev_b32 v62, 16, v63
    v_and_b32 v63, 0xffff0000, v63
    v_mul_f32 v60, 0xc1200000, v60
    v_mul_f32 v61, 0xc1200000, v61
    v_mul_f32 v62, 0xc1200000, v62
    v_mul_f32 v63, 0xc1200000, v63
    v_cvt_pk_bf16_f32 v61, v60, v61
    v_cvt_pk_bf16_f32 v63, v62, v63
    v_lshlrev_b32 v60, 16, v61
    v_and_b32 v61, 0xffff0000, v61
    v_lshlrev_b32 v62, 16, v63
    v_and_b32 v63, 0xffff0000, v63
    v_mul_f32 v60, 0x3fb8aa3b, v60
    v_mul_f32 v61, 0x3fb8aa3b, v61
    v_mul_f32 v62, 0x3fb8aa3b, v62
    v_mul_f32 v63, 0x3fb8aa3b, v63
    v_exp_f32 v60, v60
    v_exp_f32 v61, v61
    v_exp_f32 v62, v62
    v_exp_f32 v63, v63
    v_cvt_pk_bf16_f32 v102, v60, v61
    v_cvt_pk_bf16_f32 v103, v62, v63
    s_waitcnt vmcnt(20)
    v_lshlrev_b32 v50, 16, v50
    v_sub_f32 v60, v50, v56
    v_sub_f32 v61, v50, v57
    v_sub_f32 v62, v50, v58
    v_sub_f32 v63, v50, v59
    v_cvt_pk_bf16_f32 v61, v60, v61
    v_cvt_pk_bf16_f32 v63, v62, v63
    v_lshlrev_b32 v60, 16, v61
    v_and_b32 v61, 0xffff0000, v61
    v_lshlrev_b32 v62, 16, v63
    v_and_b32 v63, 0xffff0000, v63
    v_mul_f32 v60, v60, v60
    v_mul_f32 v61, v61, v61
    v_mul_f32 v62, v62, v62
    v_mul_f32 v63, v63, v63
    v_cvt_pk_bf16_f32 v61, v60, v61
    v_cvt_pk_bf16_f32 v63, v62, v63
    v_lshlrev_b32 v60, 16, v61
    v_and_b32 v61, 0xffff0000, v61
    v_lshlrev_b32 v62, 16, v63
    v_and_b32 v63, 0xffff0000, v63
    v_mul_f32 v60, 0xc1200000, v60
    v_mul_f32 v61, 0xc1200000, v61
    v_mul_f32 v62, 0xc1200000, v62
    v_mul_f32 v63, 0xc1200000, v63
    v_cvt_pk_bf16_f32 v61, v60, v61
    v_cvt_pk_bf16_f32 v63, v62, v63
    v_lshlrev_b32 v60, 16, v61
    v_and_b32 v61, 0xffff0000, v61
    v_lshlrev_b32 v62, 16, v63
    v_and_b32 v63, 0xffff0000, v63
    v_mul_f32 v60, 0x3fb8aa3b, v60
    v_mul_f32 v61, 0x3fb8aa3b, v61
    v_mul_f32 v62, 0x3fb8aa3b, v62
    v_mul_f32 v63, 0x3fb8aa3b, v63
    v_exp_f32 v60, v60
    v_exp_f32 v61, v61
    v_exp_f32 v62, v62
    v_exp_f32 v63, v63
    v_cvt_pk_bf16_f32 v104, v60, v61
    v_cvt_pk_bf16_f32 v105, v62, v63
    s_waitcnt vmcnt(19)
    v_lshlrev_b32 v51, 16, v51
    v_sub_f32 v60, v51, v56
    v_sub_f32 v61, v51, v57
    v_sub_f32 v62, v51, v58
    v_sub_f32 v63, v51, v59
    v_cvt_pk_bf16_f32 v61, v60, v61
    v_cvt_pk_bf16_f32 v63, v62, v63
    v_lshlrev_b32 v60, 16, v61
    v_and_b32 v61, 0xffff0000, v61
    v_lshlrev_b32 v62, 16, v63
    v_and_b32 v63, 0xffff0000, v63
    v_mul_f32 v60, v60, v60
    v_mul_f32 v61, v61, v61
    v_mul_f32 v62, v62, v62
    v_mul_f32 v63, v63, v63
    v_cvt_pk_bf16_f32 v61, v60, v61
    v_cvt_pk_bf16_f32 v63, v62, v63
    v_lshlrev_b32 v60, 16, v61
    v_and_b32 v61, 0xffff0000, v61
    v_lshlrev_b32 v62, 16, v63
    v_and_b32 v63, 0xffff0000, v63
    v_mul_f32 v60, 0xc1200000, v60
    v_mul_f32 v61, 0xc1200000, v61
    v_mul_f32 v62, 0xc1200000, v62
    v_mul_f32 v63, 0xc1200000, v63
    v_cvt_pk_bf16_f32 v61, v60, v61
    v_cvt_pk_bf16_f32 v63, v62, v63
    v_lshlrev_b32 v60, 16, v61
    v_and_b32 v61, 0xffff0000, v61
    v_lshlrev_b32 v62, 16, v63
    v_and_b32 v63, 0xffff0000, v63
    v_mul_f32 v60, 0x3fb8aa3b, v60
    v_mul_f32 v61, 0x3fb8aa3b, v61
    v_mul_f32 v62, 0x3fb8aa3b, v62
    v_mul_f32 v63, 0x3fb8aa3b, v63
    v_exp_f32 v60, v60
    v_exp_f32 v61, v61
    v_exp_f32 v62, v62
    v_exp_f32 v63, v63
    v_cvt_pk_bf16_f32 v106, v60, v61
    v_cvt_pk_bf16_f32 v107, v62, v63
    s_waitcnt vmcnt(18)
    v_lshlrev_b32 v52, 16, v52
    v_sub_f32 v60, v52, v56
    v_sub_f32 v61, v52, v57
    v_sub_f32 v62, v52, v58
    v_sub_f32 v63, v52, v59
    v_cvt_pk_bf16_f32 v61, v60, v61
    v_cvt_pk_bf16_f32 v63, v62, v63
    v_lshlrev_b32 v60, 16, v61
    v_and_b32 v61, 0xffff0000, v61
    v_lshlrev_b32 v62, 16, v63
    v_and_b32 v63, 0xffff0000, v63
    v_mul_f32 v60, v60, v60
    v_mul_f32 v61, v61, v61
    v_mul_f32 v62, v62, v62
    v_mul_f32 v63, v63, v63
    v_cvt_pk_bf16_f32 v61, v60, v61
    v_cvt_pk_bf16_f32 v63, v62, v63
    v_lshlrev_b32 v60, 16, v61
    v_and_b32 v61, 0xffff0000, v61
    v_lshlrev_b32 v62, 16, v63
    v_and_b32 v63, 0xffff0000, v63
    v_mul_f32 v60, 0xc1200000, v60
    v_mul_f32 v61, 0xc1200000, v61
    v_mul_f32 v62, 0xc1200000, v62
    v_mul_f32 v63, 0xc1200000, v63
    v_cvt_pk_bf16_f32 v61, v60, v61
    v_cvt_pk_bf16_f32 v63, v62, v63
    v_lshlrev_b32 v60, 16, v61
    v_and_b32 v61, 0xffff0000, v61
    v_lshlrev_b32 v62, 16, v63
    v_and_b32 v63, 0xffff0000, v63
    v_mul_f32 v60, 0x3fb8aa3b, v60
    v_mul_f32 v61, 0x3fb8aa3b, v61
    v_mul_f32 v62, 0x3fb8aa3b, v62
    v_mul_f32 v63, 0x3fb8aa3b, v63
    v_exp_f32 v60, v60
    v_exp_f32 v61, v61
    v_exp_f32 v62, v62
    v_exp_f32 v63, v63
    v_cvt_pk_bf16_f32 v108, v60, v61
    v_cvt_pk_bf16_f32 v109, v62, v63
    s_waitcnt vmcnt(17)
    v_lshlrev_b32 v53, 16, v53
    v_sub_f32 v60, v53, v56
    v_sub_f32 v61, v53, v57
    v_sub_f32 v62, v53, v58
    v_sub_f32 v63, v53, v59
    v_cvt_pk_bf16_f32 v61, v60, v61
    v_cvt_pk_bf16_f32 v63, v62, v63
    v_lshlrev_b32 v60, 16, v61
    v_and_b32 v61, 0xffff0000, v61
    v_lshlrev_b32 v62, 16, v63
    v_and_b32 v63, 0xffff0000, v63
    v_mul_f32 v60, v60, v60
    v_mul_f32 v61, v61, v61
    v_mul_f32 v62, v62, v62
    v_mul_f32 v63, v63, v63
    v_cvt_pk_bf16_f32 v61, v60, v61
    v_cvt_pk_bf16_f32 v63, v62, v63
    v_lshlrev_b32 v60, 16, v61
    v_and_b32 v61, 0xffff0000, v61
    v_lshlrev_b32 v62, 16, v63
    v_and_b32 v63, 0xffff0000, v63
    v_mul_f32 v60, 0xc1200000, v60
    v_mul_f32 v61, 0xc1200000, v61
    v_mul_f32 v62, 0xc1200000, v62
    v_mul_f32 v63, 0xc1200000, v63
    v_cvt_pk_bf16_f32 v61, v60, v61
    v_cvt_pk_bf16_f32 v63, v62, v63
    v_lshlrev_b32 v60, 16, v61
    v_and_b32 v61, 0xffff0000, v61
    v_lshlrev_b32 v62, 16, v63
    v_and_b32 v63, 0xffff0000, v63
    v_mul_f32 v60, 0x3fb8aa3b, v60
    v_mul_f32 v61, 0x3fb8aa3b, v61
    v_mul_f32 v62, 0x3fb8aa3b, v62
    v_mul_f32 v63, 0x3fb8aa3b, v63
    v_exp_f32 v60, v60
    v_exp_f32 v61, v61
    v_exp_f32 v62, v62
    v_exp_f32 v63, v63
    v_cvt_pk_bf16_f32 v110, v60, v61
    v_cvt_pk_bf16_f32 v111, v62, v63
    s_waitcnt vmcnt(16)
    v_lshlrev_b32 v54, 16, v54
    v_sub_f32 v60, v54, v56
    v_sub_f32 v61, v54, v57
    v_sub_f32 v62, v54, v58
    v_sub_f32 v63, v54, v59
    v_cvt_pk_bf16_f32 v61, v60, v61
    v_cvt_pk_bf16_f32 v63, v62, v63
    v_lshlrev_b32 v60, 16, v61
    v_and_b32 v61, 0xffff0000, v61
    v_lshlrev_b32 v62, 16, v63
    v_and_b32 v63, 0xffff0000, v63
    v_mul_f32 v60, v60, v60
    v_mul_f32 v61, v61, v61
    v_mul_f32 v62, v62, v62
    v_mul_f32 v63, v63, v63
    v_cvt_pk_bf16_f32 v61, v60, v61
    v_cvt_pk_bf16_f32 v63, v62, v63
    v_lshlrev_b32 v60, 16, v61
    v_and_b32 v61, 0xffff0000, v61
    v_lshlrev_b32 v62, 16, v63
    v_and_b32 v63, 0xffff0000, v63
    v_mul_f32 v60, 0xc1200000, v60
    v_mul_f32 v61, 0xc1200000, v61
    v_mul_f32 v62, 0xc1200000, v62
    v_mul_f32 v63, 0xc1200000, v63
    v_cvt_pk_bf16_f32 v61, v60, v61
    v_cvt_pk_bf16_f32 v63, v62, v63
    v_lshlrev_b32 v60, 16, v61
    v_and_b32 v61, 0xffff0000, v61
    v_lshlrev_b32 v62, 16, v63
    v_and_b32 v63, 0xffff0000, v63
    v_mul_f32 v60, 0x3fb8aa3b, v60
    v_mul_f32 v61, 0x3fb8aa3b, v61
    v_mul_f32 v62, 0x3fb8aa3b, v62
    v_mul_f32 v63, 0x3fb8aa3b, v63
    v_exp_f32 v60, v60
    v_exp_f32 v61, v61
    v_exp_f32 v62, v62
    v_exp_f32 v63, v63
    v_cvt_pk_bf16_f32 v112, v60, v61
    v_cvt_pk_bf16_f32 v113, v62, v63
    s_waitcnt vmcnt(0)
    v_lshl_or_b32 v38, v117, 16, v116
    v_lshl_or_b32 v40, v17, 16, v16
    v_lshl_or_b32 v120, v121, 16, v120
    v_lshl_or_b32 v124, v125, 16, v124
    v_lshl_or_b32 v39, v119, 16, v118
    v_lshl_or_b32 v41, v19, 16, v18
    v_lshl_or_b32 v121, v123, 16, v122
    v_lshl_or_b32 v125, v127, 16, v126
    v_cndmask_b32 v30, 0, v120, s[88:89]
    v_cndmask_b32 v32, v120, 0, s[88:89]
    v_cndmask_b32 v34, 0, v124, s[88:89]
    v_cndmask_b32 v36, v124, 0, s[88:89]
    v_cndmask_b32 v31, 0, v121, s[88:89]
    v_cndmask_b32 v33, v121, 0, s[88:89]
    v_cndmask_b32 v35, 0, v125, s[88:89]
    v_cndmask_b32 v37, v125, 0, s[88:89]
    v_lshlrev_b32 v1, 3, v12
    v_add_u32 v2, 24528, v1
    v_and_b32 v3, 3, v12
    v_lshlrev_b32 v3, 2, v3
    v_add_u32 v3, 161920, v3
P2_dw:
    ds_read_b32 v24, v3
    s_waitcnt lgkmcnt(0)
    v_cmp_gt_u32 vcc, 2.0, v24
    s_cbranch_vccz P2_dg
    s_sleep 2
    s_branch P2_dw
P2_dg:
    v_readlane_b32 s48, v24, 0
    v_readlane_b32 s50, v24, 1
    s_max_u32 s48, s48, s50
    v_readlane_b32 s50, v24, 2
    s_max_u32 s48, s48, s50
    v_readlane_b32 s50, v24, 3
    s_max_u32 s48, s48, s50
    s_and_b32 s48, s48, 0x3fffffff
    s_add_u32 s50, s48, 1
    s_lshr_b32 s50, s50, 1
    s_mul_i32 s50, s50, 12
    s_and_b32 s51, s48, 1
    s_lshl_b32 s51, s51, 2
    s_add_u32 s51, s51, 161904
    v_mov_b32 v25, s51
P2_pwe:
    ds_read_b32 v24, v25
    s_waitcnt lgkmcnt(0)
    v_readfirstlane_b32 s51, v24
    s_cmp_ge_u32 s51, s50
    s_cbranch_scc1 P2_pge
    s_sleep 2
    s_branch P2_pwe
P2_pge:
    s_bitcmp1_b32 s48, 0
    s_cselect_b32 s50, 43936, 0
    s_add_u32 s50, s50, 50144
    s_mul_i32 s51, s3, 12800
    s_add_u32 s50, s50, s51
    v_add_u32 v1, s50, v1
    ds_write_b64 v2, v[30:31] offset:0
    ds_write_b64 v2, v[32:33] offset:512
    ds_write_b64 v2, v[34:35] offset:1024
    ds_write_b64 v2, v[36:37] offset:1536
    ds_write_b64 v2, v[38:39] offset:2048
    ds_write_b64 v2, v[40:41] offset:2560
    ds_write_b64 v1, v[64:65] offset:0
    ds_write_b64 v1, v[66:67] offset:512
    ds_write_b64 v1, v[68:69] offset:1024
    ds_write_b64 v1, v[70:71] offset:1536
    ds_write_b64 v1, v[72:73] offset:2048
    ds_write_b64 v1, v[74:75] offset:2560
    ds_write_b64 v1, v[76:77] offset:3072
    ds_write_b64 v1, v[78:79] offset:3584
    ds_write_b64 v1, v[80:81] offset:4096
    ds_write_b64 v1, v[82:83] offset:4608
    ds_write_b64 v1, v[84:85] offset:5120
    ds_write_b64 v1, v[86:87] offset:5632
    ds_write_b64 v1, v[88:89] offset:6144
    ds_write_b64 v1, v[90:91] offset:6656
    ds_write_b64 v1, v[92:93] offset:7168
    ds_write_b64 v1, v[94:95] offset:7680
    ds_write_b64 v1, v[96:97] offset:8192
    ds_write_b64 v1, v[98:99] offset:8704
    ds_write_b64 v1, v[100:101] offset:9216
    ds_write_b64 v1, v[102:103] offset:9728
    ds_write_b64 v1, v[104:105] offset:10240
    ds_write_b64 v1, v[106:107] offset:10752
    ds_write_b64 v1, v[108:109] offset:11264
    ds_write_b64 v1, v[110:111] offset:11776
    ds_write_b64 v1, v[112:113] offset:12288
    v_mov_b32 v24, 161892
    v_mov_b32 v25, 1
    s_mov_b64 exec, 1
    s_waitcnt lgkmcnt(0)
    ds_add_u32 v24, v25
    s_mov_b64 exec, -1
    s_waitcnt lgkmcnt(0)
    s_endpgm
P2_consumer:
    s_sub_u32 s47, s3, 4
    s_min_u32 s44, s47, 4
    s_lshl_b32 s49, s47, 4
    s_add_u32 s49, s49, s44
    s_cmp_lt_u32 s47, 4
    s_cselect_b32 s50, 17, 16
    s_cselect_b32 s84, 0, 1048576
    s_cselect_b32 s85, 46, 32
    s_bfm_b64 s[92:93], s85, 0
    v_subrev_u32 v60, 256, v0
    v_lshlrev_b32 v60, 4, v60
    v_add_u32 v61, 49152, v60
    v_add_u32 v62, 98304, v60
    v_add_u32 v63, 147456, v60
    v_mov_b32 v16, 161876
P2_lws:
    ds_read_b32 v17, v16
    s_waitcnt lgkmcnt(0)
    v_readfirstlane_b32 s40, v17
    s_cmp_ge_u32 s40, 16
    s_cbranch_scc1 P2_lgs
    s_sleep 1
    s_branch P2_lws
P2_lgs:
    ds_read_b128 v[68:71], v63 offset:11344
    ds_read_b128 v[72:75], v62 offset:48208
    ds_read_b128 v[76:79], v62 offset:35920
    ds_read_b128 v[80:83], v62 offset:23632
    ds_read_b128 v[84:87], v62 offset:11344
    ds_read_b128 v[88:91], v61 offset:48208
    ds_read_b128 v[92:95], v61 offset:35920
    ds_read_b128 v[96:99], v61 offset:23632
    ds_read_b128 v[100:103], v61 offset:11344
    ds_read_b128 v[104:107], v60 offset:48208
    ds_read_b128 v[108:111], v60 offset:35920
    ds_read_b128 v[112:115], v60 offset:23632
    ds_read_b128 v[116:119], v60 offset:11344
    v_mov_b32 v34, v63
    v_mov_b32 v36, 940572672
    v_mov_b32 v37, 940572672
    v_mov_b32 v38, 940572672
    v_mov_b32 v39, 940572672
    v_add_u32 v61, 48208, v60
    v_add_u32 v62, 97360, v60
    ds_write_b128 v61, v[36:39] offset:0
    ds_write_b128 v61, v[36:39] offset:12288
    ds_write_b128 v61, v[36:39] offset:24576
    ds_write_b128 v61, v[36:39] offset:36864
    s_cmp_ge_u32 s47, 4
    s_cbranch_scc1 P2_notab
    v_and_b32 v52, 15, v12
    v_lshrrev_b32 v53, 4, v12
    v_lshrrev_b32 v56, 2, v52
    v_cmp_eq_u32 vcc, v56, v53
    v_and_b32 v56, 3, v12
    v_lshlrev_b32 v56, 4, v56
    v_mov_b32 v54, 0xffff
    v_mov_b32 v55, 0
    v_cndmask_b32 v54, 0, v54, vcc
    v_lshlrev_b64 v[54:55], v56, v[54:55]
    v_and_b32 v56, 1, v53
    v_lshlrev_b32 v56, 3, v56
    v_lshl_add_u32 v52, v52, 4, v56
    v_lshrrev_b32 v53, 1, v53
    v_lshl_add_u32 v52, v53, 8, v52
    v_and_b32 v56, 255, v0
    v_lshlrev_b32 v53, 2, v56
    v_mul_u32_u24 v56, 224, v56
    v_add_u32 v56, 2097152, v56
    v_add_u32 v57, 51232, v56
    ds_write_b64 v52, v[54:55] offset:2048
    ds_write_b32 v53, v56
    ds_write_b32 v53, v57 offset:1024
P2_notab:
    v_mov_b32 v16, 161884
    v_mov_b32 v17, 1
    s_mov_b64 exec, 1
    s_waitcnt lgkmcnt(0)
    ds_add_u32 v16, v17
    s_mov_b64 exec, -1
    s_waitcnt vmcnt(0)
    v_mov_b32 v16, 161872
    v_mov_b32 v17, 1
    s_mov_b64 exec, 1
    ds_add_rtn_u32 v17, v16, v17
    s_mov_b64 exec, -1
    s_waitcnt lgkmcnt(0)
    v_readfirstlane_b32 s40, v17
    s_cmp_lg_u32 s40, 15
    s_cbranch_scc1 P2_norelac
    v_mov_b32 v16, 0
    v_mov_b32 v17, 1
    s_mov_b64 exec, 1
    buffer_atomic_add v17, v16, s[24:27], 0 offen offset:0 sc0 sc1
    s_mov_b64 exec, -1
    s_waitcnt vmcnt(0)
    v_readfirstlane_b32 s40, v17
    s_cmp_lg_u32 s40, 255
    s_cbranch_scc1 P2_norelac
    s_mov_b64 exec, 1
    buffer_store_dword v17, v16, s[24:27], 0 offen offset:128 sc1
    s_mov_b64 exec, -1
P2_norelac:
    s_setprio 2
    buffer_store_dwordx4 v[68:71], v34, s[20:23], 0 offen sc1
    v_subrev_u32 v34, 12288, v34
    buffer_store_dwordx4 v[72:75], v34, s[20:23], 0 offen sc1
    v_subrev_u32 v34, 12288, v34
    buffer_store_dwordx4 v[76:79], v34, s[20:23], 0 offen sc1
    v_subrev_u32 v34, 12288, v34
    buffer_store_dwordx4 v[80:83], v34, s[20:23], 0 offen sc1
    v_subrev_u32 v34, 12288, v34
    buffer_store_dwordx4 v[84:87], v34, s[20:23], 0 offen sc1
    v_subrev_u32 v34, 12288, v34
    buffer_store_dwordx4 v[88:91], v34, s[20:23], 0 offen sc1
    v_subrev_u32 v34, 12288, v34
    buffer_store_dwordx4 v[92:95], v34, s[20:23], 0 offen sc1
    v_subrev_u32 v34, 12288, v34
    buffer_store_dwordx4 v[96:99], v34, s[20:23], 0 offen sc1
    v_subrev_u32 v34, 12288, v34
    buffer_store_dwordx4 v[100:103], v34, s[20:23], 0 offen sc1
    v_subrev_u32 v34, 12288, v34
    s_setprio 0
    ds_write_b128 v62, v[36:39] offset:0
    ds_write_b128 v62, v[36:39] offset:12288
    ds_write_b128 v62, v[36:39] offset:24576
    ds_write_b128 v62, v[36:39] offset:36864
    v_mov_b32 v16, 161908
    v_mov_b32 v17, 1
    s_mov_b64 exec, 1
    s_waitcnt lgkmcnt(0)
    ds_add_u32 v16, v17
    s_mov_b64 exec, -1
    v_and_b32 v13, 15, v12
    v_lshrrev_b32 v14, 4, v12
    v_and_b32 v0, 3, v12
    v_lshlrev_b32 v0, 2, v0
    v_add_u32 v0, 161904, v0
    s_mul_i32 s51, s49, 224
    s_lshr_b32 s86, s51, 1
    s_add_u32 s86, s86, 2560
    v_lshl_add_u32 v3, v14, 4, s86
    v_mul_u32_u24 v8, 224, v12
    s_add_u32 s86, s51, 2097152
    v_add_u32 v8, s86, v8
    s_add_u32 s51, s51, 50144
    v_lshl_add_u32 v4, v12, 4, s51
    v_and_b32 v9, 12, v12
    v_lshl_add_u32 v1, v14, 5, v9
    v_bfe_u32 v9, v12, 1, 1
    v_lshl_add_u32 v1, v9, 4, v1
    v_add_u32 v1, s51, v1
    v_and_b32 v5, 1, v12
    v_lshlrev_b32 v5, 4, v5
    s_mul_i32 s87, s47, 1088
    s_add_u32 s87, s87, 146512
    v_mul_u32_u24 v32, 576, v9
    v_lshrrev_b32 v9, 2, v12
    v_lshl_add_u32 v32, v9, 5, v32
    v_add3_u32 v32, v32, v5, s87
    v_lshl_add_u32 v33, v12, 3, s87
    v_and_b32 v6, 1, v12
    v_lshlrev_b32 v6, 3, v6
    v_and_b32 v9, 2, v12
    v_lshl_add_u32 v6, v9, 7, v6
    v_add_lshl_u32 v7, v12, s49, 2
    v_cmp_gt_u32 vcc, s50, v12
    s_mov_b32 s85, 10747904
    s_mov_b32 s94, 0
    s_mov_b32 s95, 0xffff0000
    v_cndmask_b32 v7, 2.0, v7, vcc
    s_lshl_b32 s51, s49, 5
    s_and_b32 s40, s46, 31
    s_add_u32 s51, s51, s40
    s_lshl_b32 s51, s51, 4
    v_add_lshl_u32 v15, v13, s51, 5
    v_lshl_add_u32 v15, v14, 3, v15
    v_lshlrev_b32 v13, 3, v12
    v_mov_b32 v44, 0
    v_mov_b32 v45, 0
    v_mov_b32 v46, 0
    v_mov_b32 v47, 0
    v_mov_b32 v48, 0
    v_mov_b32 v49, 0
    v_mov_b32 v50, 0
    v_mov_b32 v51, 0
    v_mov_b32 v52, 0
    v_mov_b32 v53, 0
    v_mov_b32 v54, 0
    v_mov_b32 v55, 0
    v_mov_b32 v56, 0
    v_mov_b32 v57, 0
    v_mov_b32 v58, 0
    v_mov_b32 v59, 0
    v_mov_b32 v60, 0
    v_mov_b32 v61, 0
    v_mov_b32 v62, 0
    v_mov_b32 v63, 0
    v_mov_b32 v64, 0
    v_mov_b32 v65, 0
    v_mov_b32 v66, 0
    v_mov_b32 v67, 0
    v_mov_b32 v68, 0
    v_mov_b32 v69, 0
    v_mov_b32 v70, 0
    v_mov_b32 v71, 0
    v_mov_b32 v72, 0
    v_mov_b32 v73, 0
    v_mov_b32 v74, 0
    v_mov_b32 v75, 0
    v_mov_b32 v76, 0
    v_mov_b32 v77, 0
    v_mov_b32 v78, 0
    v_mov_b32 v79, 0
    v_mov_b32 v80, 0
    v_mov_b32 v81, 0
    v_mov_b32 v82, 0
    v_mov_b32 v83, 0
    v_mov_b32 v84, 0
    v_mov_b32 v85, 0
    v_mov_b32 v86, 0
    v_mov_b32 v87, 0
    v_mov_b32 v88, 0
    v_mov_b32 v89, 0
    v_mov_b32 v90, 0
    v_mov_b32 v91, 0
    v_mov_b32 v92, 0
    v_mov_b32 v93, 0
    v_mov_b32 v94, 0
    v_mov_b32 v95, 0
    v_mov_b32 v96, 0
    v_mov_b32 v97, 0
    v_mov_b32 v98, 0
    v_mov_b32 v99, 0
    v_mov_b32 v100, 0
    v_mov_b32 v101, 0
    v_mov_b32 v102, 0
    v_mov_b32 v103, 0
    v_mov_b32 v120, 0
    v_mov_b32 v121, 0
    v_mov_b32 v122, 0
    v_mov_b32 v123, 0
    v_mov_b32 v124, 0
    v_mov_b32 v125, 0
    v_mov_b32 v126, 0
    v_mov_b32 v127, 0
    s_lshr_b32 s40, s46, 5
    s_mul_i32 s40, s40, 3200000
    s_add_u32 s28, s6, s40
    s_addc_u32 s29, s7, 0
    s_mov_b32 s30, 3200000
    s_mov_b32 s31, 0x20000
    s_add_u32 s12, s8, s40
    s_addc_u32 s13, s9, 0
    s_mov_b32 s14, 3200000
    s_mov_b32 s15, 0x20000
    s_mov_b32 s42, 1
    v_mov_b32 v18, 161900
P2_pre:
    ds_read_b32 v16, v0 offset:16
    ds_read_b32 v17, v18
    s_waitcnt lgkmcnt(0)
    v_cmp_eq_u32 vcc, 0, v16
    s_cbranch_vccz P2_round0
    v_cmp_eq_u32 vcc, 0, v17
    s_cbranch_vccz P2_flush
    s_sleep 2
    s_branch P2_pre
P2_flush:
    buffer_store_dwordx4 v[104:107], v34, s[20:23], 0 offen sc1
    v_subrev_u32 v34, 12288, v34
    s_nop 0
    v_mov_b32 v104, 0
    v_mov_b32 v105, 0
    v_mov_b32 v106, 0
    v_mov_b32 v107, 0
    buffer_store_dwordx4 v[108:111], v34, s[20:23], 0 offen sc1
    v_subrev_u32 v34, 12288, v34
    s_nop 0
    v_mov_b32 v108, 0
    v_mov_b32 v109, 0
    v_mov_b32 v110, 0
    v_mov_b32 v111, 0
    buffer_store_dwordx4 v[112:115], v34, s[20:23], 0 offen sc1
    v_subrev_u32 v34, 12288, v34
    s_nop 0
    v_mov_b32 v112, 0
    v_mov_b32 v113, 0
    v_mov_b32 v114, 0
    v_mov_b32 v115, 0
    buffer_store_dwordx4 v[116:119], v34, s[20:23], 0 offen sc1
    v_subrev_u32 v34, 12288, v34
    s_nop 0
    v_mov_b32 v116, 0
    v_mov_b32 v117, 0
    v_mov_b32 v118, 0
    v_mov_b32 v119, 0
    s_mov_b32 s42, 0
    s_waitcnt vmcnt(0)
    v_mov_b32 v16, 161888
    v_mov_b32 v17, 1
    s_mov_b64 exec, 1
    s_waitcnt lgkmcnt(0)
    ds_add_u32 v16, v17
    s_mov_b64 exec, -1
P2_round0:
P2_cw0:
    ds_read_b32 v17, v0 offset:16
    ds_read_b32 v9, v1 offset:0
    ds_read_b32 v16, v7 offset:0
    s_waitcnt lgkmcnt(2)
    v_cmp_ge_u32 vcc, s48, v17
    v_and_b32 v17, 0x3fffffff, v17
    s_cbranch_vccz P2_cg0
    s_sleep 2
    s_branch P2_cw0
P2_cg0:
    v_cmp_lt_u32 vcc, s48, v17
    s_cbranch_vccz P2_drain1
    ds_write_b32 v7, v8 offset:0
    s_add_u32 s48, s48, 1
    s_waitcnt lgkmcnt(0)
    v_lshrrev_b32 v2, 24, v9
    v_mad_u32_u24 v9, v9, 32, v5
    s_waitcnt vmcnt(1)
    ds_write_b128 v32, v[52:55]
    buffer_load_dwordx4 v[52:55], v9, s[8:11], 0 offen
    ds_read_b64_tr_b16 v[28:29], v33
    ds_read_b64_tr_b16 v[30:31], v33 offset:576
    v_add_u32_dpp v10, v2, v6 quad_perm:[0,0,0,0] row_mask:0xf bank_mask:0xf
    v_add_u32_dpp v11, v2, v6 quad_perm:[2,2,2,2] row_mask:0xf bank_mask:0xf
    ds_read_b64_tr_b16 v[24:25], v10 offset:2048
    ds_read_b64_tr_b16 v[26:27], v11 offset:2048
    ds_read_b128 v[20:23], v3 offset:0
    ds_read_b32 v9, v1 offset:224
    v_cmp_le_u32 s[90:91], s85, v16
    s_waitcnt lgkmcnt(4)
    v_mfma_f32_16x16x32_bf16 v[120:123], v[28:31], v[44:47], v[120:123]
    s_bitcmp1_b32 s90, 0
    s_waitcnt lgkmcnt(1)
    v_and_b32 v44, v24, v20
    v_and_b32 v45, v25, v21
    v_and_b32 v46, v26, v22
    v_and_b32 v47, v27, v23
    s_cbranch_scc1 P2_slow0_0
P2_back0_0:
    s_waitcnt lgkmcnt(0)
    v_lshrrev_b32 v2, 24, v9
    v_mad_u32_u24 v9, v9, 32, v5
    s_waitcnt vmcnt(1)
    s_cmp_lg_u32 s84, 0
    s_cbranch_scc1 P2_nt0
    ds_write_b128 v32, v[56:59]
    ds_read_b64_tr_b16 v[28:29], v33
    ds_read_b64_tr_b16 v[30:31], v33 offset:576
P2_nt0:
    buffer_load_dwordx4 v[56:59], v9, s[8:11], 0 offen
    v_add_u32_dpp v10, v2, v6 quad_perm:[0,0,0,0] row_mask:0xf bank_mask:0xf
    v_add_u32_dpp v11, v2, v6 quad_perm:[2,2,2,2] row_mask:0xf bank_mask:0xf
    ds_read_b64_tr_b16 v[24:25], v10 offset:2048
    ds_read_b64_tr_b16 v[26:27], v11 offset:2048
    ds_read_b128 v[20:23], v3 offset:112
    ds_read_b32 v9, v1 offset:448
    s_cbranch_scc1 P2_nm0
    s_waitcnt lgkmcnt(4)
    v_mfma_f32_16x16x32_bf16 v[124:127], v[28:31], v[48:51], v[124:127]
P2_nm0:
    s_bitcmp1_b32 s90, 1
    s_waitcnt lgkmcnt(1)
    v_and_b32 v48, v24, v20
    v_and_b32 v49, v25, v21
    v_and_b32 v50, v26, v22
    v_and_b32 v51, v27, v23
    s_cbranch_scc1 P2_slow0_1
P2_back0_1:
    s_waitcnt lgkmcnt(0)
    v_lshrrev_b32 v2, 24, v9
    v_mad_u32_u24 v9, v9, 32, v5
    s_bitcmp1_b32 s90, 2
    s_waitcnt vmcnt(1)
    ds_write_b128 v32, v[52:55]
    buffer_load_dwordx4 v[52:55], v9, s[8:11], 0 offen
    ds_read_b64_tr_b16 v[28:29], v33
    ds_read_b64_tr_b16 v[30:31], v33 offset:576
    v_add_u32_dpp v10, v2, v6 quad_perm:[0,0,0,0] row_mask:0xf bank_mask:0xf
    v_add_u32_dpp v11, v2, v6 quad_perm:[2,2,2,2] row_mask:0xf bank_mask:0xf
    ds_read_b64_tr_b16 v[24:25], v10 offset:2048
    ds_read_b64_tr_b16 v[26:27], v11 offset:2048
    ds_read_b128 v[20:23], v3 offset:224
    ds_read_b32 v9, v1 offset:672
    s_waitcnt lgkmcnt(1)
    v_mfma_f32_16x16x32_bf16 v[60:63], v[28:31], v[44:47], v[60:63]
    v_and_b32 v44, v24, v20
    v_and_b32 v45, v25, v21
    v_and_b32 v46, v26, v22
    v_and_b32 v47, v27, v23
    s_cbranch_scc1 P2_slow0_2
P2_back0_2:
    s_waitcnt lgkmcnt(0)
    v_lshrrev_b32 v2, 24, v9
    v_mad_u32_u24 v9, v9, 32, v5
    s_bitcmp1_b32 s90, 3
    s_waitcnt vmcnt(1)
    ds_write_b128 v32, v[56:59]
    buffer_load_dwordx4 v[56:59], v9, s[8:11], 0 offen
    ds_read_b64_tr_b16 v[28:29], v33
    ds_read_b64_tr_b16 v[30:31], v33 offset:576
    v_add_u32_dpp v10, v2, v6 quad_perm:[0,0,0,0] row_mask:0xf bank_mask:0xf
    v_add_u32_dpp v11, v2, v6 quad_perm:[2,2,2,2] row_mask:0xf bank_mask:0xf
    ds_read_b64_tr_b16 v[24:25], v10 offset:2048
    ds_read_b64_tr_b16 v[26:27], v11 offset:2048
    ds_read_b128 v[20:23], v3 offset:336
    ds_read_b32 v9, v1 offset:896
    s_waitcnt lgkmcnt(1)
    v_mfma_f32_16x16x32_bf16 v[64:67], v[28:31], v[48:51], v[64:67]
    v_and_b32 v48, v24, v20
    v_and_b32 v49, v25, v21
    v_and_b32 v50, v26, v22
    v_and_b32 v51, v27, v23
    s_cbranch_scc1 P2_slow0_3
P2_back0_3:
    s_waitcnt lgkmcnt(0)
    v_lshrrev_b32 v2, 24, v9
    v_mad_u32_u24 v9, v9, 32, v5
    s_bitcmp1_b32 s90, 4
    s_waitcnt vmcnt(1)
    ds_write_b128 v32, v[52:55]
    buffer_load_dwordx4 v[52:55], v9, s[8:11], 0 offen
    ds_read_b64_tr_b16 v[28:29], v33
    ds_read_b64_tr_b16 v[30:31], v33 offset:576
    v_add_u32_dpp v10, v2, v6 quad_perm:[0,0,0,0] row_mask:0xf bank_mask:0xf
    v_add_u32_dpp v11, v2, v6 quad_perm:[2,2,2,2] row_mask:0xf bank_mask:0xf
    ds_read_b64_tr_b16 v[24:25], v10 offset:2048
    ds_read_b64_tr_b16 v[26:27], v11 offset:2048
    ds_read_b128 v[20:23], v3 offset:448
    ds_read_b32 v9, v1 offset:1120
    s_waitcnt lgkmcnt(1)
    v_mfma_f32_16x16x32_bf16 v[68:71], v[28:31], v[44:47], v[68:71]
    v_and_b32 v44, v24, v20
    v_and_b32 v45, v25, v21
    v_and_b32 v46, v26, v22
    v_and_b32 v47, v27, v23
    s_cbranch_scc1 P2_slow0_4
P2_back0_4:
    s_waitcnt lgkmcnt(0)
    v_lshrrev_b32 v2, 24, v9
    v_mad_u32_u24 v9, v9, 32, v5
    s_bitcmp1_b32 s90, 5
    s_waitcnt vmcnt(1)
    ds_write_b128 v32, v[56:59]
    buffer_load_dwordx4 v[56:59], v9, s[8:11], 0 offen
    ds_read_b64_tr_b16 v[28:29], v33
    ds_read_b64_tr_b16 v[30:31], v33 offset:576
    v_add_u32_dpp v10, v2, v6 quad_perm:[0,0,0,0] row_mask:0xf bank_mask:0xf
    v_add_u32_dpp v11, v2, v6 quad_perm:[2,2,2,2] row_mask:0xf bank_mask:0xf
    ds_read_b64_tr_b16 v[24:25], v10 offset:2048
    ds_read_b64_tr_b16 v[26:27], v11 offset:2048
    ds_read_b128 v[20:23], v3 offset:560
    ds_read_b32 v9, v1 offset:1344
    s_waitcnt lgkmcnt(1)
    v_mfma_f32_16x16x32_bf16 v[72:75], v[28:31], v[48:51], v[72:75]
    v_and_b32 v48, v24, v20
    v_and_b32 v49, v25, v21
    v_and_b32 v50, v26, v22
    v_and_b32 v51, v27, v23
    s_cbranch_scc1 P2_slow0_5
P2_back0_5:
    s_waitcnt lgkmcnt(0)
    v_lshrrev_b32 v2, 24, v9
    v_mad_u32_u24 v9, v9, 32, v5
    s_bitcmp1_b32 s90, 6
    s_waitcnt vmcnt(1)
    ds_write_b128 v32, v[52:55]
    buffer_load_dwordx4 v[52:55], v9, s[8:11], 0 offen
    ds_read_b64_tr_b16 v[28:29], v33
    ds_read_b64_tr_b16 v[30:31], v33 offset:576
    v_add_u32_dpp v10, v2, v6 quad_perm:[0,0,0,0] row_mask:0xf bank_mask:0xf
    v_add_u32_dpp v11, v2, v6 quad_perm:[2,2,2,2] row_mask:0xf bank_mask:0xf
    ds_read_b64_tr_b16 v[24:25], v10 offset:2048
    ds_read_b64_tr_b16 v[26:27], v11 offset:2048
    ds_read_b128 v[20:23], v3 offset:672
    ds_read_b32 v9, v1 offset:1568
    s_waitcnt lgkmcnt(1)
    v_mfma_f32_16x16x32_bf16 v[76:79], v[28:31], v[44:47], v[76:79]
    v_and_b32 v44, v24, v20
    v_and_b32 v45, v25, v21
    v_and_b32 v46, v26, v22
    v_and_b32 v47, v27, v23
    s_cbranch_scc1 P2_slow0_6
P2_back0_6:
    s_waitcnt lgkmcnt(0)
    v_lshrrev_b32 v2, 24, v9
    v_mad_u32_u24 v9, v9, 32, v5
    s_bitcmp1_b32 s90, 7
    s_waitcnt vmcnt(1)
    ds_write_b128 v32, v[56:59]
    buffer_load_dwordx4 v[56:59], v9, s[8:11], 0 offen
    ds_read_b64_tr_b16 v[28:29], v33
    ds_read_b64_tr_b16 v[30:31], v33 offset:576
    v_add_u32_dpp v10, v2, v6 quad_perm:[0,0,0,0] row_mask:0xf bank_mask:0xf
    v_add_u32_dpp v11, v2, v6 quad_perm:[2,2,2,2] row_mask:0xf bank_mask:0xf
    ds_read_b64_tr_b16 v[24:25], v10 offset:2048
    ds_read_b64_tr_b16 v[26:27], v11 offset:2048
    ds_read_b128 v[20:23], v3 offset:784
    ds_read_b32 v9, v1 offset:1792
    s_waitcnt lgkmcnt(1)
    v_mfma_f32_16x16x32_bf16 v[80:83], v[28:31], v[48:51], v[80:83]
    v_and_b32 v48, v24, v20
    v_and_b32 v49, v25, v21
    v_and_b32 v50, v26, v22
    v_and_b32 v51, v27, v23
    s_cbranch_scc1 P2_slow0_7
P2_back0_7:
    s_waitcnt lgkmcnt(0)
    v_lshrrev_b32 v2, 24, v9
    v_mad_u32_u24 v9, v9, 32, v5
    s_bitcmp1_b32 s90, 8
    s_waitcnt vmcnt(1)
    ds_write_b128 v32, v[52:55]
    buffer_load_dwordx4 v[52:55], v9, s[8:11], 0 offen
    ds_read_b64_tr_b16 v[28:29], v33
    ds_read_b64_tr_b16 v[30:31], v33 offset:576
    v_add_u32_dpp v10, v2, v6 quad_perm:[0,0,0,0] row_mask:0xf bank_mask:0xf
    v_add_u32_dpp v11, v2, v6 quad_perm:[2,2,2,2] row_mask:0xf bank_mask:0xf
    ds_read_b64_tr_b16 v[24:25], v10 offset:2048
    ds_read_b64_tr_b16 v[26:27], v11 offset:2048
    ds_read_b128 v[20:23], v3 offset:896
    ds_read_b32 v9, v1 offset:2016
    s_waitcnt lgkmcnt(1)
    v_mfma_f32_16x16x32_bf16 v[84:87], v[28:31], v[44:47], v[84:87]
    v_and_b32 v44, v24, v20
    v_and_b32 v45, v25, v21
    v_and_b32 v46, v26, v22
    v_and_b32 v47, v27, v23
    s_cbranch_scc1 P2_slow0_8
P2_back0_8:
    s_waitcnt lgkmcnt(0)
    v_lshrrev_b32 v2, 24, v9
    v_mad_u32_u24 v9, v9, 32, v5
    s_bitcmp1_b32 s90, 9
    s_waitcnt vmcnt(1)
    ds_write_b128 v32, v[56:59]
    buffer_load_dwordx4 v[56:59], v9, s[8:11], 0 offen
    ds_read_b64_tr_b16 v[28:29], v33
    ds_read_b64_tr_b16 v[30:31], v33 offset:576
    v_add_u32_dpp v10, v2, v6 quad_perm:[0,0,0,0] row_mask:0xf bank_mask:0xf
    v_add_u32_dpp v11, v2, v6 quad_perm:[2,2,2,2] row_mask:0xf bank_mask:0xf
    ds_read_b64_tr_b16 v[24:25], v10 offset:2048
    ds_read_b64_tr_b16 v[26:27], v11 offset:2048
    ds_read_b128 v[20:23], v3 offset:1008
    ds_read_b32 v9, v1 offset:2240
    s_waitcnt lgkmcnt(1)
    v_mfma_f32_16x16x32_bf16 v[88:91], v[28:31], v[48:51], v[88:91]
    v_and_b32 v48, v24, v20
    v_and_b32 v49, v25, v21
    v_and_b32 v50, v26, v22
    v_and_b32 v51, v27, v23
    s_cbranch_scc1 P2_slow0_9
P2_back0_9:
    s_waitcnt lgkmcnt(0)
    v_lshrrev_b32 v2, 24, v9
    v_mad_u32_u24 v9, v9, 32, v5
    s_bitcmp1_b32 s90, 10
    s_waitcnt vmcnt(1)
    ds_write_b128 v32, v[52:55]
    buffer_load_dwordx4 v[52:55], v9, s[8:11], 0 offen
    ds_read_b64_tr_b16 v[28:29], v33
    ds_read_b64_tr_b16 v[30:31], v33 offset:576
    v_add_u32_dpp v10, v2, v6 quad_perm:[0,0,0,0] row_mask:0xf bank_mask:0xf
    v_add_u32_dpp v11, v2, v6 quad_perm:[2,2,2,2] row_mask:0xf bank_mask:0xf
    ds_read_b64_tr_b16 v[24:25], v10 offset:2048
    ds_read_b64_tr_b16 v[26:27], v11 offset:2048
    ds_read_b128 v[20:23], v3 offset:1120
    ds_read_b32 v9, v1 offset:2464
    s_waitcnt lgkmcnt(1)
    v_mfma_f32_16x16x32_bf16 v[92:95], v[28:31], v[44:47], v[92:95]
    v_and_b32 v44, v24, v20
    v_and_b32 v45, v25, v21
    v_and_b32 v46, v26, v22
    v_and_b32 v47, v27, v23
    s_cbranch_scc1 P2_slow0_10
P2_back0_10:
    s_cmp_lg_u32 s42, 0
    s_cbranch_scc1 P2_lazy10
P2_lazyb10:
    s_waitcnt lgkmcnt(0)
    v_lshrrev_b32 v2, 24, v9
    v_mad_u32_u24 v9, v9, 32, v5
    s_bitcmp1_b32 s90, 11
    s_waitcnt vmcnt(1)
    ds_write_b128 v32, v[56:59]
    buffer_load_dwordx4 v[56:59], v9, s[8:11], 0 offen
    ds_read_b64_tr_b16 v[28:29], v33
    ds_read_b64_tr_b16 v[30:31], v33 offset:576
    v_add_u32_dpp v10, v2, v6 quad_perm:[0,0,0,0] row_mask:0xf bank_mask:0xf
    v_add_u32_dpp v11, v2, v6 quad_perm:[2,2,2,2] row_mask:0xf bank_mask:0xf
    ds_read_b64_tr_b16 v[24:25], v10 offset:2048
    ds_read_b64_tr_b16 v[26:27], v11 offset:2048
    ds_read_b128 v[20:23], v3 offset:1232
    ds_read_b32 v9, v1 offset:2688
    s_waitcnt lgkmcnt(1)
    v_mfma_f32_16x16x32_bf16 v[96:99], v[28:31], v[48:51], v[96:99]
    v_and_b32 v48, v24, v20
    v_and_b32 v49, v25, v21
    v_and_b32 v50, v26, v22
    v_and_b32 v51, v27, v23
    s_cbranch_scc1 P2_slow0_11
P2_back0_11:
    s_waitcnt lgkmcnt(0)
    v_lshrrev_b32 v2, 24, v9
    v_mad_u32_u24 v9, v9, 32, v5
    s_bitcmp1_b32 s90, 12
    s_waitcnt vmcnt(1)
    ds_write_b128 v32, v[52:55]
    buffer_load_dwordx4 v[52:55], v9, s[8:11], 0 offen
    ds_read_b64_tr_b16 v[28:29], v33
    ds_read_b64_tr_b16 v[30:31], v33 offset:576
    v_add_u32_dpp v10, v2, v6 quad_perm:[0,0,0,0] row_mask:0xf bank_mask:0xf
    v_add_u32_dpp v11, v2, v6 quad_perm:[2,2,2,2] row_mask:0xf bank_mask:0xf
    ds_read_b64_tr_b16 v[24:25], v10 offset:2048
    ds_read_b64_tr_b16 v[26:27], v11 offset:2048
    ds_read_b128 v[20:23], v3 offset:1344
    ds_read_b32 v9, v1 offset:2912
    s_waitcnt lgkmcnt(1)
    v_mfma_f32_16x16x32_bf16 v[100:103], v[28:31], v[44:47], v[100:103]
    v_and_b32 v44, v24, v20
    v_and_b32 v45, v25, v21
    v_and_b32 v46, v26, v22
    v_and_b32 v47, v27, v23
    s_cbranch_scc1 P2_slow0_12
P2_back0_12:
    s_waitcnt lgkmcnt(0)
    v_lshrrev_b32 v2, 24, v9
    v_mad_u32_u24 v9, v9, 32, v5
    s_bitcmp1_b32 s90, 13
    s_waitcnt vmcnt(1)
    ds_write_b128 v32, v[56:59]
    buffer_load_dwordx4 v[56:59], v9, s[8:11], 0 offen
    ds_read_b64_tr_b16 v[28:29], v33
    ds_read_b64_tr_b16 v[30:31], v33 offset:576
    v_add_u32_dpp v10, v2, v6 quad_perm:[0,0,0,0] row_mask:0xf bank_mask:0xf
    v_add_u32_dpp v11, v2, v6 quad_perm:[2,2,2,2] row_mask:0xf bank_mask:0xf
    ds_read_b64_tr_b16 v[24:25], v10 offset:2048
    ds_read_b64_tr_b16 v[26:27], v11 offset:2048
    ds_read_b128 v[20:23], v3 offset:1456
    ds_read_b32 v9, v1 offset:3136
    s_waitcnt lgkmcnt(1)
    v_mfma_f32_16x16x32_bf16 v[104:107], v[28:31], v[48:51], v[104:107]
    v_and_b32 v48, v24, v20
    v_and_b32 v49, v25, v21
    v_and_b32 v50, v26, v22
    v_and_b32 v51, v27, v23
    s_cbranch_scc1 P2_slow0_13
P2_back0_13:
    s_waitcnt lgkmcnt(0)
    v_lshrrev_b32 v2, 24, v9
    v_mad_u32_u24 v9, v9, 32, v5
    s_bitcmp1_b32 s90, 14
    s_waitcnt vmcnt(1)
    ds_write_b128 v32, v[52:55]
    buffer_load_dwordx4 v[52:55], v9, s[8:11], 0 offen
    ds_read_b64_tr_b16 v[28:29], v33
    ds_read_b64_tr_b16 v[30:31], v33 offset:576
    v_add_u32_dpp v10, v2, v6 quad_perm:[0,0,0,0] row_mask:0xf bank_mask:0xf
    v_add_u32_dpp v11, v2, v6 quad_perm:[2,2,2,2] row_mask:0xf bank_mask:0xf
    ds_read_b64_tr_b16 v[24:25], v10 offset:2048
    ds_read_b64_tr_b16 v[26:27], v11 offset:2048
    ds_read_b128 v[20:23], v3 offset:1568
    ds_read_b32 v9, v1 offset:3360
    s_waitcnt lgkmcnt(1)
    v_mfma_f32_16x16x32_bf16 v[108:111], v[28:31], v[44:47], v[108:111]
    v_and_b32 v44, v24, v20
    v_and_b32 v45, v25, v21
    v_and_b32 v46, v26, v22
    v_and_b32 v47, v27, v23
    s_cbranch_scc1 P2_slow0_14
P2_back0_14:
    s_waitcnt lgkmcnt(0)
    v_lshrrev_b32 v2, 24, v9
    v_mad_u32_u24 v9, v9, 32, v5
    s_bitcmp1_b32 s90, 15
    s_waitcnt vmcnt(1)
    ds_write_b128 v32, v[56:59]
    buffer_load_dwordx4 v[56:59], v9, s[8:11], 0 offen
    ds_read_b64_tr_b16 v[28:29], v33
    ds_read_b64_tr_b16 v[30:31], v33 offset:576
    v_add_u32_dpp v10, v2, v6 quad_perm:[0,0,0,0] row_mask:0xf bank_mask:0xf
    v_add_u32_dpp v11, v2, v6 quad_perm:[2,2,2,2] row_mask:0xf bank_mask:0xf
    ds_read_b64_tr_b16 v[24:25], v10 offset:2048
    ds_read_b64_tr_b16 v[26:27], v11 offset:2048
    ds_read_b128 v[20:23], v3 offset:1680
    ds_read_b32 v9, v1 offset:3584
    s_waitcnt lgkmcnt(1)
    v_mfma_f32_16x16x32_bf16 v[112:115], v[28:31], v[48:51], v[112:115]
    v_and_b32 v48, v24, v20
    v_and_b32 v49, v25, v21
    v_and_b32 v50, v26, v22
    v_and_b32 v51, v27, v23
    s_cbranch_scc1 P2_slow0_15
P2_back0_15:
    s_waitcnt lgkmcnt(0)
    v_or_b32 v9, s84, v9
    v_lshrrev_b32 v2, 24, v9
    v_mad_u32_u24 v9, v9, 32, v5
    s_waitcnt vmcnt(1)
    ds_write_b128 v32, v[52:55]
    buffer_load_dwordx4 v[52:55], v9, s[8:11], 0 offen
    ds_read_b64_tr_b16 v[28:29], v33
    ds_read_b64_tr_b16 v[30:31], v33 offset:576
    s_cmp_lg_u32 s84, 0
    s_cbranch_scc1 P2_last0
    v_add_u32_dpp v10, v2, v6 quad_perm:[0,0,0,0] row_mask:0xf bank_mask:0xf
    v_add_u32_dpp v11, v2, v6 quad_perm:[2,2,2,2] row_mask:0xf bank_mask:0xf
    ds_read_b64_tr_b16 v[24:25], v10 offset:2048
    ds_read_b64_tr_b16 v[26:27], v11 offset:2048
    ds_read_b128 v[20:23], v3 offset:1792
    s_waitcnt lgkmcnt(3)
    v_mfma_f32_16x16x32_bf16 v[116:119], v[28:31], v[44:47], v[116:119]
    s_bitcmp1_b32 s90, 16
    s_waitcnt lgkmcnt(0)
    v_and_b32 v44, v24, v20
    v_and_b32 v45, v25, v21
    v_and_b32 v46, v26, v22
    v_and_b32 v47, v27, v23
    s_cbranch_scc1 P2_slow0_16
P2_back0_16:
    s_cmp_eq_u32 s42, 0
    s_cbranch_scc1 P2_nolz
    s_mov_b32 s42, 0
    s_waitcnt vmcnt(0)
    v_mov_b32 v16, 161888
    v_mov_b32 v17, 1
    s_mov_b64 exec, 1
    s_waitcnt lgkmcnt(0)
    ds_add_u32 v16, v17
    s_mov_b64 exec, -1
P2_nolz:
    v_mov_b32 v16, 940572672
    v_mov_b32 v17, 940572672
    v_mov_b32 v18, 940572672
    v_mov_b32 v19, 940572672
    ds_write_b128 v4, v[16:19] offset:0
    ds_write_b128 v4, v[16:19] offset:1024
    ds_write_b128 v4, v[16:19] offset:2048
    s_mov_b64 exec, s[92:93]
    ds_write_b128 v4, v[16:19] offset:3072
    s_mov_b64 exec, 1
    v_mov_b32 v9, 1
    s_waitcnt lgkmcnt(0)
    ds_add_rtn_u32 v9, v0, v9 offset:0
    s_lshr_b32 s40, s48, 1
    s_mul_i32 s40, s40, 12
    s_waitcnt lgkmcnt(0)
    v_readfirstlane_b32 s41, v9
    s_mov_b64 exec, -1
    s_sub_u32 s41, s41, s40
    s_setprio 0
    s_cmp_lt_u32 s41, 6
    s_cbranch_scc1 P2_round1
    s_setprio 1
    s_cmp_lt_u32 s41, 10
    s_cbranch_scc1 P2_round1
    s_setprio 2
P2_round1:
P2_cw1:
    ds_read_b32 v17, v0 offset:16
    ds_read_b32 v9, v1 offset:51232
    ds_read_b32 v16, v7 offset:1024
    s_waitcnt lgkmcnt(2)
    v_cmp_ge_u32 vcc, s48, v17
    v_and_b32 v17, 0x3fffffff, v17
    s_cbranch_vccz P2_cg1
    s_sleep 2
    s_branch P2_cw1
P2_cg1:
    v_cmp_lt_u32 vcc, s48, v17
    s_cbranch_vccz P2_drain0
    v_add_u32 v18, 51232, v8
    ds_write_b32 v7, v18 offset:1024
    s_add_u32 s48, s48, 1
    s_waitcnt lgkmcnt(0)
    v_lshrrev_b32 v2, 24, v9
    v_mad_u32_u24 v9, v9, 32, v5
    s_waitcnt vmcnt(1)
    ds_write_b128 v32, v[56:59]
    buffer_load_dwordx4 v[56:59], v9, s[8:11], 0 offen
    ds_read_b64_tr_b16 v[28:29], v33
    ds_read_b64_tr_b16 v[30:31], v33 offset:576
    v_add_u32_dpp v10, v2, v6 quad_perm:[0,0,0,0] row_mask:0xf bank_mask:0xf
    v_add_u32_dpp v11, v2, v6 quad_perm:[2,2,2,2] row_mask:0xf bank_mask:0xf
    ds_read_b64_tr_b16 v[24:25], v10 offset:2048
    ds_read_b64_tr_b16 v[26:27], v11 offset:2048
    ds_read_b128 v[20:23], v3 offset:25616
    ds_read_b32 v9, v1 offset:51456
    v_cmp_le_u32 s[90:91], s85, v16
    s_waitcnt lgkmcnt(4)
    v_mfma_f32_16x16x32_bf16 v[120:123], v[28:31], v[48:51], v[120:123]
    s_bitcmp1_b32 s90, 0
    s_waitcnt lgkmcnt(1)
    v_and_b32 v48, v24, v20
    v_and_b32 v49, v25, v21
    v_and_b32 v50, v26, v22
    v_and_b32 v51, v27, v23
    s_cbranch_scc1 P2_slow1_0
P2_back1_0:
    s_waitcnt lgkmcnt(0)
    v_lshrrev_b32 v2, 24, v9
    v_mad_u32_u24 v9, v9, 32, v5
    s_waitcnt vmcnt(1)
    s_cmp_lg_u32 s84, 0
    s_cbranch_scc1 P2_nt1
    ds_write_b128 v32, v[52:55]
    ds_read_b64_tr_b16 v[28:29], v33
    ds_read_b64_tr_b16 v[30:31], v33 offset:576
P2_nt1:
    buffer_load_dwordx4 v[52:55], v9, s[8:11], 0 offen
    v_add_u32_dpp v10, v2, v6 quad_perm:[0,0,0,0] row_mask:0xf bank_mask:0xf
    v_add_u32_dpp v11, v2, v6 quad_perm:[2,2,2,2] row_mask:0xf bank_mask:0xf
    ds_read_b64_tr_b16 v[24:25], v10 offset:2048
    ds_read_b64_tr_b16 v[26:27], v11 offset:2048
    ds_read_b128 v[20:23], v3 offset:25728
    ds_read_b32 v9, v1 offset:51680
    s_cbranch_scc1 P2_nm1
    s_waitcnt lgkmcnt(4)
    v_mfma_f32_16x16x32_bf16 v[124:127], v[28:31], v[44:47], v[124:127]
P2_nm1:
    s_bitcmp1_b32 s90, 1
    s_waitcnt lgkmcnt(1)
    v_and_b32 v44, v24, v20
    v_and_b32 v45, v25, v21
    v_and_b32 v46, v26, v22
    v_and_b32 v47, v27, v23
    s_cbranch_scc1 P2_slow1_1
P2_back1_1:
    s_waitcnt lgkmcnt(0)
    v_lshrrev_b32 v2, 24, v9
    v_mad_u32_u24 v9, v9, 32, v5
    s_bitcmp1_b32 s90, 2
    s_waitcnt vmcnt(1)
    ds_write_b128 v32, v[56:59]
    buffer_load_dwordx4 v[56:59], v9, s[8:11], 0 offen
    ds_read_b64_tr_b16 v[28:29], v33
    ds_read_b64_tr_b16 v[30:31], v33 offset:576
    v_add_u32_dpp v10, v2, v6 quad_perm:[0,0,0,0] row_mask:0xf bank_mask:0xf
    v_add_u32_dpp v11, v2, v6 quad_perm:[2,2,2,2] row_mask:0xf bank_mask:0xf
    ds_read_b64_tr_b16 v[24:25], v10 offset:2048
    ds_read_b64_tr_b16 v[26:27], v11 offset:2048
    ds_read_b128 v[20:23], v3 offset:25840
    ds_read_b32 v9, v1 offset:51904
    s_waitcnt lgkmcnt(1)
    v_mfma_f32_16x16x32_bf16 v[60:63], v[28:31], v[48:51], v[60:63]
    v_and_b32 v48, v24, v20
    v_and_b32 v49, v25, v21
    v_and_b32 v50, v26, v22
    v_and_b32 v51, v27, v23
    s_cbranch_scc1 P2_slow1_2
P2_back1_2:
    s_waitcnt lgkmcnt(0)
    v_lshrrev_b32 v2, 24, v9
    v_mad_u32_u24 v9, v9, 32, v5
    s_bitcmp1_b32 s90, 3
    s_waitcnt vmcnt(1)
    ds_write_b128 v32, v[52:55]
    buffer_load_dwordx4 v[52:55], v9, s[8:11], 0 offen
    ds_read_b64_tr_b16 v[28:29], v33
    ds_read_b64_tr_b16 v[30:31], v33 offset:576
    v_add_u32_dpp v10, v2, v6 quad_perm:[0,0,0,0] row_mask:0xf bank_mask:0xf
    v_add_u32_dpp v11, v2, v6 quad_perm:[2,2,2,2] row_mask:0xf bank_mask:0xf
    ds_read_b64_tr_b16 v[24:25], v10 offset:2048
    ds_read_b64_tr_b16 v[26:27], v11 offset:2048
    ds_read_b128 v[20:23], v3 offset:25952
    ds_read_b32 v9, v1 offset:52128
    s_waitcnt lgkmcnt(1)
    v_mfma_f32_16x16x32_bf16 v[64:67], v[28:31], v[44:47], v[64:67]
    v_and_b32 v44, v24, v20
    v_and_b32 v45, v25, v21
    v_and_b32 v46, v26, v22
    v_and_b32 v47, v27, v23
    s_cbranch_scc1 P2_slow1_3
P2_back1_3:
    s_waitcnt lgkmcnt(0)
    v_lshrrev_b32 v2, 24, v9
    v_mad_u32_u24 v9, v9, 32, v5
    s_bitcmp1_b32 s90, 4
    s_waitcnt vmcnt(1)
    ds_write_b128 v32, v[56:59]
    buffer_load_dwordx4 v[56:59], v9, s[8:11], 0 offen
    ds_read_b64_tr_b16 v[28:29], v33
    ds_read_b64_tr_b16 v[30:31], v33 offset:576
    v_add_u32_dpp v10, v2, v6 quad_perm:[0,0,0,0] row_mask:0xf bank_mask:0xf
    v_add_u32_dpp v11, v2, v6 quad_perm:[2,2,2,2] row_mask:0xf bank_mask:0xf
    ds_read_b64_tr_b16 v[24:25], v10 offset:2048
    ds_read_b64_tr_b16 v[26:27], v11 offset:2048
    ds_read_b128 v[20:23], v3 offset:26064
    ds_read_b32 v9, v1 offset:52352
    s_waitcnt lgkmcnt(1)
    v_mfma_f32_16x16x32_bf16 v[68:71], v[28:31], v[48:51], v[68:71]
    v_and_b32 v48, v24, v20
    v_and_b32 v49, v25, v21
    v_and_b32 v50, v26, v22
    v_and_b32 v51, v27, v23
    s_cbranch_scc1 P2_slow1_4
P2_back1_4:
    s_waitcnt lgkmcnt(0)
    v_lshrrev_b32 v2, 24, v9
    v_mad_u32_u24 v9, v9, 32, v5
    s_bitcmp1_b32 s90, 5
    s_waitcnt vmcnt(1)
    ds_write_b128 v32, v[52:55]
    buffer_load_dwordx4 v[52:55], v9, s[8:11], 0 offen
    ds_read_b64_tr_b16 v[28:29], v33
    ds_read_b64_tr_b16 v[30:31], v33 offset:576
    v_add_u32_dpp v10, v2, v6 quad_perm:[0,0,0,0] row_mask:0xf bank_mask:0xf
    v_add_u32_dpp v11, v2, v6 quad_perm:[2,2,2,2] row_mask:0xf bank_mask:0xf
    ds_read_b64_tr_b16 v[24:25], v10 offset:2048
    ds_read_b64_tr_b16 v[26:27], v11 offset:2048
    ds_read_b128 v[20:23], v3 offset:26176
    ds_read_b32 v9, v1 offset:52576
    s_waitcnt lgkmcnt(1)
    v_mfma_f32_16x16x32_bf16 v[72:75], v[28:31], v[44:47], v[72:75]
    v_and_b32 v44, v24, v20
    v_and_b32 v45, v25, v21
    v_and_b32 v46, v26, v22
    v_and_b32 v47, v27, v23
    s_cbranch_scc1 P2_slow1_5
P2_back1_5:
    s_waitcnt lgkmcnt(0)
    v_lshrrev_b32 v2, 24, v9
    v_mad_u32_u24 v9, v9, 32, v5
    s_bitcmp1_b32 s90, 6
    s_waitcnt vmcnt(1)
    ds_write_b128 v32, v[56:59]
    buffer_load_dwordx4 v[56:59], v9, s[8:11], 0 offen
    ds_read_b64_tr_b16 v[28:29], v33
    ds_read_b64_tr_b16 v[30:31], v33 offset:576
    v_add_u32_dpp v10, v2, v6 quad_perm:[0,0,0,0] row_mask:0xf bank_mask:0xf
    v_add_u32_dpp v11, v2, v6 quad_perm:[2,2,2,2] row_mask:0xf bank_mask:0xf
    ds_read_b64_tr_b16 v[24:25], v10 offset:2048
    ds_read_b64_tr_b16 v[26:27], v11 offset:2048
    ds_read_b128 v[20:23], v3 offset:26288
    ds_read_b32 v9, v1 offset:52800
    s_waitcnt lgkmcnt(1)
    v_mfma_f32_16x16x32_bf16 v[76:79], v[28:31], v[48:51], v[76:79]
    v_and_b32 v48, v24, v20
    v_and_b32 v49, v25, v21
    v_and_b32 v50, v26, v22
    v_and_b32 v51, v27, v23
    s_cbranch_scc1 P2_slow1_6
P2_back1_6:
    s_waitcnt lgkmcnt(0)
    v_lshrrev_b32 v2, 24, v9
    v_mad_u32_u24 v9, v9, 32, v5
    s_bitcmp1_b32 s90, 7
    s_waitcnt vmcnt(1)
    ds_write_b128 v32, v[52:55]
    buffer_load_dwordx4 v[52:55], v9, s[8:11], 0 offen
    ds_read_b64_tr_b16 v[28:29], v33
    ds_read_b64_tr_b16 v[30:31], v33 offset:576
    v_add_u32_dpp v10, v2, v6 quad_perm:[0,0,0,0] row_mask:0xf bank_mask:0xf
    v_add_u32_dpp v11, v2, v6 quad_perm:[2,2,2,2] row_mask:0xf bank_mask:0xf
    ds_read_b64_tr_b16 v[24:25], v10 offset:2048
    ds_read_b64_tr_b16 v[26:27], v11 offset:2048
    ds_read_b128 v[20:23], v3 offset:26400
    ds_read_b32 v9, v1 offset:53024
    s_waitcnt lgkmcnt(1)
    v_mfma_f32_16x16x32_bf16 v[80:83], v[28:31], v[44:47], v[80:83]
    v_and_b32 v44, v24, v20
    v_and_b32 v45, v25, v21
    v_and_b32 v46, v26, v22
    v_and_b32 v47, v27, v23
    s_cbranch_scc1 P2_slow1_7
P2_back1_7:
    s_waitcnt lgkmcnt(0)
    v_lshrrev_b32 v2, 24, v9
    v_mad_u32_u24 v9, v9, 32, v5
    s_bitcmp1_b32 s90, 8
    s_waitcnt vmcnt(1)
    ds_write_b128 v32, v[56:59]
    buffer_load_dwordx4 v[56:59], v9, s[8:11], 0 offen
    ds_read_b64_tr_b16 v[28:29], v33
    ds_read_b64_tr_b16 v[30:31], v33 offset:576
    v_add_u32_dpp v10, v2, v6 quad_perm:[0,0,0,0] row_mask:0xf bank_mask:0xf
    v_add_u32_dpp v11, v2, v6 quad_perm:[2,2,2,2] row_mask:0xf bank_mask:0xf
    ds_read_b64_tr_b16 v[24:25], v10 offset:2048
    ds_read_b64_tr_b16 v[26:27], v11 offset:2048
    ds_read_b128 v[20:23], v3 offset:26512
    ds_read_b32 v9, v1 offset:53248
    s_waitcnt lgkmcnt(1)
    v_mfma_f32_16x16x32_bf16 v[84:87], v[28:31], v[48:51], v[84:87]
    v_and_b32 v48, v24, v20
    v_and_b32 v49, v25, v21
    v_and_b32 v50, v26, v22
    v_and_b32 v51, v27, v23
    s_cbranch_scc1 P2_slow1_8
P2_back1_8:
    s_waitcnt lgkmcnt(0)
    v_lshrrev_b32 v2, 24, v9
    v_mad_u32_u24 v9, v9, 32, v5
    s_bitcmp1_b32 s90, 9
    s_waitcnt vmcnt(1)
    ds_write_b128 v32, v[52:55]
    buffer_load_dwordx4 v[52:55], v9, s[8:11], 0 offen
    ds_read_b64_tr_b16 v[28:29], v33
    ds_read_b64_tr_b16 v[30:31], v33 offset:576
    v_add_u32_dpp v10, v2, v6 quad_perm:[0,0,0,0] row_mask:0xf bank_mask:0xf
    v_add_u32_dpp v11, v2, v6 quad_perm:[2,2,2,2] row_mask:0xf bank_mask:0xf
    ds_read_b64_tr_b16 v[24:25], v10 offset:2048
    ds_read_b64_tr_b16 v[26:27], v11 offset:2048
    ds_read_b128 v[20:23], v3 offset:26624
    ds_read_b32 v9, v1 offset:53472
    s_waitcnt lgkmcnt(1)
    v_mfma_f32_16x16x32_bf16 v[88:91], v[28:31], v[44:47], v[88:91]
    v_and_b32 v44, v24, v20
    v_and_b32 v45, v25, v21
    v_and_b32 v46, v26, v22
    v_and_b32 v47, v27, v23
    s_cbranch_scc1 P2_slow1_9
P2_back1_9:
    s_waitcnt lgkmcnt(0)
    v_lshrrev_b32 v2, 24, v9
    v_mad_u32_u24 v9, v9, 32, v5
    s_bitcmp1_b32 s90, 10
    s_waitcnt vmcnt(1)
    ds_write_b128 v32, v[56:59]
    buffer_load_dwordx4 v[56:59], v9, s[8:11], 0 offen
    ds_read_b64_tr_b16 v[28:29], v33
    ds_read_b64_tr_b16 v[30:31], v33 offset:576
    v_add_u32_dpp v10, v2, v6 quad_perm:[0,0,0,0] row_mask:0xf bank_mask:0xf
    v_add_u32_dpp v11, v2, v6 quad_perm:[2,2,2,2] row_mask:0xf bank_mask:0xf
    ds_read_b64_tr_b16 v[24:25], v10 offset:2048
    ds_read_b64_tr_b16 v[26:27], v11 offset:2048
    ds_read_b128 v[20:23], v3 offset:26736
    ds_read_b32 v9, v1 offset:53696
    s_waitcnt lgkmcnt(1)
    v_mfma_f32_16x16x32_bf16 v[92:95], v[28:31], v[48:51], v[92:95]
    v_and_b32 v48, v24, v20
    v_and_b32 v49, v25, v21
    v_and_b32 v50, v26, v22
    v_and_b32 v51, v27, v23
    s_cbranch_scc1 P2_slow1_10
P2_back1_10:
    s_waitcnt lgkmcnt(0)
    v_lshrrev_b32 v2, 24, v9
    v_mad_u32_u24 v9, v9, 32, v5
    s_bitcmp1_b32 s90, 11
    s_waitcnt vmcnt(1)
    ds_write_b128 v32, v[52:55]
    buffer_load_dwordx4 v[52:55], v9, s[8:11], 0 offen
    ds_read_b64_tr_b16 v[28:29], v33
    ds_read_b64_tr_b16 v[30:31], v33 offset:576
    v_add_u32_dpp v10, v2, v6 quad_perm:[0,0,0,0] row_mask:0xf bank_mask:0xf
    v_add_u32_dpp v11, v2, v6 quad_perm:[2,2,2,2] row_mask:0xf bank_mask:0xf
    ds_read_b64_tr_b16 v[24:25], v10 offset:2048
    ds_read_b64_tr_b16 v[26:27], v11 offset:2048
    ds_read_b128 v[20:23], v3 offset:26848
    ds_read_b32 v9, v1 offset:53920
    s_waitcnt lgkmcnt(1)
    v_mfma_f32_16x16x32_bf16 v[96:99], v[28:31], v[44:47], v[96:99]
    v_and_b32 v44, v24, v20
    v_and_b32 v45, v25, v21
    v_and_b32 v46, v26, v22
    v_and_b32 v47, v27, v23
    s_cbranch_scc1 P2_slow1_11
P2_back1_11:
    s_waitcnt lgkmcnt(0)
    v_lshrrev_b32 v2, 24, v9
    v_mad_u32_u24 v9, v9, 32, v5
    s_bitcmp1_b32 s90, 12
    s_waitcnt vmcnt(1)
    ds_write_b128 v32, v[56:59]
    buffer_load_dwordx4 v[56:59], v9, s[8:11], 0 offen
    ds_read_b64_tr_b16 v[28:29], v33
    ds_read_b64_tr_b16 v[30:31], v33 offset:576
    v_add_u32_dpp v10, v2, v6 quad_perm:[0,0,0,0] row_mask:0xf bank_mask:0xf
    v_add_u32_dpp v11, v2, v6 quad_perm:[2,2,2,2] row_mask:0xf bank_mask:0xf
    ds_read_b64_tr_b16 v[24:25], v10 offset:2048
    ds_read_b64_tr_b16 v[26:27], v11 offset:2048
    ds_read_b128 v[20:23], v3 offset:26960
    ds_read_b32 v9, v1 offset:54144
    s_waitcnt lgkmcnt(1)
    v_mfma_f32_16x16x32_bf16 v[100:103], v[28:31], v[48:51], v[100:103]
    v_and_b32 v48, v24, v20
    v_and_b32 v49, v25, v21
    v_and_b32 v50, v26, v22
    v_and_b32 v51, v27, v23
    s_cbranch_scc1 P2_slow1_12
P2_back1_12:
    s_waitcnt lgkmcnt(0)
    v_lshrrev_b32 v2, 24, v9
    v_mad_u32_u24 v9, v9, 32, v5
    s_bitcmp1_b32 s90, 13
    s_waitcnt vmcnt(1)
    ds_write_b128 v32, v[52:55]
    buffer_load_dwordx4 v[52:55], v9, s[8:11], 0 offen
    ds_read_b64_tr_b16 v[28:29], v33
    ds_read_b64_tr_b16 v[30:31], v33 offset:576
    v_add_u32_dpp v10, v2, v6 quad_perm:[0,0,0,0] row_mask:0xf bank_mask:0xf
    v_add_u32_dpp v11, v2, v6 quad_perm:[2,2,2,2] row_mask:0xf bank_mask:0xf
    ds_read_b64_tr_b16 v[24:25], v10 offset:2048
    ds_read_b64_tr_b16 v[26:27], v11 offset:2048
    ds_read_b128 v[20:23], v3 offset:27072
    ds_read_b32 v9, v1 offset:54368
    s_waitcnt lgkmcnt(1)
    v_mfma_f32_16x16x32_bf16 v[104:107], v[28:31], v[44:47], v[104:107]
    v_and_b32 v44, v24, v20
    v_and_b32 v45, v25, v21
    v_and_b32 v46, v26, v22
    v_and_b32 v47, v27, v23
    s_cbranch_scc1 P2_slow1_13
P2_back1_13:
    s_waitcnt lgkmcnt(0)
    v_lshrrev_b32 v2, 24, v9
    v_mad_u32_u24 v9, v9, 32, v5
    s_bitcmp1_b32 s90, 14
    s_waitcnt vmcnt(1)
    ds_write_b128 v32, v[56:59]
    buffer_load_dwordx4 v[56:59], v9, s[8:11], 0 offen
    ds_read_b64_tr_b16 v[28:29], v33
    ds_read_b64_tr_b16 v[30:31], v33 offset:576
    v_add_u32_dpp v10, v2, v6 quad_perm:[0,0,0,0] row_mask:0xf bank_mask:0xf
    v_add_u32_dpp v11, v2, v6 quad_perm:[2,2,2,2] row_mask:0xf bank_mask:0xf
    ds_read_b64_tr_b16 v[24:25], v10 offset:2048
    ds_read_b64_tr_b16 v[26:27], v11 offset:2048
    ds_read_b128 v[20:23], v3 offset:27184
    ds_read_b32 v9, v1 offset:54592
    s_waitcnt lgkmcnt(1)
    v_mfma_f32_16x16x32_bf16 v[108:111], v[28:31], v[48:51], v[108:111]
    v_and_b32 v48, v24, v20
    v_and_b32 v49, v25, v21
    v_and_b32 v50, v26, v22
    v_and_b32 v51, v27, v23
    s_cbranch_scc1 P2_slow1_14
P2_back1_14:
    s_waitcnt lgkmcnt(0)
    v_lshrrev_b32 v2, 24, v9
    v_mad_u32_u24 v9, v9, 32, v5
    s_bitcmp1_b32 s90, 15
    s_waitcnt vmcnt(1)
    ds_write_b128 v32, v[52:55]
    buffer_load_dwordx4 v[52:55], v9, s[8:11], 0 offen
    ds_read_b64_tr_b16 v[28:29], v33
    ds_read_b64_tr_b16 v[30:31], v33 offset:576
    v_add_u32_dpp v10, v2, v6 quad_perm:[0,0,0,0] row_mask:0xf bank_mask:0xf
    v_add_u32_dpp v11, v2, v6 quad_perm:[2,2,2,2] row_mask:0xf bank_mask:0xf
    ds_read_b64_tr_b16 v[24:25], v10 offset:2048
    ds_read_b64_tr_b16 v[26:27], v11 offset:2048
    ds_read_b128 v[20:23], v3 offset:27296
    ds_read_b32 v9, v1 offset:54816
    s_waitcnt lgkmcnt(1)
    v_mfma_f32_16x16x32_bf16 v[112:115], v[28:31], v[44:47], v[112:115]
    v_and_b32 v44, v24, v20
    v_and_b32 v45, v25, v21
    v_and_b32 v46, v26, v22
    v_and_b32 v47, v27, v23
    s_cbranch_scc1 P2_slow1_15
P2_back1_15:
    s_waitcnt lgkmcnt(0)
    v_or_b32 v9, s84, v9
    v_lshrrev_b32 v2, 24, v9
    v_mad_u32_u24 v9, v9, 32, v5
    s_waitcnt vmcnt(1)
    ds_write_b128 v32, v[56:59]
    buffer_load_dwordx4 v[56:59], v9, s[8:11], 0 offen
    ds_read_b64_tr_b16 v[28:29], v33
    ds_read_b64_tr_b16 v[30:31], v33 offset:576
    s_cmp_lg_u32 s84, 0
    s_cbranch_scc1 P2_last1
    v_add_u32_dpp v10, v2, v6 quad_perm:[0,0,0,0] row_mask:0xf bank_mask:0xf
    v_add_u32_dpp v11, v2, v6 quad_perm:[2,2,2,2] row_mask:0xf bank_mask:0xf
    ds_read_b64_tr_b16 v[24:25], v10 offset:2048
    ds_read_b64_tr_b16 v[26:27], v11 offset:2048
    ds_read_b128 v[20:23], v3 offset:27408
    s_waitcnt lgkmcnt(3)
    v_mfma_f32_16x16x32_bf16 v[116:119], v[28:31], v[48:51], v[116:119]
    s_bitcmp1_b32 s90, 16
    s_waitcnt lgkmcnt(0)
    v_and_b32 v48, v24, v20
    v_and_b32 v49, v25, v21
    v_and_b32 v50, v26, v22
    v_and_b32 v51, v27, v23
    s_cbranch_scc1 P2_slow1_16
P2_back1_16:
    v_mov_b32 v16, 940572672
    v_mov_b32 v17, 940572672
    v_mov_b32 v18, 940572672
    v_mov_b32 v19, 940572672
    ds_write_b128 v4, v[16:19] offset:51232
    ds_write_b128 v4, v[16:19] offset:52256
    ds_write_b128 v4, v[16:19] offset:53280
    s_mov_b64 exec, s[92:93]
    ds_write_b128 v4, v[16:19] offset:54304
    s_mov_b64 exec, 1
    v_mov_b32 v9, 1
    s_waitcnt lgkmcnt(0)
    ds_add_rtn_u32 v9, v0, v9 offset:4
    s_lshr_b32 s40, s48, 1
    s_mul_i32 s40, s40, 12
    s_waitcnt lgkmcnt(0)
    v_readfirstlane_b32 s41, v9
    s_mov_b64 exec, -1
    s_sub_u32 s41, s41, s40
    s_setprio 0
    s_cmp_lt_u32 s41, 6
    s_cbranch_scc1 P2_round0
    s_setprio 1
    s_cmp_lt_u32 s41, 10
    s_cbranch_scc1 P2_round0
    s_setprio 2
    s_branch P2_round0
P2_last0:
    s_waitcnt lgkmcnt(0)
    v_mfma_f32_16x16x32_bf16 v[116:119], v[28:31], v[44:47], v[116:119]
    s_branch P2_back0_16
P2_last1:
    s_waitcnt lgkmcnt(0)
    v_mfma_f32_16x16x32_bf16 v[116:119], v[28:31], v[48:51], v[116:119]
    s_branch P2_back1_16
P2_lazy10:
    buffer_store_dwordx4 v[104:107], v34, s[20:23], 0 offen sc1
    v_subrev_u32 v34, 12288, v34
    s_nop 0
    v_mov_b32 v104, 0
    v_mov_b32 v105, 0
    v_mov_b32 v106, 0
    v_mov_b32 v107, 0
    buffer_store_dwordx4 v[108:111], v34, s[20:23], 0 offen sc1
    v_subrev_u32 v34, 12288, v34
    s_nop 0
    v_mov_b32 v108, 0
    v_mov_b32 v109, 0
    v_mov_b32 v110, 0
    v_mov_b32 v111, 0
    buffer_store_dwordx4 v[112:115], v34, s[20:23], 0 offen sc1
    v_subrev_u32 v34, 12288, v34
    s_nop 0
    v_mov_b32 v112, 0
    v_mov_b32 v113, 0
    v_mov_b32 v114, 0
    v_mov_b32 v115, 0
    buffer_store_dwordx4 v[116:119], v34, s[20:23], 0 offen sc1
    v_subrev_u32 v34, 12288, v34
    s_nop 0
    v_mov_b32 v116, 0
    v_mov_b32 v117, 0
    v_mov_b32 v118, 0
    v_mov_b32 v119, 0
    s_branch P2_lazyb10
P2_slow0_0:
    ds_read_b32 v9, v1 offset:128
    s_waitcnt lgkmcnt(0)
    s_mov_b64 exec, s[94:95]
    v_mov_b32 v9, 940572672
    s_mov_b64 exec, -1
    v_lshrrev_b32 v2, 24, v9
    v_mad_u32_u24 v9, v9, 32, v5
    buffer_load_dwordx4 v[16:19], v9, s[8:11], 0 offen
    v_add_u32_dpp v10, v2, v6 quad_perm:[0,0,0,0] row_mask:0xf bank_mask:0xf
    v_add_u32_dpp v11, v2, v6 quad_perm:[2,2,2,2] row_mask:0xf bank_mask:0xf
    ds_read_b64_tr_b16 v[24:25], v10 offset:2048
    ds_read_b64_tr_b16 v[26:27], v11 offset:2048
    ds_read_b128 v[20:23], v3 offset:64
    ds_read_b32 v9, v1 offset:224
    s_waitcnt lgkmcnt(1)
    v_and_b32 v24, v24, v20
    v_and_b32 v25, v25, v21
    v_and_b32 v26, v26, v22
    v_and_b32 v27, v27, v23
    s_waitcnt vmcnt(0)
    ds_write_b128 v32, v[16:19]
    ds_read_b64_tr_b16 v[28:29], v33
    ds_read_b64_tr_b16 v[30:31], v33 offset:576
    s_waitcnt lgkmcnt(0)
    v_mfma_f32_16x16x32_bf16 v[60:63], v[28:31], v[24:27], v[60:63]
    s_branch P2_back0_0
P2_slow0_1:
    ds_read_b32 v9, v1 offset:352
    s_waitcnt lgkmcnt(0)
    s_mov_b64 exec, s[94:95]
    v_mov_b32 v9, 940572672
    s_mov_b64 exec, -1
    v_lshrrev_b32 v2, 24, v9
    v_mad_u32_u24 v9, v9, 32, v5
    buffer_load_dwordx4 v[16:19], v9, s[8:11], 0 offen
    v_add_u32_dpp v10, v2, v6 quad_perm:[0,0,0,0] row_mask:0xf bank_mask:0xf
    v_add_u32_dpp v11, v2, v6 quad_perm:[2,2,2,2] row_mask:0xf bank_mask:0xf
    ds_read_b64_tr_b16 v[24:25], v10 offset:2048
    ds_read_b64_tr_b16 v[26:27], v11 offset:2048
    ds_read_b128 v[20:23], v3 offset:176
    ds_read_b32 v9, v1 offset:448
    s_waitcnt lgkmcnt(1)
    v_and_b32 v24, v24, v20
    v_and_b32 v25, v25, v21
    v_and_b32 v26, v26, v22
    v_and_b32 v27, v27, v23
    s_waitcnt vmcnt(0)
    ds_write_b128 v32, v[16:19]
    ds_read_b64_tr_b16 v[28:29], v33
    ds_read_b64_tr_b16 v[30:31], v33 offset:576
    s_waitcnt lgkmcnt(0)
    v_mfma_f32_16x16x32_bf16 v[64:67], v[28:31], v[24:27], v[64:67]
    s_branch P2_back0_1
P2_slow0_2:
    ds_read_b32 v9, v1 offset:576
    s_waitcnt lgkmcnt(0)
    s_mov_b64 exec, s[94:95]
    v_mov_b32 v9, 940572672
    s_mov_b64 exec, -1
    v_lshrrev_b32 v2, 24, v9
    v_mad_u32_u24 v9, v9, 32, v5
    buffer_load_dwordx4 v[16:19], v9, s[8:11], 0 offen
    v_add_u32_dpp v10, v2, v6 quad_perm:[0,0,0,0] row_mask:0xf bank_mask:0xf
    v_add_u32_dpp v11, v2, v6 quad_perm:[2,2,2,2] row_mask:0xf bank_mask:0xf
    ds_read_b64_tr_b16 v[24:25], v10 offset:2048
    ds_read_b64_tr_b16 v[26:27], v11 offset:2048
    ds_read_b128 v[20:23], v3 offset:288
    ds_read_b32 v9, v1 offset:672
    s_waitcnt lgkmcnt(1)
    v_and_b32 v24, v24, v20
    v_and_b32 v25, v25, v21
    v_and_b32 v26, v26, v22
    v_and_b32 v27, v27, v23
    s_waitcnt vmcnt(0)
    ds_write_b128 v32, v[16:19]
    ds_read_b64_tr_b16 v[28:29], v33
    ds_read_b64_tr_b16 v[30:31], v33 offset:576
    s_waitcnt lgkmcnt(0)
    v_mfma_f32_16x16x32_bf16 v[68:71], v[28:31], v[24:27], v[68:71]
    s_branch P2_back0_2
P2_slow0_3:
    ds_read_b32 v9, v1 offset:800
    s_waitcnt lgkmcnt(0)
    s_mov_b64 exec, s[94:95]
    v_mov_b32 v9, 940572672
    s_mov_b64 exec, -1
    v_lshrrev_b32 v2, 24, v9
    v_mad_u32_u24 v9, v9, 32, v5
    buffer_load_dwordx4 v[16:19], v9, s[8:11], 0 offen
    v_add_u32_dpp v10, v2, v6 quad_perm:[0,0,0,0] row_mask:0xf bank_mask:0xf
    v_add_u32_dpp v11, v2, v6 quad_perm:[2,2,2,2] row_mask:0xf bank_mask:0xf
    ds_read_b64_tr_b16 v[24:25], v10 offset:2048
    ds_read_b64_tr_b16 v[26:27], v11 offset:2048
    ds_read_b128 v[20:23], v3 offset:400
    ds_read_b32 v9, v1 offset:896
    s_waitcnt lgkmcnt(1)
    v_and_b32 v24, v24, v20
    v_and_b32 v25, v25, v21
    v_and_b32 v26, v26, v22
    v_and_b32 v27, v27, v23
    s_waitcnt vmcnt(0)
    ds_write_b128 v32, v[16:19]
    ds_read_b64_tr_b16 v[28:29], v33
    ds_read_b64_tr_b16 v[30:31], v33 offset:576
    s_waitcnt lgkmcnt(0)
    v_mfma_f32_16x16x32_bf16 v[72:75], v[28:31], v[24:27], v[72:75]
    s_branch P2_back0_3
P2_slow0_4:
    ds_read_b32 v9, v1 offset:1024
    s_waitcnt lgkmcnt(0)
    s_mov_b64 exec, s[94:95]
    v_mov_b32 v9, 940572672
    s_mov_b64 exec, -1
    v_lshrrev_b32 v2, 24, v9
    v_mad_u32_u24 v9, v9, 32, v5
    buffer_load_dwordx4 v[16:19], v9, s[8:11], 0 offen
    v_add_u32_dpp v10, v2, v6 quad_perm:[0,0,0,0] row_mask:0xf bank_mask:0xf
    v_add_u32_dpp v11, v2, v6 quad_perm:[2,2,2,2] row_mask:0xf bank_mask:0xf
    ds_read_b64_tr_b16 v[24:25], v10 offset:2048
    ds_read_b64_tr_b16 v[26:27], v11 offset:2048
    ds_read_b128 v[20:23], v3 offset:512
    ds_read_b32 v9, v1 offset:1120
    s_waitcnt lgkmcnt(1)
    v_and_b32 v24, v24, v20
    v_and_b32 v25, v25, v21
    v_and_b32 v26, v26, v22
    v_and_b32 v27, v27, v23
    s_waitcnt vmcnt(0)
    ds_write_b128 v32, v[16:19]
    ds_read_b64_tr_b16 v[28:29], v33
    ds_read_b64_tr_b16 v[30:31], v33 offset:576
    s_waitcnt lgkmcnt(0)
    v_mfma_f32_16x16x32_bf16 v[76:79], v[28:31], v[24:27], v[76:79]
    s_branch P2_back0_4
P2_slow0_5:
    ds_read_b32 v9, v1 offset:1248
    s_waitcnt lgkmcnt(0)
    s_mov_b64 exec, s[94:95]
    v_mov_b32 v9, 940572672
    s_mov_b64 exec, -1
    v_lshrrev_b32 v2, 24, v9
    v_mad_u32_u24 v9, v9, 32, v5
    buffer_load_dwordx4 v[16:19], v9, s[8:11], 0 offen
    v_add_u32_dpp v10, v2, v6 quad_perm:[0,0,0,0] row_mask:0xf bank_mask:0xf
    v_add_u32_dpp v11, v2, v6 quad_perm:[2,2,2,2] row_mask:0xf bank_mask:0xf
    ds_read_b64_tr_b16 v[24:25], v10 offset:2048
    ds_read_b64_tr_b16 v[26:27], v11 offset:2048
    ds_read_b128 v[20:23], v3 offset:624
    ds_read_b32 v9, v1 offset:1344
    s_waitcnt lgkmcnt(1)
    v_and_b32 v24, v24, v20
    v_and_b32 v25, v25, v21
    v_and_b32 v26, v26, v22
    v_and_b32 v27, v27, v23
    s_waitcnt vmcnt(0)
    ds_write_b128 v32, v[16:19]
    ds_read_b64_tr_b16 v[28:29], v33
    ds_read_b64_tr_b16 v[30:31], v33 offset:576
    s_waitcnt lgkmcnt(0)
    v_mfma_f32_16x16x32_bf16 v[80:83], v[28:31], v[24:27], v[80:83]
    s_branch P2_back0_5
P2_slow0_6:
    ds_read_b32 v9, v1 offset:1472
    s_waitcnt lgkmcnt(0)
    s_mov_b64 exec, s[94:95]
    v_mov_b32 v9, 940572672
    s_mov_b64 exec, -1
    v_lshrrev_b32 v2, 24, v9
    v_mad_u32_u24 v9, v9, 32, v5
    buffer_load_dwordx4 v[16:19], v9, s[8:11], 0 offen
    v_add_u32_dpp v10, v2, v6 quad_perm:[0,0,0,0] row_mask:0xf bank_mask:0xf
    v_add_u32_dpp v11, v2, v6 quad_perm:[2,2,2,2] row_mask:0xf bank_mask:0xf
    ds_read_b64_tr_b16 v[24:25], v10 offset:2048
    ds_read_b64_tr_b16 v[26:27], v11 offset:2048
    ds_read_b128 v[20:23], v3 offset:736
    ds_read_b32 v9, v1 offset:1568
    s_waitcnt lgkmcnt(1)
    v_and_b32 v24, v24, v20
    v_and_b32 v25, v25, v21
    v_and_b32 v26, v26, v22
    v_and_b32 v27, v27, v23
    s_waitcnt vmcnt(0)
    ds_write_b128 v32, v[16:19]
    ds_read_b64_tr_b16 v[28:29], v33
    ds_read_b64_tr_b16 v[30:31], v33 offset:576
    s_waitcnt lgkmcnt(0)
    v_mfma_f32_16x16x32_bf16 v[84:87], v[28:31], v[24:27], v[84:87]
    s_branch P2_back0_6
P2_slow0_7:
    ds_read_b32 v9, v1 offset:1696
    s_waitcnt lgkmcnt(0)
    s_mov_b64 exec, s[94:95]
    v_mov_b32 v9, 940572672
    s_mov_b64 exec, -1
    v_lshrrev_b32 v2, 24, v9
    v_mad_u32_u24 v9, v9, 32, v5
    buffer_load_dwordx4 v[16:19], v9, s[8:11], 0 offen
    v_add_u32_dpp v10, v2, v6 quad_perm:[0,0,0,0] row_mask:0xf bank_mask:0xf
    v_add_u32_dpp v11, v2, v6 quad_perm:[2,2,2,2] row_mask:0xf bank_mask:0xf
    ds_read_b64_tr_b16 v[24:25], v10 offset:2048
    ds_read_b64_tr_b16 v[26:27], v11 offset:2048
    ds_read_b128 v[20:23], v3 offset:848
    ds_read_b32 v9, v1 offset:1792
    s_waitcnt lgkmcnt(1)
    v_and_b32 v24, v24, v20
    v_and_b32 v25, v25, v21
    v_and_b32 v26, v26, v22
    v_and_b32 v27, v27, v23
    s_waitcnt vmcnt(0)
    ds_write_b128 v32, v[16:19]
    ds_read_b64_tr_b16 v[28:29], v33
    ds_read_b64_tr_b16 v[30:31], v33 offset:576
    s_waitcnt lgkmcnt(0)
    v_mfma_f32_16x16x32_bf16 v[88:91], v[28:31], v[24:27], v[88:91]
    s_branch P2_back0_7
P2_slow0_8:
    ds_read_b32 v9, v1 offset:1920
    s_waitcnt lgkmcnt(0)
    s_mov_b64 exec, s[94:95]
    v_mov_b32 v9, 940572672
    s_mov_b64 exec, -1
    v_lshrrev_b32 v2, 24, v9
    v_mad_u32_u24 v9, v9, 32, v5
    buffer_load_dwordx4 v[16:19], v9, s[8:11], 0 offen
    v_add_u32_dpp v10, v2, v6 quad_perm:[0,0,0,0] row_mask:0xf bank_mask:0xf
    v_add_u32_dpp v11, v2, v6 quad_perm:[2,2,2,2] row_mask:0xf bank_mask:0xf
    ds_read_b64_tr_b16 v[24:25], v10 offset:2048
    ds_read_b64_tr_b16 v[26:27], v11 offset:2048
    ds_read_b128 v[20:23], v3 offset:960
    ds_read_b32 v9, v1 offset:2016
    s_waitcnt lgkmcnt(1)
    v_and_b32 v24, v24, v20
    v_and_b32 v25, v25, v21
    v_and_b32 v26, v26, v22
    v_and_b32 v27, v27, v23
    s_waitcnt vmcnt(0)
    ds_write_b128 v32, v[16:19]
    ds_read_b64_tr_b16 v[28:29], v33
    ds_read_b64_tr_b16 v[30:31], v33 offset:576
    s_waitcnt lgkmcnt(0)
    v_mfma_f32_16x16x32_bf16 v[92:95], v[28:31], v[24:27], v[92:95]
    s_branch P2_back0_8
P2_slow0_9:
    ds_read_b32 v9, v1 offset:2144
    s_waitcnt lgkmcnt(0)
    s_mov_b64 exec, s[94:95]
    v_mov_b32 v9, 940572672
    s_mov_b64 exec, -1
    v_lshrrev_b32 v2, 24, v9
    v_mad_u32_u24 v9, v9, 32, v5
    buffer_load_dwordx4 v[16:19], v9, s[8:11], 0 offen
    v_add_u32_dpp v10, v2, v6 quad_perm:[0,0,0,0] row_mask:0xf bank_mask:0xf
    v_add_u32_dpp v11, v2, v6 quad_perm:[2,2,2,2] row_mask:0xf bank_mask:0xf
    ds_read_b64_tr_b16 v[24:25], v10 offset:2048
    ds_read_b64_tr_b16 v[26:27], v11 offset:2048
    ds_read_b128 v[20:23], v3 offset:1072
    ds_read_b32 v9, v1 offset:2240
    s_waitcnt lgkmcnt(1)
    v_and_b32 v24, v24, v20
    v_and_b32 v25, v25, v21
    v_and_b32 v26, v26, v22
    v_and_b32 v27, v27, v23
    s_waitcnt vmcnt(0)
    ds_write_b128 v32, v[16:19]
    ds_read_b64_tr_b16 v[28:29], v33
    ds_read_b64_tr_b16 v[30:31], v33 offset:576
    s_waitcnt lgkmcnt(0)
    v_mfma_f32_16x16x32_bf16 v[96:99], v[28:31], v[24:27], v[96:99]
    s_branch P2_back0_9
P2_slow0_10:
    ds_read_b32 v9, v1 offset:2368
    s_waitcnt lgkmcnt(0)
    s_mov_b64 exec, s[94:95]
    v_mov_b32 v9, 940572672
    s_mov_b64 exec, -1
    v_lshrrev_b32 v2, 24, v9
    v_mad_u32_u24 v9, v9, 32, v5
    buffer_load_dwordx4 v[16:19], v9, s[8:11], 0 offen
    v_add_u32_dpp v10, v2, v6 quad_perm:[0,0,0,0] row_mask:0xf bank_mask:0xf
    v_add_u32_dpp v11, v2, v6 quad_perm:[2,2,2,2] row_mask:0xf bank_mask:0xf
    ds_read_b64_tr_b16 v[24:25], v10 offset:2048
    ds_read_b64_tr_b16 v[26:27], v11 offset:2048
    ds_read_b128 v[20:23], v3 offset:1184
    ds_read_b32 v9, v1 offset:2464
    s_waitcnt lgkmcnt(1)
    v_and_b32 v24, v24, v20
    v_and_b32 v25, v25, v21
    v_and_b32 v26, v26, v22
    v_and_b32 v27, v27, v23
    s_waitcnt vmcnt(0)
    ds_write_b128 v32, v[16:19]
    ds_read_b64_tr_b16 v[28:29], v33
    ds_read_b64_tr_b16 v[30:31], v33 offset:576
    s_waitcnt lgkmcnt(0)
    v_mfma_f32_16x16x32_bf16 v[100:103], v[28:31], v[24:27], v[100:103]
    s_branch P2_back0_10
P2_slow0_11:
    ds_read_b32 v9, v1 offset:2592
    s_waitcnt lgkmcnt(0)
    s_mov_b64 exec, s[94:95]
    v_mov_b32 v9, 940572672
    s_mov_b64 exec, -1
    v_lshrrev_b32 v2, 24, v9
    v_mad_u32_u24 v9, v9, 32, v5
    buffer_load_dwordx4 v[16:19], v9, s[8:11], 0 offen
    v_add_u32_dpp v10, v2, v6 quad_perm:[0,0,0,0] row_mask:0xf bank_mask:0xf
    v_add_u32_dpp v11, v2, v6 quad_perm:[2,2,2,2] row_mask:0xf bank_mask:0xf
    ds_read_b64_tr_b16 v[24:25], v10 offset:2048
    ds_read_b64_tr_b16 v[26:27], v11 offset:2048
    ds_read_b128 v[20:23], v3 offset:1296
    ds_read_b32 v9, v1 offset:2688
    s_waitcnt lgkmcnt(1)
    v_and_b32 v24, v24, v20
    v_and_b32 v25, v25, v21
    v_and_b32 v26, v26, v22
    v_and_b32 v27, v27, v23
    s_waitcnt vmcnt(0)
    ds_write_b128 v32, v[16:19]
    ds_read_b64_tr_b16 v[28:29], v33
    ds_read_b64_tr_b16 v[30:31], v33 offset:576
    s_waitcnt lgkmcnt(0)
    v_mfma_f32_16x16x32_bf16 v[104:107], v[28:31], v[24:27], v[104:107]
    s_branch P2_back0_11
P2_slow0_12:
    ds_read_b32 v9, v1 offset:2816
    s_waitcnt lgkmcnt(0)
    s_mov_b64 exec, s[94:95]
    v_mov_b32 v9, 940572672
    s_mov_b64 exec, -1
    v_lshrrev_b32 v2, 24, v9
    v_mad_u32_u24 v9, v9, 32, v5
    buffer_load_dwordx4 v[16:19], v9, s[8:11], 0 offen
    v_add_u32_dpp v10, v2, v6 quad_perm:[0,0,0,0] row_mask:0xf bank_mask:0xf
    v_add_u32_dpp v11, v2, v6 quad_perm:[2,2,2,2] row_mask:0xf bank_mask:0xf
    ds_read_b64_tr_b16 v[24:25], v10 offset:2048
    ds_read_b64_tr_b16 v[26:27], v11 offset:2048
    ds_read_b128 v[20:23], v3 offset:1408
    ds_read_b32 v9, v1 offset:2912
    s_waitcnt lgkmcnt(1)
    v_and_b32 v24, v24, v20
    v_and_b32 v25, v25, v21
    v_and_b32 v26, v26, v22
    v_and_b32 v27, v27, v23
    s_waitcnt vmcnt(0)
    ds_write_b128 v32, v[16:19]
    ds_read_b64_tr_b16 v[28:29], v33
    ds_read_b64_tr_b16 v[30:31], v33 offset:576
    s_waitcnt lgkmcnt(0)
    v_mfma_f32_16x16x32_bf16 v[108:111], v[28:31], v[24:27], v[108:111]
    s_branch P2_back0_12
P2_slow0_13:
    ds_read_b32 v9, v1 offset:3040
    s_waitcnt lgkmcnt(0)
    s_mov_b64 exec, s[94:95]
    v_mov_b32 v9, 940572672
    s_mov_b64 exec, -1
    v_lshrrev_b32 v2, 24, v9
    v_mad_u32_u24 v9, v9, 32, v5
    buffer_load_dwordx4 v[16:19], v9, s[8:11], 0 offen
    v_add_u32_dpp v10, v2, v6 quad_perm:[0,0,0,0] row_mask:0xf bank_mask:0xf
    v_add_u32_dpp v11, v2, v6 quad_perm:[2,2,2,2] row_mask:0xf bank_mask:0xf
    ds_read_b64_tr_b16 v[24:25], v10 offset:2048
    ds_read_b64_tr_b16 v[26:27], v11 offset:2048
    ds_read_b128 v[20:23], v3 offset:1520
    ds_read_b32 v9, v1 offset:3136
    s_waitcnt lgkmcnt(1)
    v_and_b32 v24, v24, v20
    v_and_b32 v25, v25, v21
    v_and_b32 v26, v26, v22
    v_and_b32 v27, v27, v23
    s_waitcnt vmcnt(0)
    ds_write_b128 v32, v[16:19]
    ds_read_b64_tr_b16 v[28:29], v33
    ds_read_b64_tr_b16 v[30:31], v33 offset:576
    s_waitcnt lgkmcnt(0)
    v_mfma_f32_16x16x32_bf16 v[112:115], v[28:31], v[24:27], v[112:115]
    s_branch P2_back0_13
P2_slow0_14:
    ds_read_b32 v9, v1 offset:3264
    s_waitcnt lgkmcnt(0)
    s_mov_b64 exec, s[94:95]
    v_mov_b32 v9, 940572672
    s_mov_b64 exec, -1
    v_lshrrev_b32 v2, 24, v9
    v_mad_u32_u24 v9, v9, 32, v5
    buffer_load_dwordx4 v[16:19], v9, s[8:11], 0 offen
    v_add_u32_dpp v10, v2, v6 quad_perm:[0,0,0,0] row_mask:0xf bank_mask:0xf
    v_add_u32_dpp v11, v2, v6 quad_perm:[2,2,2,2] row_mask:0xf bank_mask:0xf
    ds_read_b64_tr_b16 v[24:25], v10 offset:2048
    ds_read_b64_tr_b16 v[26:27], v11 offset:2048
    ds_read_b128 v[20:23], v3 offset:1632
    ds_read_b32 v9, v1 offset:3360
    s_waitcnt lgkmcnt(1)
    v_and_b32 v24, v24, v20
    v_and_b32 v25, v25, v21
    v_and_b32 v26, v26, v22
    v_and_b32 v27, v27, v23
    s_waitcnt vmcnt(0)
    ds_write_b128 v32, v[16:19]
    ds_read_b64_tr_b16 v[28:29], v33
    ds_read_b64_tr_b16 v[30:31], v33 offset:576
    s_waitcnt lgkmcnt(0)
    v_mfma_f32_16x16x32_bf16 v[116:119], v[28:31], v[24:27], v[116:119]
    s_branch P2_back0_14
P2_slow0_15:
    ds_read_b32 v9, v1 offset:3488
    s_waitcnt lgkmcnt(0)
    s_mov_b64 exec, s[94:95]
    v_mov_b32 v9, 940572672
    s_mov_b64 exec, -1
    v_lshrrev_b32 v2, 24, v9
    v_mad_u32_u24 v9, v9, 32, v5
    buffer_load_dwordx4 v[16:19], v9, s[8:11], 0 offen
    v_add_u32_dpp v10, v2, v6 quad_perm:[0,0,0,0] row_mask:0xf bank_mask:0xf
    v_add_u32_dpp v11, v2, v6 quad_perm:[2,2,2,2] row_mask:0xf bank_mask:0xf
    ds_read_b64_tr_b16 v[24:25], v10 offset:2048
    ds_read_b64_tr_b16 v[26:27], v11 offset:2048
    ds_read_b128 v[20:23], v3 offset:1744
    ds_read_b32 v9, v1 offset:3584
    s_waitcnt lgkmcnt(1)
    v_and_b32 v24, v24, v20
    v_and_b32 v25, v25, v21
    v_and_b32 v26, v26, v22
    v_and_b32 v27, v27, v23
    s_waitcnt vmcnt(0)
    ds_write_b128 v32, v[16:19]
    ds_read_b64_tr_b16 v[28:29], v33
    ds_read_b64_tr_b16 v[30:31], v33 offset:576
    s_waitcnt lgkmcnt(0)
    v_mfma_f32_16x16x32_bf16 v[120:123], v[28:31], v[24:27], v[120:123]
    s_branch P2_back0_15
P2_slow0_16:
    ds_read_b32 v9, v1 offset:3712
    s_waitcnt lgkmcnt(0)
    s_mov_b64 exec, s[94:95]
    v_mov_b32 v9, 940572672
    s_mov_b64 exec, -1
    v_lshrrev_b32 v2, 24, v9
    v_mad_u32_u24 v9, v9, 32, v5
    buffer_load_dwordx4 v[16:19], v9, s[8:11], 0 offen
    v_add_u32_dpp v10, v2, v6 quad_perm:[0,0,0,0] row_mask:0xf bank_mask:0xf
    v_add_u32_dpp v11, v2, v6 quad_perm:[2,2,2,2] row_mask:0xf bank_mask:0xf
    ds_read_b64_tr_b16 v[24:25], v10 offset:2048
    ds_read_b64_tr_b16 v[26:27], v11 offset:2048
    ds_read_b128 v[20:23], v3 offset:1856
    s_waitcnt lgkmcnt(0)
    v_and_b32 v24, v24, v20
    v_and_b32 v25, v25, v21
    v_and_b32 v26, v26, v22
    v_and_b32 v27, v27, v23
    s_waitcnt vmcnt(0)
    ds_write_b128 v32, v[16:19]
    ds_read_b64_tr_b16 v[28:29], v33
    ds_read_b64_tr_b16 v[30:31], v33 offset:576
    s_waitcnt lgkmcnt(0)
    v_mfma_f32_16x16x32_bf16 v[124:127], v[28:31], v[24:27], v[124:127]
    s_branch P2_back0_16
P2_slow1_0:
    ds_read_b32 v9, v1 offset:51360
    s_waitcnt lgkmcnt(0)
    s_mov_b64 exec, s[94:95]
    v_mov_b32 v9, 940572672
    s_mov_b64 exec, -1
    v_lshrrev_b32 v2, 24, v9
    v_mad_u32_u24 v9, v9, 32, v5
    buffer_load_dwordx4 v[16:19], v9, s[8:11], 0 offen
    v_add_u32_dpp v10, v2, v6 quad_perm:[0,0,0,0] row_mask:0xf bank_mask:0xf
    v_add_u32_dpp v11, v2, v6 quad_perm:[2,2,2,2] row_mask:0xf bank_mask:0xf
    ds_read_b64_tr_b16 v[24:25], v10 offset:2048
    ds_read_b64_tr_b16 v[26:27], v11 offset:2048
    ds_read_b128 v[20:23], v3 offset:25680
    ds_read_b32 v9, v1 offset:51456
    s_waitcnt lgkmcnt(1)
    v_and_b32 v24, v24, v20
    v_and_b32 v25, v25, v21
    v_and_b32 v26, v26, v22
    v_and_b32 v27, v27, v23
    s_waitcnt vmcnt(0)
    ds_write_b128 v32, v[16:19]
    ds_read_b64_tr_b16 v[28:29], v33
    ds_read_b64_tr_b16 v[30:31], v33 offset:576
    s_waitcnt lgkmcnt(0)
    v_mfma_f32_16x16x32_bf16 v[60:63], v[28:31], v[24:27], v[60:63]
    s_branch P2_back1_0
P2_slow1_1:
    ds_read_b32 v9, v1 offset:51584
    s_waitcnt lgkmcnt(0)
    s_mov_b64 exec, s[94:95]
    v_mov_b32 v9, 940572672
    s_mov_b64 exec, -1
    v_lshrrev_b32 v2, 24, v9
    v_mad_u32_u24 v9, v9, 32, v5
    buffer_load_dwordx4 v[16:19], v9, s[8:11], 0 offen
    v_add_u32_dpp v10, v2, v6 quad_perm:[0,0,0,0] row_mask:0xf bank_mask:0xf
    v_add_u32_dpp v11, v2, v6 quad_perm:[2,2,2,2] row_mask:0xf bank_mask:0xf
    ds_read_b64_tr_b16 v[24:25], v10 offset:2048
    ds_read_b64_tr_b16 v[26:27], v11 offset:2048
    ds_read_b128 v[20:23], v3 offset:25792
    ds_read_b32 v9, v1 offset:51680
    s_waitcnt lgkmcnt(1)
    v_and_b32 v24, v24, v20
    v_and_b32 v25, v25, v21
    v_and_b32 v26, v26, v22
    v_and_b32 v27, v27, v23
    s_waitcnt vmcnt(0)
    ds_write_b128 v32, v[16:19]
    ds_read_b64_tr_b16 v[28:29], v33
    ds_read_b64_tr_b16 v[30:31], v33 offset:576
    s_waitcnt lgkmcnt(0)
    v_mfma_f32_16x16x32_bf16 v[64:67], v[28:31], v[24:27], v[64:67]
    s_branch P2_back1_1
P2_slow1_2:
    ds_read_b32 v9, v1 offset:51808
    s_waitcnt lgkmcnt(0)
    s_mov_b64 exec, s[94:95]
    v_mov_b32 v9, 940572672
    s_mov_b64 exec, -1
    v_lshrrev_b32 v2, 24, v9
    v_mad_u32_u24 v9, v9, 32, v5
    buffer_load_dwordx4 v[16:19], v9, s[8:11], 0 offen
    v_add_u32_dpp v10, v2, v6 quad_perm:[0,0,0,0] row_mask:0xf bank_mask:0xf
    v_add_u32_dpp v11, v2, v6 quad_perm:[2,2,2,2] row_mask:0xf bank_mask:0xf
    ds_read_b64_tr_b16 v[24:25], v10 offset:2048
    ds_read_b64_tr_b16 v[26:27], v11 offset:2048
    ds_read_b128 v[20:23], v3 offset:25904
    ds_read_b32 v9, v1 offset:51904
    s_waitcnt lgkmcnt(1)
    v_and_b32 v24, v24, v20
    v_and_b32 v25, v25, v21
    v_and_b32 v26, v26, v22
    v_and_b32 v27, v27, v23
    s_waitcnt vmcnt(0)
    ds_write_b128 v32, v[16:19]
    ds_read_b64_tr_b16 v[28:29], v33
    ds_read_b64_tr_b16 v[30:31], v33 offset:576
    s_waitcnt lgkmcnt(0)
    v_mfma_f32_16x16x32_bf16 v[68:71], v[28:31], v[24:27], v[68:71]
    s_branch P2_back1_2
P2_slow1_3:
    ds_read_b32 v9, v1 offset:52032
    s_waitcnt lgkmcnt(0)
    s_mov_b64 exec, s[94:95]
    v_mov_b32 v9, 940572672
    s_mov_b64 exec, -1
    v_lshrrev_b32 v2, 24, v9
    v_mad_u32_u24 v9, v9, 32, v5
    buffer_load_dwordx4 v[16:19], v9, s[8:11], 0 offen
    v_add_u32_dpp v10, v2, v6 quad_perm:[0,0,0,0] row_mask:0xf bank_mask:0xf
    v_add_u32_dpp v11, v2, v6 quad_perm:[2,2,2,2] row_mask:0xf bank_mask:0xf
    ds_read_b64_tr_b16 v[24:25], v10 offset:2048
    ds_read_b64_tr_b16 v[26:27], v11 offset:2048
    ds_read_b128 v[20:23], v3 offset:26016
    ds_read_b32 v9, v1 offset:52128
    s_waitcnt lgkmcnt(1)
    v_and_b32 v24, v24, v20
    v_and_b32 v25, v25, v21
    v_and_b32 v26, v26, v22
    v_and_b32 v27, v27, v23
    s_waitcnt vmcnt(0)
    ds_write_b128 v32, v[16:19]
    ds_read_b64_tr_b16 v[28:29], v33
    ds_read_b64_tr_b16 v[30:31], v33 offset:576
    s_waitcnt lgkmcnt(0)
    v_mfma_f32_16x16x32_bf16 v[72:75], v[28:31], v[24:27], v[72:75]
    s_branch P2_back1_3
P2_slow1_4:
    ds_read_b32 v9, v1 offset:52256
    s_waitcnt lgkmcnt(0)
    s_mov_b64 exec, s[94:95]
    v_mov_b32 v9, 940572672
    s_mov_b64 exec, -1
    v_lshrrev_b32 v2, 24, v9
    v_mad_u32_u24 v9, v9, 32, v5
    buffer_load_dwordx4 v[16:19], v9, s[8:11], 0 offen
    v_add_u32_dpp v10, v2, v6 quad_perm:[0,0,0,0] row_mask:0xf bank_mask:0xf
    v_add_u32_dpp v11, v2, v6 quad_perm:[2,2,2,2] row_mask:0xf bank_mask:0xf
    ds_read_b64_tr_b16 v[24:25], v10 offset:2048
    ds_read_b64_tr_b16 v[26:27], v11 offset:2048
    ds_read_b128 v[20:23], v3 offset:26128
    ds_read_b32 v9, v1 offset:52352
    s_waitcnt lgkmcnt(1)
    v_and_b32 v24, v24, v20
    v_and_b32 v25, v25, v21
    v_and_b32 v26, v26, v22
    v_and_b32 v27, v27, v23
    s_waitcnt vmcnt(0)
    ds_write_b128 v32, v[16:19]
    ds_read_b64_tr_b16 v[28:29], v33
    ds_read_b64_tr_b16 v[30:31], v33 offset:576
    s_waitcnt lgkmcnt(0)
    v_mfma_f32_16x16x32_bf16 v[76:79], v[28:31], v[24:27], v[76:79]
    s_branch P2_back1_4
P2_slow1_5:
    ds_read_b32 v9, v1 offset:52480
    s_waitcnt lgkmcnt(0)
    s_mov_b64 exec, s[94:95]
    v_mov_b32 v9, 940572672
    s_mov_b64 exec, -1
    v_lshrrev_b32 v2, 24, v9
    v_mad_u32_u24 v9, v9, 32, v5
    buffer_load_dwordx4 v[16:19], v9, s[8:11], 0 offen
    v_add_u32_dpp v10, v2, v6 quad_perm:[0,0,0,0] row_mask:0xf bank_mask:0xf
    v_add_u32_dpp v11, v2, v6 quad_perm:[2,2,2,2] row_mask:0xf bank_mask:0xf
    ds_read_b64_tr_b16 v[24:25], v10 offset:2048
    ds_read_b64_tr_b16 v[26:27], v11 offset:2048
    ds_read_b128 v[20:23], v3 offset:26240
    ds_read_b32 v9, v1 offset:52576
    s_waitcnt lgkmcnt(1)
    v_and_b32 v24, v24, v20
    v_and_b32 v25, v25, v21
    v_and_b32 v26, v26, v22
    v_and_b32 v27, v27, v23
    s_waitcnt vmcnt(0)
    ds_write_b128 v32, v[16:19]
    ds_read_b64_tr_b16 v[28:29], v33
    ds_read_b64_tr_b16 v[30:31], v33 offset:576
    s_waitcnt lgkmcnt(0)
    v_mfma_f32_16x16x32_bf16 v[80:83], v[28:31], v[24:27], v[80:83]
    s_branch P2_back1_5
P2_slow1_6:
    ds_read_b32 v9, v1 offset:52704
    s_waitcnt lgkmcnt(0)
    s_mov_b64 exec, s[94:95]
    v_mov_b32 v9, 940572672
    s_mov_b64 exec, -1
    v_lshrrev_b32 v2, 24, v9
    v_mad_u32_u24 v9, v9, 32, v5
    buffer_load_dwordx4 v[16:19], v9, s[8:11], 0 offen
    v_add_u32_dpp v10, v2, v6 quad_perm:[0,0,0,0] row_mask:0xf bank_mask:0xf
    v_add_u32_dpp v11, v2, v6 quad_perm:[2,2,2,2] row_mask:0xf bank_mask:0xf
    ds_read_b64_tr_b16 v[24:25], v10 offset:2048
    ds_read_b64_tr_b16 v[26:27], v11 offset:2048
    ds_read_b128 v[20:23], v3 offset:26352
    ds_read_b32 v9, v1 offset:52800
    s_waitcnt lgkmcnt(1)
    v_and_b32 v24, v24, v20
    v_and_b32 v25, v25, v21
    v_and_b32 v26, v26, v22
    v_and_b32 v27, v27, v23
    s_waitcnt vmcnt(0)
    ds_write_b128 v32, v[16:19]
    ds_read_b64_tr_b16 v[28:29], v33
    ds_read_b64_tr_b16 v[30:31], v33 offset:576
    s_waitcnt lgkmcnt(0)
    v_mfma_f32_16x16x32_bf16 v[84:87], v[28:31], v[24:27], v[84:87]
    s_branch P2_back1_6
P2_slow1_7:
    ds_read_b32 v9, v1 offset:52928
    s_waitcnt lgkmcnt(0)
    s_mov_b64 exec, s[94:95]
    v_mov_b32 v9, 940572672
    s_mov_b64 exec, -1
    v_lshrrev_b32 v2, 24, v9
    v_mad_u32_u24 v9, v9, 32, v5
    buffer_load_dwordx4 v[16:19], v9, s[8:11], 0 offen
    v_add_u32_dpp v10, v2, v6 quad_perm:[0,0,0,0] row_mask:0xf bank_mask:0xf
    v_add_u32_dpp v11, v2, v6 quad_perm:[2,2,2,2] row_mask:0xf bank_mask:0xf
    ds_read_b64_tr_b16 v[24:25], v10 offset:2048
    ds_read_b64_tr_b16 v[26:27], v11 offset:2048
    ds_read_b128 v[20:23], v3 offset:26464
    ds_read_b32 v9, v1 offset:53024
    s_waitcnt lgkmcnt(1)
    v_and_b32 v24, v24, v20
    v_and_b32 v25, v25, v21
    v_and_b32 v26, v26, v22
    v_and_b32 v27, v27, v23
    s_waitcnt vmcnt(0)
    ds_write_b128 v32, v[16:19]
    ds_read_b64_tr_b16 v[28:29], v33
    ds_read_b64_tr_b16 v[30:31], v33 offset:576
    s_waitcnt lgkmcnt(0)
    v_mfma_f32_16x16x32_bf16 v[88:91], v[28:31], v[24:27], v[88:91]
    s_branch P2_back1_7
P2_slow1_8:
    ds_read_b32 v9, v1 offset:53152
    s_waitcnt lgkmcnt(0)
    s_mov_b64 exec, s[94:95]
    v_mov_b32 v9, 940572672
    s_mov_b64 exec, -1
    v_lshrrev_b32 v2, 24, v9
    v_mad_u32_u24 v9, v9, 32, v5
    buffer_load_dwordx4 v[16:19], v9, s[8:11], 0 offen
    v_add_u32_dpp v10, v2, v6 quad_perm:[0,0,0,0] row_mask:0xf bank_mask:0xf
    v_add_u32_dpp v11, v2, v6 quad_perm:[2,2,2,2] row_mask:0xf bank_mask:0xf
    ds_read_b64_tr_b16 v[24:25], v10 offset:2048
    ds_read_b64_tr_b16 v[26:27], v11 offset:2048
    ds_read_b128 v[20:23], v3 offset:26576
    ds_read_b32 v9, v1 offset:53248
    s_waitcnt lgkmcnt(1)
    v_and_b32 v24, v24, v20
    v_and_b32 v25, v25, v21
    v_and_b32 v26, v26, v22
    v_and_b32 v27, v27, v23
    s_waitcnt vmcnt(0)
    ds_write_b128 v32, v[16:19]
    ds_read_b64_tr_b16 v[28:29], v33
    ds_read_b64_tr_b16 v[30:31], v33 offset:576
    s_waitcnt lgkmcnt(0)
    v_mfma_f32_16x16x32_bf16 v[92:95], v[28:31], v[24:27], v[92:95]
    s_branch P2_back1_8
P2_slow1_9:
    ds_read_b32 v9, v1 offset:53376
    s_waitcnt lgkmcnt(0)
    s_mov_b64 exec, s[94:95]
    v_mov_b32 v9, 940572672
    s_mov_b64 exec, -1
    v_lshrrev_b32 v2, 24, v9
    v_mad_u32_u24 v9, v9, 32, v5
    buffer_load_dwordx4 v[16:19], v9, s[8:11], 0 offen
    v_add_u32_dpp v10, v2, v6 quad_perm:[0,0,0,0] row_mask:0xf bank_mask:0xf
    v_add_u32_dpp v11, v2, v6 quad_perm:[2,2,2,2] row_mask:0xf bank_mask:0xf
    ds_read_b64_tr_b16 v[24:25], v10 offset:2048
    ds_read_b64_tr_b16 v[26:27], v11 offset:2048
    ds_read_b128 v[20:23], v3 offset:26688
    ds_read_b32 v9, v1 offset:53472
    s_waitcnt lgkmcnt(1)
    v_and_b32 v24, v24, v20
    v_and_b32 v25, v25, v21
    v_and_b32 v26, v26, v22
    v_and_b32 v27, v27, v23
    s_waitcnt vmcnt(0)
    ds_write_b128 v32, v[16:19]
    ds_read_b64_tr_b16 v[28:29], v33
    ds_read_b64_tr_b16 v[30:31], v33 offset:576
    s_waitcnt lgkmcnt(0)
    v_mfma_f32_16x16x32_bf16 v[96:99], v[28:31], v[24:27], v[96:99]
    s_branch P2_back1_9
P2_slow1_10:
    ds_read_b32 v9, v1 offset:53600
    s_waitcnt lgkmcnt(0)
    s_mov_b64 exec, s[94:95]
    v_mov_b32 v9, 940572672
    s_mov_b64 exec, -1
    v_lshrrev_b32 v2, 24, v9
    v_mad_u32_u24 v9, v9, 32, v5
    buffer_load_dwordx4 v[16:19], v9, s[8:11], 0 offen
    v_add_u32_dpp v10, v2, v6 quad_perm:[0,0,0,0] row_mask:0xf bank_mask:0xf
    v_add_u32_dpp v11, v2, v6 quad_perm:[2,2,2,2] row_mask:0xf bank_mask:0xf
    ds_read_b64_tr_b16 v[24:25], v10 offset:2048
    ds_read_b64_tr_b16 v[26:27], v11 offset:2048
    ds_read_b128 v[20:23], v3 offset:26800
    ds_read_b32 v9, v1 offset:53696
    s_waitcnt lgkmcnt(1)
    v_and_b32 v24, v24, v20
    v_and_b32 v25, v25, v21
    v_and_b32 v26, v26, v22
    v_and_b32 v27, v27, v23
    s_waitcnt vmcnt(0)
    ds_write_b128 v32, v[16:19]
    ds_read_b64_tr_b16 v[28:29], v33
    ds_read_b64_tr_b16 v[30:31], v33 offset:576
    s_waitcnt lgkmcnt(0)
    v_mfma_f32_16x16x32_bf16 v[100:103], v[28:31], v[24:27], v[100:103]
    s_branch P2_back1_10
P2_slow1_11:
    ds_read_b32 v9, v1 offset:53824
    s_waitcnt lgkmcnt(0)
    s_mov_b64 exec, s[94:95]
    v_mov_b32 v9, 940572672
    s_mov_b64 exec, -1
    v_lshrrev_b32 v2, 24, v9
    v_mad_u32_u24 v9, v9, 32, v5
    buffer_load_dwordx4 v[16:19], v9, s[8:11], 0 offen
    v_add_u32_dpp v10, v2, v6 quad_perm:[0,0,0,0] row_mask:0xf bank_mask:0xf
    v_add_u32_dpp v11, v2, v6 quad_perm:[2,2,2,2] row_mask:0xf bank_mask:0xf
    ds_read_b64_tr_b16 v[24:25], v10 offset:2048
    ds_read_b64_tr_b16 v[26:27], v11 offset:2048
    ds_read_b128 v[20:23], v3 offset:26912
    ds_read_b32 v9, v1 offset:53920
    s_waitcnt lgkmcnt(1)
    v_and_b32 v24, v24, v20
    v_and_b32 v25, v25, v21
    v_and_b32 v26, v26, v22
    v_and_b32 v27, v27, v23
    s_waitcnt vmcnt(0)
    ds_write_b128 v32, v[16:19]
    ds_read_b64_tr_b16 v[28:29], v33
    ds_read_b64_tr_b16 v[30:31], v33 offset:576
    s_waitcnt lgkmcnt(0)
    v_mfma_f32_16x16x32_bf16 v[104:107], v[28:31], v[24:27], v[104:107]
    s_branch P2_back1_11
P2_slow1_12:
    ds_read_b32 v9, v1 offset:54048
    s_waitcnt lgkmcnt(0)
    s_mov_b64 exec, s[94:95]
    v_mov_b32 v9, 940572672
    s_mov_b64 exec, -1
    v_lshrrev_b32 v2, 24, v9
    v_mad_u32_u24 v9, v9, 32, v5
    buffer_load_dwordx4 v[16:19], v9, s[8:11], 0 offen
    v_add_u32_dpp v10, v2, v6 quad_perm:[0,0,0,0] row_mask:0xf bank_mask:0xf
    v_add_u32_dpp v11, v2, v6 quad_perm:[2,2,2,2] row_mask:0xf bank_mask:0xf
    ds_read_b64_tr_b16 v[24:25], v10 offset:2048
    ds_read_b64_tr_b16 v[26:27], v11 offset:2048
    ds_read_b128 v[20:23], v3 offset:27024
    ds_read_b32 v9, v1 offset:54144
    s_waitcnt lgkmcnt(1)
    v_and_b32 v24, v24, v20
    v_and_b32 v25, v25, v21
    v_and_b32 v26, v26, v22
    v_and_b32 v27, v27, v23
    s_waitcnt vmcnt(0)
    ds_write_b128 v32, v[16:19]
    ds_read_b64_tr_b16 v[28:29], v33
    ds_read_b64_tr_b16 v[30:31], v33 offset:576
    s_waitcnt lgkmcnt(0)
    v_mfma_f32_16x16x32_bf16 v[108:111], v[28:31], v[24:27], v[108:111]
    s_branch P2_back1_12
P2_slow1_13:
    ds_read_b32 v9, v1 offset:54272
    s_waitcnt lgkmcnt(0)
    s_mov_b64 exec, s[94:95]
    v_mov_b32 v9, 940572672
    s_mov_b64 exec, -1
    v_lshrrev_b32 v2, 24, v9
    v_mad_u32_u24 v9, v9, 32, v5
    buffer_load_dwordx4 v[16:19], v9, s[8:11], 0 offen
    v_add_u32_dpp v10, v2, v6 quad_perm:[0,0,0,0] row_mask:0xf bank_mask:0xf
    v_add_u32_dpp v11, v2, v6 quad_perm:[2,2,2,2] row_mask:0xf bank_mask:0xf
    ds_read_b64_tr_b16 v[24:25], v10 offset:2048
    ds_read_b64_tr_b16 v[26:27], v11 offset:2048
    ds_read_b128 v[20:23], v3 offset:27136
    ds_read_b32 v9, v1 offset:54368
    s_waitcnt lgkmcnt(1)
    v_and_b32 v24, v24, v20
    v_and_b32 v25, v25, v21
    v_and_b32 v26, v26, v22
    v_and_b32 v27, v27, v23
    s_waitcnt vmcnt(0)
    ds_write_b128 v32, v[16:19]
    ds_read_b64_tr_b16 v[28:29], v33
    ds_read_b64_tr_b16 v[30:31], v33 offset:576
    s_waitcnt lgkmcnt(0)
    v_mfma_f32_16x16x32_bf16 v[112:115], v[28:31], v[24:27], v[112:115]
    s_branch P2_back1_13
P2_slow1_14:
    ds_read_b32 v9, v1 offset:54496
    s_waitcnt lgkmcnt(0)
    s_mov_b64 exec, s[94:95]
    v_mov_b32 v9, 940572672
    s_mov_b64 exec, -1
    v_lshrrev_b32 v2, 24, v9
    v_mad_u32_u24 v9, v9, 32, v5
    buffer_load_dwordx4 v[16:19], v9, s[8:11], 0 offen
    v_add_u32_dpp v10, v2, v6 quad_perm:[0,0,0,0] row_mask:0xf bank_mask:0xf
    v_add_u32_dpp v11, v2, v6 quad_perm:[2,2,2,2] row_mask:0xf bank_mask:0xf
    ds_read_b64_tr_b16 v[24:25], v10 offset:2048
    ds_read_b64_tr_b16 v[26:27], v11 offset:2048
    ds_read_b128 v[20:23], v3 offset:27248
    ds_read_b32 v9, v1 offset:54592
    s_waitcnt lgkmcnt(1)
    v_and_b32 v24, v24, v20
    v_and_b32 v25, v25, v21
    v_and_b32 v26, v26, v22
    v_and_b32 v27, v27, v23
    s_waitcnt vmcnt(0)
    ds_write_b128 v32, v[16:19]
    ds_read_b64_tr_b16 v[28:29], v33
    ds_read_b64_tr_b16 v[30:31], v33 offset:576
    s_waitcnt lgkmcnt(0)
    v_mfma_f32_16x16x32_bf16 v[116:119], v[28:31], v[24:27], v[116:119]
    s_branch P2_back1_14
P2_slow1_15:
    ds_read_b32 v9, v1 offset:54720
    s_waitcnt lgkmcnt(0)
    s_mov_b64 exec, s[94:95]
    v_mov_b32 v9, 940572672
    s_mov_b64 exec, -1
    v_lshrrev_b32 v2, 24, v9
    v_mad_u32_u24 v9, v9, 32, v5
    buffer_load_dwordx4 v[16:19], v9, s[8:11], 0 offen
    v_add_u32_dpp v10, v2, v6 quad_perm:[0,0,0,0] row_mask:0xf bank_mask:0xf
    v_add_u32_dpp v11, v2, v6 quad_perm:[2,2,2,2] row_mask:0xf bank_mask:0xf
    ds_read_b64_tr_b16 v[24:25], v10 offset:2048
    ds_read_b64_tr_b16 v[26:27], v11 offset:2048
    ds_read_b128 v[20:23], v3 offset:27360
    ds_read_b32 v9, v1 offset:54816
    s_waitcnt lgkmcnt(1)
    v_and_b32 v24, v24, v20
    v_and_b32 v25, v25, v21
    v_and_b32 v26, v26, v22
    v_and_b32 v27, v27, v23
    s_waitcnt vmcnt(0)
    ds_write_b128 v32, v[16:19]
    ds_read_b64_tr_b16 v[28:29], v33
    ds_read_b64_tr_b16 v[30:31], v33 offset:576
    s_waitcnt lgkmcnt(0)
    v_mfma_f32_16x16x32_bf16 v[120:123], v[28:31], v[24:27], v[120:123]
    s_branch P2_back1_15
P2_slow1_16:
    ds_read_b32 v9, v1 offset:54944
    s_waitcnt lgkmcnt(0)
    s_mov_b64 exec, s[94:95]
    v_mov_b32 v9, 940572672
    s_mov_b64 exec, -1
    v_lshrrev_b32 v2, 24, v9
    v_mad_u32_u24 v9, v9, 32, v5
    buffer_load_dwordx4 v[16:19], v9, s[8:11], 0 offen
    v_add_u32_dpp v10, v2, v6 quad_perm:[0,0,0,0] row_mask:0xf bank_mask:0xf
    v_add_u32_dpp v11, v2, v6 quad_perm:[2,2,2,2] row_mask:0xf bank_mask:0xf
    ds_read_b64_tr_b16 v[24:25], v10 offset:2048
    ds_read_b64_tr_b16 v[26:27], v11 offset:2048
    ds_read_b128 v[20:23], v3 offset:27472
    s_waitcnt lgkmcnt(0)
    v_and_b32 v24, v24, v20
    v_and_b32 v25, v25, v21
    v_and_b32 v26, v26, v22
    v_and_b32 v27, v27, v23
    s_waitcnt vmcnt(0)
    ds_write_b128 v32, v[16:19]
    ds_read_b64_tr_b16 v[28:29], v33
    ds_read_b64_tr_b16 v[30:31], v33 offset:576
    s_waitcnt lgkmcnt(0)
    v_mfma_f32_16x16x32_bf16 v[124:127], v[28:31], v[24:27], v[124:127]
    s_branch P2_back1_16
P2_drain1:
    s_waitcnt lgkmcnt(0)
    v_mov_b32 v14, v15
    buffer_load_dwordx2 v[0:1], v14, s[12:15], 0 offen
    v_add_u32 v14, 16384, v14
    buffer_load_dwordx2 v[2:3], v14, s[12:15], 0 offen
    v_add_u32 v14, 16384, v14
    buffer_load_dwordx2 v[4:5], v14, s[12:15], 0 offen
    v_add_u32 v14, 16384, v14
    buffer_load_dwordx2 v[6:7], v14, s[12:15], 0 offen
    v_add_u32 v14, 16384, v14
    buffer_load_dwordx2 v[8:9], v14, s[12:15], 0 offen
    v_add_u32 v14, 16384, v14
    buffer_load_dwordx2 v[10:11], v14, s[12:15], 0 offen
    v_add_u32 v14, 16384, v14
    buffer_load_dwordx2 v[16:17], v14, s[12:15], 0 offen
    v_add_u32 v14, 16384, v14
    buffer_load_dwordx2 v[18:19], v14, s[12:15], 0 offen
    v_add_u32 v14, 16384, v14
    buffer_load_dwordx2 v[20:21], v14, s[12:15], 0 offen
    v_add_u32 v14, 16384, v14
    buffer_load_dwordx2 v[22:23], v14, s[12:15], 0 offen
    v_add_u32 v14, 16384, v14
    buffer_load_dwordx2 v[24:25], v14, s[12:15], 0 offen
    v_add_u32 v14, 16384, v14
    buffer_load_dwordx2 v[26:27], v14, s[12:15], 0 offen
    v_add_u32 v14, 16384, v14
    s_mov_b32 s51, 50144
    s_waitcnt vmcnt(13)
    ds_write_b128 v32, v[52:55]
    ds_read_b64_tr_b16 v[28:29], v33
    ds_read_b64_tr_b16 v[30:31], v33 offset:576
    s_waitcnt lgkmcnt(0)
    v_mfma_f32_16x16x32_bf16 v[120:123], v[28:31], v[44:47], v[120:123]
    s_waitcnt vmcnt(12)
    ds_write_b128 v32, v[56:59]
    ds_read_b64_tr_b16 v[28:29], v33
    ds_read_b64_tr_b16 v[30:31], v33 offset:576
    s_waitcnt lgkmcnt(0)
    v_mfma_f32_16x16x32_bf16 v[124:127], v[28:31], v[48:51], v[124:127]
    s_branch P2_epi
P2_drain0:
    s_waitcnt lgkmcnt(0)
    v_mov_b32 v14, v15
    buffer_load_dwordx2 v[0:1], v14, s[12:15], 0 offen
    v_add_u32 v14, 16384, v14
    buffer_load_dwordx2 v[2:3], v14, s[12:15], 0 offen
    v_add_u32 v14, 16384, v14
    buffer_load_dwordx2 v[4:5], v14, s[12:15], 0 offen
    v_add_u32 v14, 16384, v14
    buffer_load_dwordx2 v[6:7], v14, s[12:15], 0 offen
    v_add_u32 v14, 16384, v14
    buffer_load_dwordx2 v[8:9], v14, s[12:15], 0 offen
    v_add_u32 v14, 16384, v14
    buffer_load_dwordx2 v[10:11], v14, s[12:15], 0 offen
    v_add_u32 v14, 16384, v14
    buffer_load_dwordx2 v[16:17], v14, s[12:15], 0 offen
    v_add_u32 v14, 16384, v14
    buffer_load_dwordx2 v[18:19], v14, s[12:15], 0 offen
    v_add_u32 v14, 16384, v14
    buffer_load_dwordx2 v[20:21], v14, s[12:15], 0 offen
    v_add_u32 v14, 16384, v14
    buffer_load_dwordx2 v[22:23], v14, s[12:15], 0 offen
    v_add_u32 v14, 16384, v14
    buffer_load_dwordx2 v[24:25], v14, s[12:15], 0 offen
    v_add_u32 v14, 16384, v14
    buffer_load_dwordx2 v[26:27], v14, s[12:15], 0 offen
    v_add_u32 v14, 16384, v14
    s_mov_b32 s51, 94080
    s_waitcnt vmcnt(13)
    ds_write_b128 v32, v[56:59]
    ds_read_b64_tr_b16 v[28:29], v33
    ds_read_b64_tr_b16 v[30:31], v33 offset:576
    s_waitcnt lgkmcnt(0)
    v_mfma_f32_16x16x32_bf16 v[120:123], v[28:31], v[48:51], v[120:123]
    s_waitcnt vmcnt(12)
    ds_write_b128 v32, v[52:55]
    ds_read_b64_tr_b16 v[28:29], v33
    ds_read_b64_tr_b16 v[30:31], v33 offset:576
    s_waitcnt lgkmcnt(0)
    v_mfma_f32_16x16x32_bf16 v[124:127], v[28:31], v[44:47], v[124:127]
P2_epi:
    s_lshl_b32 s47, s47, 3
    s_add_u32 s47, s47, s44
    s_lshl_b32 s47, s47, 9
    s_add_u32 s51, s51, s47
    v_add_u32 v12, s51, v13
    v_add_u32 v13, 24528, v13
    v_mov_b32 v56, 161892
P2_lwr:
    ds_read_b32 v57, v56
    s_waitcnt lgkmcnt(0)
    v_readfirstlane_b32 s40, v57
    s_cmp_ge_u32 s40, 4
    s_cbranch_scc1 P2_lgr
    s_sleep 1
    s_branch P2_lwr
P2_lgr:
    ds_read_b64 v[32:33], v13 offset:0
    ds_read_b64 v[34:35], v13 offset:512
    ds_read_b64 v[36:37], v13 offset:1024
    ds_read_b64 v[38:39], v13 offset:1536
    ds_read_b64 v[40:41], v13 offset:2048
    ds_read_b64 v[42:43], v13 offset:2560
    ds_read_b64 v[44:45], v12 offset:0
    ds_read_b64 v[46:47], v12 offset:512
    v_cvt_pk_bf16_f32 v60, v60, v61
    v_cvt_pk_bf16_f32 v61, v62, v63
    s_waitcnt lgkmcnt(0)
    s_nop 0
    v_mfma_f32_16x16x16_bf16 v[28:31], v[42:43], v[60:61], 0
    v_mfma_f32_16x16x16_bf16 v[48:51], v[32:33], v[44:45], 0
    v_mfma_f32_16x16x16_bf16 v[52:55], v[36:37], v[44:45], 0
    s_nop 6
    v_pk_mul_f32 v[60:61], v[48:49], v[28:29]
    v_pk_mul_f32 v[62:63], v[50:51], v[30:31]
    v_cvt_pk_bf16_f32 v60, v60, v61
    v_cvt_pk_bf16_f32 v61, v62, v63
    s_nop 1
    v_mfma_f32_16x16x16_bf16 v[56:59], v[40:41], v[60:61], 0
    v_cvt_pk_bf16_f32 v64, v64, v65
    v_cvt_pk_bf16_f32 v65, v66, v67
    s_waitcnt vmcnt(11)
    v_mfma_f32_16x16x16_bf16 v[48:51], v[34:35], v[44:45], 0
    v_lshlrev_b32 v60, 16, v0
    v_and_b32 v61, 0xffff0000, v0
    v_mfma_f32_16x16x16_bf16 v[28:31], v[42:43], v[64:65], 0
    v_lshlrev_b32 v62, 16, v1
    v_and_b32 v63, 0xffff0000, v1
    v_pk_fma_f32 v[60:61], v[56:57], v[52:53], v[60:61]
    v_pk_fma_f32 v[62:63], v[58:59], v[54:55], v[62:63]
    v_mfma_f32_16x16x16_bf16 v[52:55], v[38:39], v[44:45], 0
    v_cvt_pk_bf16_f32 v0, v60, v61
    v_cvt_pk_bf16_f32 v1, v62, v63
    buffer_store_dwordx2 v[0:1], v15, s[28:31], 0 offen nt
    v_pk_mul_f32 v[64:65], v[48:49], v[28:29]
    v_pk_mul_f32 v[66:67], v[50:51], v[30:31]
    v_cvt_pk_bf16_f32 v64, v64, v65
    v_cvt_pk_bf16_f32 v65, v66, v67
    v_add_u32 v15, 16384, v15
    ds_read_b64 v[44:45], v12 offset:1024
    buffer_load_dwordx2 v[60:61], v14, s[12:15], 0 offen
    v_add_u32 v14, 16384, v14
    buffer_load_dwordx2 v[62:63], v14, s[12:15], 0 offen
    v_add_u32 v14, 16384, v14
    v_mfma_f32_16x16x16_bf16 v[56:59], v[40:41], v[64:65], 0
    v_cvt_pk_bf16_f32 v68, v68, v69
    v_cvt_pk_bf16_f32 v69, v70, v71
    s_waitcnt vmcnt(13) lgkmcnt(1)
    v_mfma_f32_16x16x16_bf16 v[48:51], v[32:33], v[46:47], 0
    v_lshlrev_b32 v64, 16, v2
    v_and_b32 v65, 0xffff0000, v2
    v_mfma_f32_16x16x16_bf16 v[28:31], v[42:43], v[68:69], 0
    v_lshlrev_b32 v66, 16, v3
    v_and_b32 v67, 0xffff0000, v3
    v_pk_fma_f32 v[64:65], v[56:57], v[52:53], v[64:65]
    v_pk_fma_f32 v[66:67], v[58:59], v[54:55], v[66:67]
    v_mfma_f32_16x16x16_bf16 v[52:55], v[36:37], v[46:47], 0
    v_cvt_pk_bf16_f32 v2, v64, v65
    v_cvt_pk_bf16_f32 v3, v66, v67
    buffer_store_dwordx2 v[2:3], v15, s[28:31], 0 offen nt
    v_pk_mul_f32 v[68:69], v[48:49], v[28:29]
    v_pk_mul_f32 v[70:71], v[50:51], v[30:31]
    v_cvt_pk_bf16_f32 v68, v68, v69
    v_cvt_pk_bf16_f32 v69, v70, v71
    v_add_u32 v15, 16384, v15
    buffer_load_dwordx2 v[64:65], v14, s[12:15], 0 offen
    v_add_u32 v14, 16384, v14
    buffer_load_dwordx2 v[66:67], v14, s[12:15], 0 offen
    v_add_u32 v14, 16384, v14
    v_mfma_f32_16x16x16_bf16 v[56:59], v[40:41], v[68:69], 0
    v_cvt_pk_bf16_f32 v72, v72, v73
    v_cvt_pk_bf16_f32 v73, v74, v75
    s_waitcnt vmcnt(15)
    v_mfma_f32_16x16x16_bf16 v[48:51], v[34:35], v[46:47], 0
    v_lshlrev_b32 v68, 16, v4
    v_and_b32 v69, 0xffff0000, v4
    v_mfma_f32_16x16x16_bf16 v[28:31], v[42:43], v[72:73], 0
    v_lshlrev_b32 v70, 16, v5
    v_and_b32 v71, 0xffff0000, v5
    v_pk_fma_f32 v[68:69], v[56:57], v[52:53], v[68:69]
    v_pk_fma_f32 v[70:71], v[58:59], v[54:55], v[70:71]
    v_mfma_f32_16x16x16_bf16 v[52:55], v[38:39], v[46:47], 0
    v_cvt_pk_bf16_f32 v4, v68, v69
    v_cvt_pk_bf16_f32 v5, v70, v71
    buffer_store_dwordx2 v[4:5], v15, s[28:31], 0 offen nt
    v_pk_mul_f32 v[72:73], v[48:49], v[28:29]
    v_pk_mul_f32 v[74:75], v[50:51], v[30:31]
    v_cvt_pk_bf16_f32 v72, v72, v73
    v_cvt_pk_bf16_f32 v73, v74, v75
    v_add_u32 v15, 16384, v15
    ds_read_b64 v[46:47], v12 offset:1536
    buffer_load_dwordx2 v[68:69], v14, s[12:15], 0 offen
    v_add_u32 v14, 16384, v14
    v_mfma_f32_16x16x16_bf16 v[56:59], v[40:41], v[72:73], 0
    v_cvt_pk_bf16_f32 v76, v76, v77
    v_cvt_pk_bf16_f32 v77, v78, v79
    s_waitcnt vmcnt(16) lgkmcnt(1)
    v_mfma_f32_16x16x16_bf16 v[48:51], v[32:33], v[44:45], 0
    v_lshlrev_b32 v72, 16, v6
    v_and_b32 v73, 0xffff0000, v6
    v_mfma_f32_16x16x16_bf16 v[28:31], v[42:43], v[76:77], 0
    v_lshlrev_b32 v74, 16, v7
    v_and_b32 v75, 0xffff0000, v7
    v_pk_fma_f32 v[72:73], v[56:57], v[52:53], v[72:73]
    v_pk_fma_f32 v[74:75], v[58:59], v[54:55], v[74:75]
    v_mfma_f32_16x16x16_bf16 v[52:55], v[36:37], v[44:45], 0
    v_cvt_pk_bf16_f32 v6, v72, v73
    v_cvt_pk_bf16_f32 v7, v74, v75
    buffer_store_dwordx2 v[6:7], v15, s[28:31], 0 offen nt
    v_pk_mul_f32 v[76:77], v[48:49], v[28:29]
    v_pk_mul_f32 v[78:79], v[50:51], v[30:31]
    v_cvt_pk_bf16_f32 v76, v76, v77
    v_cvt_pk_bf16_f32 v77, v78, v79
    v_add_u32 v15, 16384, v15
    s_nop 0
    v_mfma_f32_16x16x16_bf16 v[56:59], v[40:41], v[76:77], 0
    v_cvt_pk_bf16_f32 v80, v80, v81
    v_cvt_pk_bf16_f32 v81, v82, v83
    s_waitcnt vmcnt(16)
    v_mfma_f32_16x16x16_bf16 v[48:51], v[34:35], v[44:45], 0
    v_lshlrev_b32 v76, 16, v8
    v_and_b32 v77, 0xffff0000, v8
    v_mfma_f32_16x16x16_bf16 v[28:31], v[42:43], v[80:81], 0
    v_lshlrev_b32 v78, 16, v9
    v_and_b32 v79, 0xffff0000, v9
    v_pk_fma_f32 v[76:77], v[56:57], v[52:53], v[76:77]
    v_pk_fma_f32 v[78:79], v[58:59], v[54:55], v[78:79]
    v_mfma_f32_16x16x16_bf16 v[52:55], v[38:39], v[44:45], 0
    v_cvt_pk_bf16_f32 v8, v76, v77
    v_cvt_pk_bf16_f32 v9, v78, v79
    buffer_store_dwordx2 v[8:9], v15, s[28:31], 0 offen nt
    v_pk_mul_f32 v[80:81], v[48:49], v[28:29]
    v_pk_mul_f32 v[82:83], v[50:51], v[30:31]
    v_cvt_pk_bf16_f32 v80, v80, v81
    v_cvt_pk_bf16_f32 v81, v82, v83
    v_add_u32 v15, 16384, v15
    ds_read_b64 v[44:45], v12 offset:2048
    v_mfma_f32_16x16x16_bf16 v[56:59], v[40:41], v[80:81], 0
    v_cvt_pk_bf16_f32 v84, v84, v85
    v_cvt_pk_bf16_f32 v85, v86, v87
    s_waitcnt vmcnt(16) lgkmcnt(1)
    v_mfma_f32_16x16x16_bf16 v[48:51], v[32:33], v[46:47], 0
    v_lshlrev_b32 v80, 16, v10
    v_and_b32 v81, 0xffff0000, v10
    v_mfma_f32_16x16x16_bf16 v[28:31], v[42:43], v[84:85], 0
    v_lshlrev_b32 v82, 16, v11
    v_and_b32 v83, 0xffff0000, v11
    v_pk_fma_f32 v[80:81], v[56:57], v[52:53], v[80:81]
    v_pk_fma_f32 v[82:83], v[58:59], v[54:55], v[82:83]
    v_mfma_f32_16x16x16_bf16 v[52:55], v[36:37], v[46:47], 0
    v_cvt_pk_bf16_f32 v10, v80, v81
    v_cvt_pk_bf16_f32 v11, v82, v83
    buffer_store_dwordx2 v[10:11], v15, s[28:31], 0 offen nt
    v_pk_mul_f32 v[84:85], v[48:49], v[28:29]
    v_pk_mul_f32 v[86:87], v[50:51], v[30:31]
    v_cvt_pk_bf16_f32 v84, v84, v85
    v_cvt_pk_bf16_f32 v85, v86, v87
    v_add_u32 v15, 16384, v15
    s_nop 0
    v_mfma_f32_16x16x16_bf16 v[56:59], v[40:41], v[84:85], 0
    v_cvt_pk_bf16_f32 v88, v88, v89
    v_cvt_pk_bf16_f32 v89, v90, v91
    s_waitcnt vmcnt(16)
    v_mfma_f32_16x16x16_bf16 v[48:51], v[34:35], v[46:47], 0
    v_lshlrev_b32 v84, 16, v16
    v_and_b32 v85, 0xffff0000, v16
    v_mfma_f32_16x16x16_bf16 v[28:31], v[42:43], v[88:89], 0
    v_lshlrev_b32 v86, 16, v17
    v_and_b32 v87, 0xffff0000, v17
    v_pk_fma_f32 v[84:85], v[56:57], v[52:53], v[84:85]
    v_pk_fma_f32 v[86:87], v[58:59], v[54:55], v[86:87]
    v_mfma_f32_16x16x16_bf16 v[52:55], v[38:39], v[46:47], 0
    v_cvt_pk_bf16_f32 v16, v84, v85
    v_cvt_pk_bf16_f32 v17, v86, v87
    buffer_store_dwordx2 v[16:17], v15, s[28:31], 0 offen nt
    v_pk_mul_f32 v[88:89], v[48:49], v[28:29]
    v_pk_mul_f32 v[90:91], v[50:51], v[30:31]
    v_cvt_pk_bf16_f32 v88, v88, v89
    v_cvt_pk_bf16_f32 v89, v90, v91
    v_add_u32 v15, 16384, v15
    ds_read_b64 v[46:47], v12 offset:2560
    v_mfma_f32_16x16x16_bf16 v[56:59], v[40:41], v[88:89], 0
    v_cvt_pk_bf16_f32 v92, v92, v93
    v_cvt_pk_bf16_f32 v93, v94, v95
    s_waitcnt vmcnt(16) lgkmcnt(1)
    v_mfma_f32_16x16x16_bf16 v[48:51], v[32:33], v[44:45], 0
    v_lshlrev_b32 v88, 16, v18
    v_and_b32 v89, 0xffff0000, v18
    v_mfma_f32_16x16x16_bf16 v[28:31], v[42:43], v[92:93], 0
    v_lshlrev_b32 v90, 16, v19
    v_and_b32 v91, 0xffff0000, v19
    v_pk_fma_f32 v[88:89], v[56:57], v[52:53], v[88:89]
    v_pk_fma_f32 v[90:91], v[58:59], v[54:55], v[90:91]
    v_mfma_f32_16x16x16_bf16 v[52:55], v[36:37], v[44:45], 0
    v_cvt_pk_bf16_f32 v18, v88, v89
    v_cvt_pk_bf16_f32 v19, v90, v91
    buffer_store_dwordx2 v[18:19], v15, s[28:31], 0 offen nt
    v_pk_mul_f32 v[92:93], v[48:49], v[28:29]
    v_pk_mul_f32 v[94:95], v[50:51], v[30:31]
    v_cvt_pk_bf16_f32 v92, v92, v93
    v_cvt_pk_bf16_f32 v93, v94, v95
    v_add_u32 v15, 16384, v15
    s_nop 0
    v_mfma_f32_16x16x16_bf16 v[56:59], v[40:41], v[92:93], 0
    v_cvt_pk_bf16_f32 v96, v96, v97
    v_cvt_pk_bf16_f32 v97, v98, v99
    s_waitcnt vmcnt(16)
    v_mfma_f32_16x16x16_bf16 v[48:51], v[34:35], v[44:45], 0
    v_lshlrev_b32 v92, 16, v20
    v_and_b32 v93, 0xffff0000, v20
    v_mfma_f32_16x16x16_bf16 v[28:31], v[42:43], v[96:97], 0
    v_lshlrev_b32 v94, 16, v21
    v_and_b32 v95, 0xffff0000, v21
    v_pk_fma_f32 v[92:93], v[56:57], v[52:53], v[92:93]
    v_pk_fma_f32 v[94:95], v[58:59], v[54:55], v[94:95]
    v_mfma_f32_16x16x16_bf16 v[52:55], v[38:39], v[44:45], 0
    v_cvt_pk_bf16_f32 v20, v92, v93
    v_cvt_pk_bf16_f32 v21, v94, v95
    buffer_store_dwordx2 v[20:21], v15, s[28:31], 0 offen nt
    v_pk_mul_f32 v[96:97], v[48:49], v[28:29]
    v_pk_mul_f32 v[98:99], v[50:51], v[30:31]
    v_cvt_pk_bf16_f32 v96, v96, v97
    v_cvt_pk_bf16_f32 v97, v98, v99
    v_add_u32 v15, 16384, v15
    ds_read_b64 v[44:45], v12 offset:3072
    v_mfma_f32_16x16x16_bf16 v[56:59], v[40:41], v[96:97], 0
    v_cvt_pk_bf16_f32 v100, v100, v101
    v_cvt_pk_bf16_f32 v101, v102, v103
    s_waitcnt vmcnt(16) lgkmcnt(1)
    v_mfma_f32_16x16x16_bf16 v[48:51], v[32:33], v[46:47], 0
    v_lshlrev_b32 v96, 16, v22
    v_and_b32 v97, 0xffff0000, v22
    v_mfma_f32_16x16x16_bf16 v[28:31], v[42:43], v[100:101], 0
    v_lshlrev_b32 v98, 16, v23
    v_and_b32 v99, 0xffff0000, v23
    v_pk_fma_f32 v[96:97], v[56:57], v[52:53], v[96:97]
    v_pk_fma_f32 v[98:99], v[58:59], v[54:55], v[98:99]
    v_mfma_f32_16x16x16_bf16 v[52:55], v[36:37], v[46:47], 0
    v_cvt_pk_bf16_f32 v22, v96, v97
    v_cvt_pk_bf16_f32 v23, v98, v99
    buffer_store_dwordx2 v[22:23], v15, s[28:31], 0 offen nt
    v_pk_mul_f32 v[100:101], v[48:49], v[28:29]
    v_pk_mul_f32 v[102:103], v[50:51], v[30:31]
    v_cvt_pk_bf16_f32 v100, v100, v101
    v_cvt_pk_bf16_f32 v101, v102, v103
    v_add_u32 v15, 16384, v15
    s_nop 0
    v_mfma_f32_16x16x16_bf16 v[56:59], v[40:41], v[100:101], 0
    v_cvt_pk_bf16_f32 v104, v104, v105
    v_cvt_pk_bf16_f32 v105, v106, v107
    s_waitcnt vmcnt(16)
    v_mfma_f32_16x16x16_bf16 v[48:51], v[34:35], v[46:47], 0
    v_lshlrev_b32 v100, 16, v24
    v_and_b32 v101, 0xffff0000, v24
    v_mfma_f32_16x16x16_bf16 v[28:31], v[42:43], v[104:105], 0
    v_lshlrev_b32 v102, 16, v25
    v_and_b32 v103, 0xffff0000, v25
    v_pk_fma_f32 v[100:101], v[56:57], v[52:53], v[100:101]
    v_pk_fma_f32 v[102:103], v[58:59], v[54:55], v[102:103]
    v_mfma_f32_16x16x16_bf16 v[52:55], v[38:39], v[46:47], 0
    v_cvt_pk_bf16_f32 v24, v100, v101
    v_cvt_pk_bf16_f32 v25, v102, v103
    buffer_store_dwordx2 v[24:25], v15, s[28:31], 0 offen nt
    v_pk_mul_f32 v[104:105], v[48:49], v[28:29]
    v_pk_mul_f32 v[106:107], v[50:51], v[30:31]
    v_cvt_pk_bf16_f32 v104, v104, v105
    v_cvt_pk_bf16_f32 v105, v106, v107
    v_add_u32 v15, 16384, v15
    ds_read_b64 v[46:47], v12 offset:3584
    v_mfma_f32_16x16x16_bf16 v[56:59], v[40:41], v[104:105], 0
    v_cvt_pk_bf16_f32 v108, v108, v109
    v_cvt_pk_bf16_f32 v109, v110, v111
    s_waitcnt vmcnt(16) lgkmcnt(1)
    v_mfma_f32_16x16x16_bf16 v[48:51], v[32:33], v[44:45], 0
    v_lshlrev_b32 v104, 16, v26
    v_and_b32 v105, 0xffff0000, v26
    v_mfma_f32_16x16x16_bf16 v[28:31], v[42:43], v[108:109], 0
    v_lshlrev_b32 v106, 16, v27
    v_and_b32 v107, 0xffff0000, v27
    v_pk_fma_f32 v[104:105], v[56:57], v[52:53], v[104:105]
    v_pk_fma_f32 v[106:107], v[58:59], v[54:55], v[106:107]
    v_mfma_f32_16x16x16_bf16 v[52:55], v[36:37], v[44:45], 0
    v_cvt_pk_bf16_f32 v26, v104, v105
    v_cvt_pk_bf16_f32 v27, v106, v107
    buffer_store_dwordx2 v[26:27], v15, s[28:31], 0 offen nt
    v_pk_mul_f32 v[108:109], v[48:49], v[28:29]
    v_pk_mul_f32 v[110:111], v[50:51], v[30:31]
    v_cvt_pk_bf16_f32 v108, v108, v109
    v_cvt_pk_bf16_f32 v109, v110, v111
    v_add_u32 v15, 16384, v15
    s_nop 0
    v_mfma_f32_16x16x16_bf16 v[56:59], v[40:41], v[108:109], 0
    v_cvt_pk_bf16_f32 v112, v112, v113
    v_cvt_pk_bf16_f32 v113, v114, v115
    s_waitcnt vmcnt(15)
    v_mfma_f32_16x16x16_bf16 v[48:51], v[34:35], v[44:45], 0
    v_lshlrev_b32 v108, 16, v60
    v_and_b32 v109, 0xffff0000, v60
    v_mfma_f32_16x16x16_bf16 v[28:31], v[42:43], v[112:113], 0
    v_lshlrev_b32 v110, 16, v61
    v_and_b32 v111, 0xffff0000, v61
    v_pk_fma_f32 v[108:109], v[56:57], v[52:53], v[108:109]
    v_pk_fma_f32 v[110:111], v[58:59], v[54:55], v[110:111]
    v_mfma_f32_16x16x16_bf16 v[52:55], v[38:39], v[44:45], 0
    v_cvt_pk_bf16_f32 v60, v108, v109
    v_cvt_pk_bf16_f32 v61, v110, v111
    buffer_store_dwordx2 v[60:61], v15, s[28:31], 0 offen nt
    v_pk_mul_f32 v[112:113], v[48:49], v[28:29]
    v_pk_mul_f32 v[114:115], v[50:51], v[30:31]
    v_cvt_pk_bf16_f32 v112, v112, v113
    v_cvt_pk_bf16_f32 v113, v114, v115
    v_add_u32 v15, 16384, v15
    ds_read_b64 v[44:45], v12 offset:4096
    v_mfma_f32_16x16x16_bf16 v[56:59], v[40:41], v[112:113], 0
    v_cvt_pk_bf16_f32 v116, v116, v117
    v_cvt_pk_bf16_f32 v117, v118, v119
    s_waitcnt vmcnt(15) lgkmcnt(1)
    v_mfma_f32_16x16x16_bf16 v[48:51], v[32:33], v[46:47], 0
    v_lshlrev_b32 v112, 16, v62
    v_and_b32 v113, 0xffff0000, v62
    v_mfma_f32_16x16x16_bf16 v[28:31], v[42:43], v[116:117], 0
    v_lshlrev_b32 v114, 16, v63
    v_and_b32 v115, 0xffff0000, v63
    v_pk_fma_f32 v[112:113], v[56:57], v[52:53], v[112:113]
    v_pk_fma_f32 v[114:115], v[58:59], v[54:55], v[114:115]
    v_mfma_f32_16x16x16_bf16 v[52:55], v[36:37], v[46:47], 0
    v_cvt_pk_bf16_f32 v62, v112, v113
    v_cvt_pk_bf16_f32 v63, v114, v115
    buffer_store_dwordx2 v[62:63], v15, s[28:31], 0 offen nt
    v_pk_mul_f32 v[116:117], v[48:49], v[28:29]
    v_pk_mul_f32 v[118:119], v[50:51], v[30:31]
    v_cvt_pk_bf16_f32 v116, v116, v117
    v_cvt_pk_bf16_f32 v117, v118, v119
    v_add_u32 v15, 16384, v15
    s_nop 0
    v_mfma_f32_16x16x16_bf16 v[56:59], v[40:41], v[116:117], 0
    v_cvt_pk_bf16_f32 v120, v120, v121
    v_cvt_pk_bf16_f32 v121, v122, v123
    s_waitcnt vmcnt(14)
    v_mfma_f32_16x16x16_bf16 v[48:51], v[34:35], v[46:47], 0
    v_lshlrev_b32 v116, 16, v64
    v_and_b32 v117, 0xffff0000, v64
    v_mfma_f32_16x16x16_bf16 v[28:31], v[42:43], v[120:121], 0
    v_lshlrev_b32 v118, 16, v65
    v_and_b32 v119, 0xffff0000, v65
    v_pk_fma_f32 v[116:117], v[56:57], v[52:53], v[116:117]
    v_pk_fma_f32 v[118:119], v[58:59], v[54:55], v[118:119]
    v_mfma_f32_16x16x16_bf16 v[52:55], v[38:39], v[46:47], 0
    v_cvt_pk_bf16_f32 v64, v116, v117
    v_cvt_pk_bf16_f32 v65, v118, v119
    buffer_store_dwordx2 v[64:65], v15, s[28:31], 0 offen nt
    v_pk_mul_f32 v[120:121], v[48:49], v[28:29]
    v_pk_mul_f32 v[122:123], v[50:51], v[30:31]
    v_cvt_pk_bf16_f32 v120, v120, v121
    v_cvt_pk_bf16_f32 v121, v122, v123
    v_add_u32 v15, 16384, v15
    s_nop 0
    v_mfma_f32_16x16x16_bf16 v[56:59], v[40:41], v[120:121], 0
    v_cvt_pk_bf16_f32 v124, v124, v125
    v_cvt_pk_bf16_f32 v125, v126, v127
    s_waitcnt vmcnt(14) lgkmcnt(0)
    v_mfma_f32_16x16x16_bf16 v[48:51], v[32:33], v[44:45], 0
    v_lshlrev_b32 v120, 16, v66
    v_and_b32 v121, 0xffff0000, v66
    v_mfma_f32_16x16x16_bf16 v[28:31], v[42:43], v[124:125], 0
    v_lshlrev_b32 v122, 16, v67
    v_and_b32 v123, 0xffff0000, v67
    v_pk_fma_f32 v[120:121], v[56:57], v[52:53], v[120:121]
    v_pk_fma_f32 v[122:123], v[58:59], v[54:55], v[122:123]
    v_mfma_f32_16x16x16_bf16 v[52:55], v[36:37], v[44:45], 0
    v_cvt_pk_bf16_f32 v66, v120, v121
    v_cvt_pk_bf16_f32 v67, v122, v123
    buffer_store_dwordx2 v[66:67], v15, s[28:31], 0 offen nt
    v_pk_mul_f32 v[124:125], v[48:49], v[28:29]
    v_pk_mul_f32 v[126:127], v[50:51], v[30:31]
    v_cvt_pk_bf16_f32 v124, v124, v125
    v_cvt_pk_bf16_f32 v125, v126, v127
    v_add_u32 v15, 16384, v15
    s_cmp_lt_u32 s50, 17
    s_cbranch_scc1 P2_fin
    v_mfma_f32_16x16x16_bf16 v[56:59], v[40:41], v[124:125], 0
    s_waitcnt vmcnt(13)
    v_lshlrev_b32 v124, 16, v68
    v_and_b32 v125, 0xffff0000, v68
    v_lshlrev_b32 v126, 16, v69
    v_and_b32 v127, 0xffff0000, v69
    s_nop 2
    v_pk_fma_f32 v[124:125], v[56:57], v[52:53], v[124:125]
    v_pk_fma_f32 v[126:127], v[58:59], v[54:55], v[126:127]
    v_cvt_pk_bf16_f32 v68, v124, v125
    v_cvt_pk_bf16_f32 v69, v126, v127
    buffer_store_dwordx2 v[68:69], v15, s[28:31], 0 offen nt
    v_add_u32 v15, 16384, v15
P2_fin:
P2_end:
    s_endpgm
.section .rodata,"a"
.p2align 6
.amdhsa_kernel gather_scatter__molecular_angular_gemnet__graph_kernel
  .amdhsa_next_free_vgpr 128
  .amdhsa_next_free_sgpr 100
  .amdhsa_accum_offset 128
  .amdhsa_group_segment_fixed_size 0
  .amdhsa_kernarg_size 112
  .amdhsa_user_sgpr_count 2
  .amdhsa_user_sgpr_kernarg_segment_ptr 1
  .amdhsa_system_sgpr_workgroup_id_x 1
  .amdhsa_float_denorm_mode_32 3
.end_amdhsa_kernel
```
